```python
import torch

def _softmax(x, axis=-1):
    return torch.softmax(x, dim=axis)

def _gelu(x):
    return torch.nn.functional.gelu(x, approximate='tanh')

def _silu(x):
    return torch.nn.functional.silu(x)

def _sigmoid(x):
    return torch.sigmoid(x)

def _layernorm(x, axis=-1, eps=1e-05):
    m = x.mean(dim=axis, keepdim=True)
    v = x.var(dim=axis, keepdim=True, unbiased=False)
    return (x - m) / torch.sqrt(v + eps)

def _scatter_add(tgt, idx, src, axis=0):
    return tgt.clone().index_add_(axis, idx, src)

def _segment_sum(src, seg, n):
    out = torch.zeros((n,) + src.shape[1:], dtype=src.dtype)
    return out.index_add_(0, seg, src)

def _pad(x, pw):
    flat = tuple((v for pair in reversed(pw) for v in pair))
    return torch.nn.functional.pad(x, flat)
kernel_name = 'interleave_layers__sliding_local_dilated__memory_aug_recurrent_mem_tr__prompt'

def setup_inputs():

    _w = lambda a: (lambda t: t.to(torch.bfloat16) if t.is_floating_point() else t)(torch.as_tensor(a))

    def _A_setup():
        B, S, D = (1, 2048, 512)
        return {'x': _w((lambda *s: torch.randn(*s, dtype=torch.bfloat16) * 0.05)(B, S, D)), 'wqkv': _w((lambda *s: torch.randn(*s, dtype=torch.bfloat16) * 0.05)(D, 3 * D)), 'wo': _w((lambda *s: torch.randn(*s, dtype=torch.bfloat16) * 0.05)(D, D))}
    _A_in = _A_setup()

    def _B_setup():
        B, S, Dm = (1, 2048, 512)
        H, Dh = (32, 128)
        M, seg = (8, 32)
        seg = min(seg, S)
        S = S // seg * seg
        return {'x': _w((lambda *s: torch.randn(*s, dtype=torch.bfloat16) * 0.05)(B, S, Dm)), 'mem0': _w((lambda *s: torch.randn(*s, dtype=torch.bfloat16) * 0.8)(B, M, Dm)), 'Wq': _w((lambda *s: torch.randn(*s, dtype=torch.bfloat16) * 1.6)(Dm, H, Dh) * Dm ** (-0.5)), 'Wk': _w((lambda *s: torch.randn(*s, dtype=torch.bfloat16) * 1.6)(Dm, H, Dh) * Dm ** (-0.5)), 'Wv': _w((lambda *s: torch.randn(*s, dtype=torch.bfloat16) * 0.8)(Dm, H, Dh) * Dm ** (-0.5)), 'Wo': _w((lambda *s: torch.randn(*s, dtype=torch.bfloat16) * 0.8)(H, Dh, Dm) * (H * Dh) ** (-0.5)), 'seg_len': seg}
    _B_in = _B_setup()
    return {'A_x': _A_in['x'], 'A_wqkv': _A_in['wqkv'], 'A_wo': _A_in['wo'], 'B_x': _B_in['x'], 'B_mem0': _B_in['mem0'], 'B_Wq': _B_in['Wq'], 'B_Wk': _B_in['Wk'], 'B_Wv': _B_in['Wv'], 'B_Wo': _B_in['Wo'], 'B_seg_len': _B_in['seg_len']}

def reference(A_x, A_wqkv, A_wo, B_x, B_mem0, B_Wq, B_Wk, B_Wv, B_Wo, B_seg_len):

    def _A_ref(x, wqkv, wo):
        B, S, D = x.shape
        H = 32
        Dh = D // H
        W, dil = (8, 2)
        qkv = (lambda x, *d: x.permute(*d))((x @ wqkv).reshape(B, S, 3, H, Dh), 2, 0, 3, 1, 4)
        q, k, v = (qkv[0], qkv[1], qkv[2])
        scale = Dh ** (-0.5)
        pos = torch.arange(S)
        off = torch.arange(W) * dil
        idx = pos[:, None] - off[None, :]
        mask = idx >= 0
        idx_c = torch.where(mask, idx, 0).reshape(-1)
        kg = k[:, :, idx_c, :].reshape(B, H, S, W, Dh)
        vg = v[:, :, idx_c, :].reshape(B, H, S, W, Dh)
        logits = torch.einsum('bhsd,bhswd->bhsw', q, kg) * scale
        logits = torch.where(mask[None, None, :, :], logits, -1000000000.0)
        attn = _softmax(logits, axis=-1)
        o = torch.einsum('bhsw,bhswd->bhsd', attn, vg)
        return (lambda x, *d: x.permute(*d))(o, 0, 2, 1, 3).reshape(B, S, D) @ wo

    def _B_ref(x, mem0, Wq, Wk, Wv, Wo, seg_len):
        B, S, Dm = x.shape
        H, Dh = (Wq.shape[1], Wq.shape[2])
        M = mem0.shape[1]
        scale = Dh ** (-0.5)
        n_seg = S // seg_len
        L = M + seg_len
        idx = torch.arange(L)
        mask = (idx[:, None] < M) | (idx[:, None] >= idx[None, :])
        mem = mem0
        outs = []
        for s in range(n_seg):
            xs = x[:, s * seg_len:(s + 1) * seg_len, :].clone()
            h = torch.concatenate([mem, xs], axis=1)
            q = torch.einsum('btd,dhe->bhte', h, Wq)
            k = torch.einsum('btd,dhe->bhte', h, Wk)
            v = torch.einsum('btd,dhe->bhte', h, Wv)
            scores = torch.einsum('bhqe,bhke->bhqk', q, k) * scale
            scores = torch.where(mask[None, None], scores, -1000000000.0)
            p = _softmax(scores, axis=-1)
            o = torch.einsum('bhqk,bhke->bhqe', p, v)
            o = torch.einsum('bhte,hed->btd', o, Wo)
            mem = o[:, :M, :].clone()
            outs.append(o[:, M:, :])
        return torch.concatenate(outs, axis=1)
    x = A_x
    x = x + _A_ref(_layernorm(x, axis=-1), A_wqkv, A_wo)
    x = x + _B_ref(_layernorm(x, axis=-1), B_mem0, B_Wq, B_Wk, B_Wv, B_Wo, B_seg_len)
    x = x + _A_ref(_layernorm(x, axis=-1), A_wqkv, A_wo)
    x = x + _B_ref(_layernorm(x, axis=-1), B_mem0, B_Wq, B_Wk, B_Wv, B_Wo, B_seg_len)
    return x
```

```asm
; @launch grid=(256,1,1) block=(256,1,1) lds=163840
.amdgcn_target "amdgcn-amd-amdhsa--gfx950"
.text
.globl interleave_layers__sliding_local_dilated__memory_aug_recurrent_mem_tr__prompt_kernel
.p2align 8
.type interleave_layers__sliding_local_dilated__memory_aug_recurrent_mem_tr__prompt_kernel,@function
interleave_layers__sliding_local_dilated__memory_aug_recurrent_mem_tr__prompt_kernel:
    s_cmp_ge_u32 s2, 256
    s_cbranch_scc1 K_DONE
    s_load_dwordx2 s[88:89], s[0:1], 88
    s_load_dwordx2 s[84:85], s[0:1], 96
    s_load_dwordx2 s[82:83], s[0:1], 0
    s_getreg_b32 s90, hwreg(HW_REG_XCC_ID, 0, 4)
    s_and_b32 s90, s90, 7
    v_lshrrev_b32 v3, 6, v0
    v_and_b32 v6, 63, v0
    v_readfirstlane_b32 s95, v3
    v_lshlrev_b32 v5, 4, v6
    v_mov_b32 v8, 0
    v_mov_b32 v12, -1
    v_mov_b32 v9, 0
    v_mov_b32 v13, -1
    v_mov_b32 v10, 0
    v_mov_b32 v14, -1
    v_mov_b32 v11, 0
    v_mov_b32 v15, -1
    s_waitcnt lgkmcnt(0)
    s_mov_b32 s86, 0x10000000
    s_mov_b32 s87, 0x20000
    s_cmp_eq_u32 s95, 3
    s_cbranch_scc1 ST_ZERO
    s_mul_i32 s93, s2, 6144
    s_lshl_b32 s94, s95, 11
    s_add_u32 s93, s93, s94
    s_add_u32 s93, s93, 1048576
    buffer_store_dwordx4 v[12:15], v5, s[84:87], s93 offen sc1
    buffer_store_dwordx4 v[12:15], v5, s[84:87], s93 offen offset:1024 sc1
    s_branch ST_INIT
ST_ZERO:
    s_lshl_b32 s93, s2, 10
    buffer_store_dwordx4 v[8:11], v5, s[84:87], s93 offen sc1
ST_INIT:
    s_waitcnt vmcnt(0)
    s_barrier
    s_cmp_lg_u32 s95, 0
    s_cbranch_scc1 ST_REGD
    s_lshr_b32 s93, s90, 2
    s_lshl_b32 s93, s93, 7
    s_and_b32 s94, s90, 3
    s_lshl_b32 s94, s94, 2
    s_add_u32 s93, s93, s94
    v_mov_b32 v1, s93
    v_mov_b32 v2, 1
    s_mov_b64 exec, 1
    global_atomic_add v4, v1, v2, s[88:89] sc0
    s_mov_b64 exec, -1
    s_waitcnt vmcnt(0)
    v_readfirstlane_b32 s91, v4
    s_nop 0
    s_cmp_lt_u32 s91, 32
    s_cbranch_scc1 ST_SLOT
    v_mov_b32 v1, 16
    s_mov_b64 exec, 1
    global_atomic_add v4, v1, v2, s[88:89] sc0
    s_mov_b64 exec, -1
    s_waitcnt vmcnt(0)
    v_readfirstlane_b32 s91, v4
    s_mov_b32 s94, 0
ST_ALL:
    v_and_b32 v1, 7, v6
    v_lshrrev_b32 v5, 2, v1
    v_lshlrev_b32 v5, 7, v5
    v_and_b32 v1, 3, v1
    v_lshlrev_b32 v1, 2, v1
    v_add_u32 v1, v1, v5
    global_load_dword v4, v1, s[88:89] sc1
    s_add_u32 s94, s94, 1
    s_cmp_gt_u32 s94, 200000
    s_cbranch_scc1 K_FAIL
    s_waitcnt vmcnt(0)
    s_mov_b32 s93, 0
    v_readlane_b32 s60, v4, 0
    v_readlane_b32 s61, v4, 1
    v_readlane_b32 s62, v4, 2
    v_readlane_b32 s63, v4, 3
    v_readlane_b32 s64, v4, 4
    v_readlane_b32 s65, v4, 5
    v_readlane_b32 s66, v4, 6
    v_readlane_b32 s67, v4, 7
    s_add_u32 s93, s93, s60
    s_add_u32 s93, s93, s61
    s_add_u32 s93, s93, s62
    s_add_u32 s93, s93, s63
    s_add_u32 s93, s93, s64
    s_add_u32 s93, s93, s65
    s_add_u32 s93, s93, s66
    s_add_u32 s93, s93, s67
    s_cmp_lt_u32 s93, 256
    s_cbranch_scc1 ST_ALL
    s_min_u32 s93, s60, 32
    s_sub_u32 s94, 32, s93
    s_cmp_lt_u32 s91, s94
    s_cbranch_scc0 ST_NX0
    s_mov_b32 s90, 0
    s_add_u32 s91, s91, s93
    s_branch ST_SLOT
ST_NX0:
    s_sub_u32 s91, s91, s94
    s_min_u32 s93, s61, 32
    s_sub_u32 s94, 32, s93
    s_cmp_lt_u32 s91, s94
    s_cbranch_scc0 ST_NX1
    s_mov_b32 s90, 1
    s_add_u32 s91, s91, s93
    s_branch ST_SLOT
ST_NX1:
    s_sub_u32 s91, s91, s94
    s_min_u32 s93, s62, 32
    s_sub_u32 s94, 32, s93
    s_cmp_lt_u32 s91, s94
    s_cbranch_scc0 ST_NX2
    s_mov_b32 s90, 2
    s_add_u32 s91, s91, s93
    s_branch ST_SLOT
ST_NX2:
    s_sub_u32 s91, s91, s94
    s_min_u32 s93, s63, 32
    s_sub_u32 s94, 32, s93
    s_cmp_lt_u32 s91, s94
    s_cbranch_scc0 ST_NX3
    s_mov_b32 s90, 3
    s_add_u32 s91, s91, s93
    s_branch ST_SLOT
ST_NX3:
    s_sub_u32 s91, s91, s94
    s_min_u32 s93, s64, 32
    s_sub_u32 s94, 32, s93
    s_cmp_lt_u32 s91, s94
    s_cbranch_scc0 ST_NX4
    s_mov_b32 s90, 4
    s_add_u32 s91, s91, s93
    s_branch ST_SLOT
ST_NX4:
    s_sub_u32 s91, s91, s94
    s_min_u32 s93, s65, 32
    s_sub_u32 s94, 32, s93
    s_cmp_lt_u32 s91, s94
    s_cbranch_scc0 ST_NX5
    s_mov_b32 s90, 5
    s_add_u32 s91, s91, s93
    s_branch ST_SLOT
ST_NX5:
    s_sub_u32 s91, s91, s94
    s_min_u32 s93, s66, 32
    s_sub_u32 s94, 32, s93
    s_cmp_lt_u32 s91, s94
    s_cbranch_scc0 ST_NX6
    s_mov_b32 s90, 6
    s_add_u32 s91, s91, s93
    s_branch ST_SLOT
ST_NX6:
    s_sub_u32 s91, s91, s94
    s_min_u32 s93, s67, 32
    s_sub_u32 s94, 32, s93
    s_cmp_lt_u32 s91, s94
    s_cbranch_scc0 ST_NX7
    s_mov_b32 s90, 7
    s_add_u32 s91, s91, s93
    s_branch ST_SLOT
ST_NX7:
    s_sub_u32 s91, s91, s94
    s_branch K_FAIL
ST_SLOT:
    v_mov_b32 v8, s90
    v_mov_b32 v9, s91
    v_mov_b32 v6, 0
    ds_write_b64 v6, v[8:9]
    s_waitcnt lgkmcnt(0)
ST_REGD:
    s_barrier
    v_mov_b32 v6, 0
    ds_read_b64 v[8:9], v6
    s_waitcnt lgkmcnt(0)
    v_readfirstlane_b32 s90, v8
    v_readfirstlane_b32 s91, v9
    s_and_b32 s90, s90, 7
    s_and_b32 s91, s91, 31
    s_barrier
    s_mov_b64 s[4:5], s[84:85]
    s_mov_b32 s6, s86
    s_mov_b32 s7, s87
    v_mbcnt_lo_u32_b32 v0, -1, 0
    v_mbcnt_hi_u32_b32 v0, -1, v0
    s_lshl_b32 s93, s95, 6
    v_add_u32 v0, s93, v0
    s_cmp_eq_u32 s90, 0
    s_cbranch_scc1 TEAM0
    s_cmp_eq_u32 s90, 1
    s_cbranch_scc1 TEAM1
    s_cmp_eq_u32 s90, 2
    s_cbranch_scc1 TEAM2
    s_cmp_eq_u32 s90, 3
    s_cbranch_scc1 TEAM3
    s_cmp_eq_u32 s90, 4
    s_cbranch_scc1 TEAM4
    s_cmp_eq_u32 s90, 5
    s_cbranch_scc1 TEAM5
    s_cmp_eq_u32 s90, 6
    s_cbranch_scc1 TEAM6
    s_cmp_eq_u32 s90, 7
    s_cbranch_scc1 TEAM7
    s_branch K_FAIL
TEAM0:
    s_mov_b32 s36, 0
    s_branch ROLE_R
TEAM1:
    s_mov_b32 s94, 4
    s_branch PHASE_L1
TEAM2:
    s_mov_b32 s94, 0
    s_branch PHASE_L1
TEAM3:
    s_load_dwordx2 s[4:5], s[0:1], 96
    s_load_dwordx2 s[20:21], s[0:1], 80
    s_mov_b32 s9, s95
    s_lshr_b32 s53, s91, 3
    s_and_b32 s55, s91, 7
    s_lshl_b32 s8, s55, 2
    s_add_u32 s8, s8, s9
    s_mov_b32 s6, 268435456
    s_mov_b32 s7, 0x20000
    s_mov_b32 s22, 2097152
    s_mov_b32 s23, 0x20000
    v_and_b32 v11, 63, v0
    v_lshlrev_b32 v0, 4, v11
    v_lshrrev_b32 v12, 4, v11
    v_and_b32 v13, 15, v11
    v_lshlrev_b32 v14, 9, v12
    v_lshlrev_b32 v15, 4, v13
    v_add_u32 v1, v14, v15
    v_lshrrev_b32 v15, 2, v13
    v_lshlrev_b32 v14, 3, v12
    v_add_u32 v14, v14, v15
    v_lshlrev_b32 v14, 7, v14
    v_lshrrev_b32 v15, 1, v15
    v_and_b32 v16, 1, v12
    v_lshlrev_b32 v16, 1, v16
    v_or_b32 v15, v15, v16
    v_xor_b32 v15, s9, v15
    v_lshlrev_b32 v15, 5, v15
    v_add_u32 v14, v14, v15
    v_and_b32 v15, 3, v11
    v_lshlrev_b32 v15, 3, v15
    v_add_u32 v5, v14, v15
    v_and_b32 v14, 7, v11
    v_lshlrev_b32 v2, 2, v14
    v_and_b32 v14, 31, v11
    v_lshrrev_b32 v15, 5, v11
    v_lshlrev_b32 v16, 10, v14
    v_lshlrev_b32 v17, 4, v15
    s_lshl_b32 s11, s8, 5
    v_add3_u32 v3, v16, v17, s11
    v_lshlrev_b32 v17, 4, v14
    s_lshr_b32 s11, s55, 1
    s_lshl_b32 s11, s11, 9
    s_and_b32 s12, s55, 1
    s_lshl_b32 s12, s12, 3
    s_add_u32 s11, s11, s12
    v_add_u32 v4, s11, v17
    v_and_b32 v14, 7, v11
    v_lshlrev_b32 v14, 8, v14
    s_lshr_b32 s11, s8, 4
    s_lshl_b32 s11, s11, 7
    s_bfe_u32 s12, s8, 0x20002
    s_lshl_b32 s12, s12, 2
    s_add_u32 s11, s11, s12
    v_add_u32 v7, s11, v14
    s_mov_b32 s24, -1
    s_mov_b32 s25, 0
    v_mov_b32 v18, -1
    v_mov_b32 v19, -1
    s_waitcnt lgkmcnt(0)
    s_lshl_b32 s57, s95, 5
    s_add_u32 s57, s57, s91
    s_lshl_b32 s12, s57, 14
    s_lshr_b32 s13, s57, 1
    s_lshl_b32 s61, s13, 15
    s_and_b32 s13, s57, 1
    s_lshl_b32 s13, s13, 8
    s_add_u32 s61, s61, s13
    s_add_u32 s61, s61, 8388608
    s_load_dwordx2 s[16:17], s[0:1], 0
    s_mov_b32 s18, 2097152
    s_mov_b32 s19, 0x20000
    s_waitcnt lgkmcnt(0)
    v_lshrrev_b32 v11, 4, v0
    v_and_b32 v12, 15, v11
    v_lshlrev_b32 v12, 10, v12
    v_lshrrev_b32 v13, 4, v11
    v_lshlrev_b32 v13, 4, v13
    v_add_u32 v16, v12, v13
    buffer_load_dwordx4 v[128:131], v16, s[16:19], s12 offen offset:0
    buffer_load_dwordx4 v[132:135], v16, s[16:19], s12 offen offset:64
    buffer_load_dwordx4 v[136:139], v16, s[16:19], s12 offen offset:128
    buffer_load_dwordx4 v[140:143], v16, s[16:19], s12 offen offset:192
    buffer_load_dwordx4 v[144:147], v16, s[16:19], s12 offen offset:256
    buffer_load_dwordx4 v[148:151], v16, s[16:19], s12 offen offset:320
    buffer_load_dwordx4 v[152:155], v16, s[16:19], s12 offen offset:384
    buffer_load_dwordx4 v[156:159], v16, s[16:19], s12 offen offset:448
    buffer_load_dwordx4 v[160:163], v16, s[16:19], s12 offen offset:512
    buffer_load_dwordx4 v[164:167], v16, s[16:19], s12 offen offset:576
    buffer_load_dwordx4 v[168:171], v16, s[16:19], s12 offen offset:640
    buffer_load_dwordx4 v[172:175], v16, s[16:19], s12 offen offset:704
    buffer_load_dwordx4 v[176:179], v16, s[16:19], s12 offen offset:768
    buffer_load_dwordx4 v[180:183], v16, s[16:19], s12 offen offset:832
    buffer_load_dwordx4 v[184:187], v16, s[16:19], s12 offen offset:896
    buffer_load_dwordx4 v[188:191], v16, s[16:19], s12 offen offset:960
    s_mov_b32 s58, 0x3f803f80
    v_mov_b32 v44, 0
    v_mov_b32 v45, 0
    v_mov_b32 v14, 0
    v_mov_b32 v15, 0
    s_waitcnt vmcnt(15)
    v_dot2c_f32_bf16 v44, s58, v128
    v_dot2c_f32_bf16 v45, v128, v128
    v_dot2c_f32_bf16 v14, s58, v129
    v_dot2c_f32_bf16 v15, v129, v129
    v_dot2c_f32_bf16 v44, s58, v130
    v_dot2c_f32_bf16 v45, v130, v130
    v_dot2c_f32_bf16 v14, s58, v131
    v_dot2c_f32_bf16 v15, v131, v131
    s_waitcnt vmcnt(14)
    v_dot2c_f32_bf16 v44, s58, v132
    v_dot2c_f32_bf16 v45, v132, v132
    v_dot2c_f32_bf16 v14, s58, v133
    v_dot2c_f32_bf16 v15, v133, v133
    v_dot2c_f32_bf16 v44, s58, v134
    v_dot2c_f32_bf16 v45, v134, v134
    v_dot2c_f32_bf16 v14, s58, v135
    v_dot2c_f32_bf16 v15, v135, v135
    s_waitcnt vmcnt(13)
    v_dot2c_f32_bf16 v44, s58, v136
    v_dot2c_f32_bf16 v45, v136, v136
    v_dot2c_f32_bf16 v14, s58, v137
    v_dot2c_f32_bf16 v15, v137, v137
    v_dot2c_f32_bf16 v44, s58, v138
    v_dot2c_f32_bf16 v45, v138, v138
    v_dot2c_f32_bf16 v14, s58, v139
    v_dot2c_f32_bf16 v15, v139, v139
    s_waitcnt vmcnt(12)
    v_dot2c_f32_bf16 v44, s58, v140
    v_dot2c_f32_bf16 v45, v140, v140
    v_dot2c_f32_bf16 v14, s58, v141
    v_dot2c_f32_bf16 v15, v141, v141
    v_dot2c_f32_bf16 v44, s58, v142
    v_dot2c_f32_bf16 v45, v142, v142
    v_dot2c_f32_bf16 v14, s58, v143
    v_dot2c_f32_bf16 v15, v143, v143
    s_waitcnt vmcnt(11)
    v_dot2c_f32_bf16 v44, s58, v144
    v_dot2c_f32_bf16 v45, v144, v144
    v_dot2c_f32_bf16 v14, s58, v145
    v_dot2c_f32_bf16 v15, v145, v145
    v_dot2c_f32_bf16 v44, s58, v146
    v_dot2c_f32_bf16 v45, v146, v146
    v_dot2c_f32_bf16 v14, s58, v147
    v_dot2c_f32_bf16 v15, v147, v147
    s_waitcnt vmcnt(10)
    v_dot2c_f32_bf16 v44, s58, v148
    v_dot2c_f32_bf16 v45, v148, v148
    v_dot2c_f32_bf16 v14, s58, v149
    v_dot2c_f32_bf16 v15, v149, v149
    v_dot2c_f32_bf16 v44, s58, v150
    v_dot2c_f32_bf16 v45, v150, v150
    v_dot2c_f32_bf16 v14, s58, v151
    v_dot2c_f32_bf16 v15, v151, v151
    s_waitcnt vmcnt(9)
    v_dot2c_f32_bf16 v44, s58, v152
    v_dot2c_f32_bf16 v45, v152, v152
    v_dot2c_f32_bf16 v14, s58, v153
    v_dot2c_f32_bf16 v15, v153, v153
    v_dot2c_f32_bf16 v44, s58, v154
    v_dot2c_f32_bf16 v45, v154, v154
    v_dot2c_f32_bf16 v14, s58, v155
    v_dot2c_f32_bf16 v15, v155, v155
    s_waitcnt vmcnt(8)
    v_dot2c_f32_bf16 v44, s58, v156
    v_dot2c_f32_bf16 v45, v156, v156
    v_dot2c_f32_bf16 v14, s58, v157
    v_dot2c_f32_bf16 v15, v157, v157
    v_dot2c_f32_bf16 v44, s58, v158
    v_dot2c_f32_bf16 v45, v158, v158
    v_dot2c_f32_bf16 v14, s58, v159
    v_dot2c_f32_bf16 v15, v159, v159
    s_waitcnt vmcnt(7)
    v_dot2c_f32_bf16 v44, s58, v160
    v_dot2c_f32_bf16 v45, v160, v160
    v_dot2c_f32_bf16 v14, s58, v161
    v_dot2c_f32_bf16 v15, v161, v161
    v_dot2c_f32_bf16 v44, s58, v162
    v_dot2c_f32_bf16 v45, v162, v162
    v_dot2c_f32_bf16 v14, s58, v163
    v_dot2c_f32_bf16 v15, v163, v163
    s_waitcnt vmcnt(6)
    v_dot2c_f32_bf16 v44, s58, v164
    v_dot2c_f32_bf16 v45, v164, v164
    v_dot2c_f32_bf16 v14, s58, v165
    v_dot2c_f32_bf16 v15, v165, v165
    v_dot2c_f32_bf16 v44, s58, v166
    v_dot2c_f32_bf16 v45, v166, v166
    v_dot2c_f32_bf16 v14, s58, v167
    v_dot2c_f32_bf16 v15, v167, v167
    s_waitcnt vmcnt(5)
    v_dot2c_f32_bf16 v44, s58, v168
    v_dot2c_f32_bf16 v45, v168, v168
    v_dot2c_f32_bf16 v14, s58, v169
    v_dot2c_f32_bf16 v15, v169, v169
    v_dot2c_f32_bf16 v44, s58, v170
    v_dot2c_f32_bf16 v45, v170, v170
    v_dot2c_f32_bf16 v14, s58, v171
    v_dot2c_f32_bf16 v15, v171, v171
    s_waitcnt vmcnt(4)
    v_dot2c_f32_bf16 v44, s58, v172
    v_dot2c_f32_bf16 v45, v172, v172
    v_dot2c_f32_bf16 v14, s58, v173
    v_dot2c_f32_bf16 v15, v173, v173
    v_dot2c_f32_bf16 v44, s58, v174
    v_dot2c_f32_bf16 v45, v174, v174
    v_dot2c_f32_bf16 v14, s58, v175
    v_dot2c_f32_bf16 v15, v175, v175
    s_waitcnt vmcnt(3)
    v_dot2c_f32_bf16 v44, s58, v176
    v_dot2c_f32_bf16 v45, v176, v176
    v_dot2c_f32_bf16 v14, s58, v177
    v_dot2c_f32_bf16 v15, v177, v177
    v_dot2c_f32_bf16 v44, s58, v178
    v_dot2c_f32_bf16 v45, v178, v178
    v_dot2c_f32_bf16 v14, s58, v179
    v_dot2c_f32_bf16 v15, v179, v179
    s_waitcnt vmcnt(2)
    v_dot2c_f32_bf16 v44, s58, v180
    v_dot2c_f32_bf16 v45, v180, v180
    v_dot2c_f32_bf16 v14, s58, v181
    v_dot2c_f32_bf16 v15, v181, v181
    v_dot2c_f32_bf16 v44, s58, v182
    v_dot2c_f32_bf16 v45, v182, v182
    v_dot2c_f32_bf16 v14, s58, v183
    v_dot2c_f32_bf16 v15, v183, v183
    s_waitcnt vmcnt(1)
    v_dot2c_f32_bf16 v44, s58, v184
    v_dot2c_f32_bf16 v45, v184, v184
    v_dot2c_f32_bf16 v14, s58, v185
    v_dot2c_f32_bf16 v15, v185, v185
    v_dot2c_f32_bf16 v44, s58, v186
    v_dot2c_f32_bf16 v45, v186, v186
    v_dot2c_f32_bf16 v14, s58, v187
    v_dot2c_f32_bf16 v15, v187, v187
    s_waitcnt vmcnt(0)
    v_dot2c_f32_bf16 v44, s58, v188
    v_dot2c_f32_bf16 v45, v188, v188
    v_dot2c_f32_bf16 v14, s58, v189
    v_dot2c_f32_bf16 v15, v189, v189
    v_dot2c_f32_bf16 v44, s58, v190
    v_dot2c_f32_bf16 v45, v190, v190
    v_dot2c_f32_bf16 v14, s58, v191
    v_dot2c_f32_bf16 v15, v191, v191
    s_nop 1
    v_add_f32 v44, v44, v14
    v_add_f32 v45, v45, v15
    v_mov_b32 v12, v44
    v_mov_b32 v13, v45
    s_nop 0
    v_permlane16_swap_b32 v44, v12
    v_permlane16_swap_b32 v45, v13
    v_add_f32 v44, v44, v12
    v_add_f32 v45, v45, v13
    v_mov_b32 v12, v44
    v_mov_b32 v13, v45
    s_nop 0
    v_permlane32_swap_b32 v44, v12
    v_permlane32_swap_b32 v45, v13
    v_add_f32 v44, v44, v12
    v_add_f32 v45, v45, v13
    v_mul_f32 v44, 0x3b000000, v44
    v_mul_f32 v45, 0x3b000000, v45
    v_fma_f32 v45, -v44, v44, v45
    v_max_f32 v45, 0, v45
    v_add_f32 v45, 0x3727c5ac, v45
    v_rsq_f32 v45, v45
    s_nop 0
    v_mul_f32 v44, v44, v45
    v_sub_f32 v44, 0, v44
    s_mov_b32 s11, s61
    v_lshlrev_b32 v12, 16, v128
    v_and_b32 v13, 0xffff0000, v128
    v_lshlrev_b32 v14, 16, v129
    v_and_b32 v15, 0xffff0000, v129
    v_lshlrev_b32 v16, 16, v130
    v_and_b32 v17, 0xffff0000, v130
    v_lshlrev_b32 v10, 16, v131
    v_and_b32 v11, 0xffff0000, v131
    v_fma_f32 v12, v12, v45, v44
    v_fma_f32 v13, v13, v45, v44
    v_fma_f32 v14, v14, v45, v44
    v_fma_f32 v15, v15, v45, v44
    v_fma_f32 v16, v16, v45, v44
    v_fma_f32 v17, v17, v45, v44
    v_fma_f32 v10, v10, v45, v44
    v_fma_f32 v11, v11, v45, v44
    v_cvt_pk_bf16_f32 v128, v12, v13
    v_cvt_pk_bf16_f32 v129, v14, v15
    v_cvt_pk_bf16_f32 v130, v16, v17
    v_cvt_pk_bf16_f32 v131, v10, v11
    buffer_store_dwordx4 v[128:131], v1, s[4:7], s11 offen offset:0 sc1
    v_lshlrev_b32 v12, 16, v132
    v_and_b32 v13, 0xffff0000, v132
    v_lshlrev_b32 v14, 16, v133
    v_and_b32 v15, 0xffff0000, v133
    v_lshlrev_b32 v16, 16, v134
    v_and_b32 v17, 0xffff0000, v134
    v_lshlrev_b32 v10, 16, v135
    v_and_b32 v11, 0xffff0000, v135
    v_fma_f32 v12, v12, v45, v44
    v_fma_f32 v13, v13, v45, v44
    v_fma_f32 v14, v14, v45, v44
    v_fma_f32 v15, v15, v45, v44
    v_fma_f32 v16, v16, v45, v44
    v_fma_f32 v17, v17, v45, v44
    v_fma_f32 v10, v10, v45, v44
    v_fma_f32 v11, v11, v45, v44
    v_cvt_pk_bf16_f32 v132, v12, v13
    v_cvt_pk_bf16_f32 v133, v14, v15
    v_cvt_pk_bf16_f32 v134, v16, v17
    v_cvt_pk_bf16_f32 v135, v10, v11
    buffer_store_dwordx4 v[132:135], v1, s[4:7], s11 offen offset:2048 sc1
    s_add_u32 s11, s11, 4096
    v_lshlrev_b32 v12, 16, v136
    v_and_b32 v13, 0xffff0000, v136
    v_lshlrev_b32 v14, 16, v137
    v_and_b32 v15, 0xffff0000, v137
    v_lshlrev_b32 v16, 16, v138
    v_and_b32 v17, 0xffff0000, v138
    v_lshlrev_b32 v10, 16, v139
    v_and_b32 v11, 0xffff0000, v139
    v_fma_f32 v12, v12, v45, v44
    v_fma_f32 v13, v13, v45, v44
    v_fma_f32 v14, v14, v45, v44
    v_fma_f32 v15, v15, v45, v44
    v_fma_f32 v16, v16, v45, v44
    v_fma_f32 v17, v17, v45, v44
    v_fma_f32 v10, v10, v45, v44
    v_fma_f32 v11, v11, v45, v44
    v_cvt_pk_bf16_f32 v136, v12, v13
    v_cvt_pk_bf16_f32 v137, v14, v15
    v_cvt_pk_bf16_f32 v138, v16, v17
    v_cvt_pk_bf16_f32 v139, v10, v11
    buffer_store_dwordx4 v[136:139], v1, s[4:7], s11 offen offset:0 sc1
    v_lshlrev_b32 v12, 16, v140
    v_and_b32 v13, 0xffff0000, v140
    v_lshlrev_b32 v14, 16, v141
    v_and_b32 v15, 0xffff0000, v141
    v_lshlrev_b32 v16, 16, v142
    v_and_b32 v17, 0xffff0000, v142
    v_lshlrev_b32 v10, 16, v143
    v_and_b32 v11, 0xffff0000, v143
    v_fma_f32 v12, v12, v45, v44
    v_fma_f32 v13, v13, v45, v44
    v_fma_f32 v14, v14, v45, v44
    v_fma_f32 v15, v15, v45, v44
    v_fma_f32 v16, v16, v45, v44
    v_fma_f32 v17, v17, v45, v44
    v_fma_f32 v10, v10, v45, v44
    v_fma_f32 v11, v11, v45, v44
    v_cvt_pk_bf16_f32 v140, v12, v13
    v_cvt_pk_bf16_f32 v141, v14, v15
    v_cvt_pk_bf16_f32 v142, v16, v17
    v_cvt_pk_bf16_f32 v143, v10, v11
    buffer_store_dwordx4 v[140:143], v1, s[4:7], s11 offen offset:2048 sc1
    s_add_u32 s11, s11, 4096
    v_lshlrev_b32 v12, 16, v144
    v_and_b32 v13, 0xffff0000, v144
    v_lshlrev_b32 v14, 16, v145
    v_and_b32 v15, 0xffff0000, v145
    v_lshlrev_b32 v16, 16, v146
    v_and_b32 v17, 0xffff0000, v146
    v_lshlrev_b32 v10, 16, v147
    v_and_b32 v11, 0xffff0000, v147
    v_fma_f32 v12, v12, v45, v44
    v_fma_f32 v13, v13, v45, v44
    v_fma_f32 v14, v14, v45, v44
    v_fma_f32 v15, v15, v45, v44
    v_fma_f32 v16, v16, v45, v44
    v_fma_f32 v17, v17, v45, v44
    v_fma_f32 v10, v10, v45, v44
    v_fma_f32 v11, v11, v45, v44
    v_cvt_pk_bf16_f32 v144, v12, v13
    v_cvt_pk_bf16_f32 v145, v14, v15
    v_cvt_pk_bf16_f32 v146, v16, v17
    v_cvt_pk_bf16_f32 v147, v10, v11
    buffer_store_dwordx4 v[144:147], v1, s[4:7], s11 offen offset:0 sc1
    v_lshlrev_b32 v12, 16, v148
    v_and_b32 v13, 0xffff0000, v148
    v_lshlrev_b32 v14, 16, v149
    v_and_b32 v15, 0xffff0000, v149
    v_lshlrev_b32 v16, 16, v150
    v_and_b32 v17, 0xffff0000, v150
    v_lshlrev_b32 v10, 16, v151
    v_and_b32 v11, 0xffff0000, v151
    v_fma_f32 v12, v12, v45, v44
    v_fma_f32 v13, v13, v45, v44
    v_fma_f32 v14, v14, v45, v44
    v_fma_f32 v15, v15, v45, v44
    v_fma_f32 v16, v16, v45, v44
    v_fma_f32 v17, v17, v45, v44
    v_fma_f32 v10, v10, v45, v44
    v_fma_f32 v11, v11, v45, v44
    v_cvt_pk_bf16_f32 v148, v12, v13
    v_cvt_pk_bf16_f32 v149, v14, v15
    v_cvt_pk_bf16_f32 v150, v16, v17
    v_cvt_pk_bf16_f32 v151, v10, v11
    buffer_store_dwordx4 v[148:151], v1, s[4:7], s11 offen offset:2048 sc1
    s_add_u32 s11, s11, 4096
    v_lshlrev_b32 v12, 16, v152
    v_and_b32 v13, 0xffff0000, v152
    v_lshlrev_b32 v14, 16, v153
    v_and_b32 v15, 0xffff0000, v153
    v_lshlrev_b32 v16, 16, v154
    v_and_b32 v17, 0xffff0000, v154
    v_lshlrev_b32 v10, 16, v155
    v_and_b32 v11, 0xffff0000, v155
    v_fma_f32 v12, v12, v45, v44
    v_fma_f32 v13, v13, v45, v44
    v_fma_f32 v14, v14, v45, v44
    v_fma_f32 v15, v15, v45, v44
    v_fma_f32 v16, v16, v45, v44
    v_fma_f32 v17, v17, v45, v44
    v_fma_f32 v10, v10, v45, v44
    v_fma_f32 v11, v11, v45, v44
    v_cvt_pk_bf16_f32 v152, v12, v13
    v_cvt_pk_bf16_f32 v153, v14, v15
    v_cvt_pk_bf16_f32 v154, v16, v17
    v_cvt_pk_bf16_f32 v155, v10, v11
    buffer_store_dwordx4 v[152:155], v1, s[4:7], s11 offen offset:0 sc1
    v_lshlrev_b32 v12, 16, v156
    v_and_b32 v13, 0xffff0000, v156
    v_lshlrev_b32 v14, 16, v157
    v_and_b32 v15, 0xffff0000, v157
    v_lshlrev_b32 v16, 16, v158
    v_and_b32 v17, 0xffff0000, v158
    v_lshlrev_b32 v10, 16, v159
    v_and_b32 v11, 0xffff0000, v159
    v_fma_f32 v12, v12, v45, v44
    v_fma_f32 v13, v13, v45, v44
    v_fma_f32 v14, v14, v45, v44
    v_fma_f32 v15, v15, v45, v44
    v_fma_f32 v16, v16, v45, v44
    v_fma_f32 v17, v17, v45, v44
    v_fma_f32 v10, v10, v45, v44
    v_fma_f32 v11, v11, v45, v44
    v_cvt_pk_bf16_f32 v156, v12, v13
    v_cvt_pk_bf16_f32 v157, v14, v15
    v_cvt_pk_bf16_f32 v158, v16, v17
    v_cvt_pk_bf16_f32 v159, v10, v11
    buffer_store_dwordx4 v[156:159], v1, s[4:7], s11 offen offset:2048 sc1
    s_add_u32 s11, s11, 4096
    v_lshlrev_b32 v12, 16, v160
    v_and_b32 v13, 0xffff0000, v160
    v_lshlrev_b32 v14, 16, v161
    v_and_b32 v15, 0xffff0000, v161
    v_lshlrev_b32 v16, 16, v162
    v_and_b32 v17, 0xffff0000, v162
    v_lshlrev_b32 v10, 16, v163
    v_and_b32 v11, 0xffff0000, v163
    v_fma_f32 v12, v12, v45, v44
    v_fma_f32 v13, v13, v45, v44
    v_fma_f32 v14, v14, v45, v44
    v_fma_f32 v15, v15, v45, v44
    v_fma_f32 v16, v16, v45, v44
    v_fma_f32 v17, v17, v45, v44
    v_fma_f32 v10, v10, v45, v44
    v_fma_f32 v11, v11, v45, v44
    v_cvt_pk_bf16_f32 v160, v12, v13
    v_cvt_pk_bf16_f32 v161, v14, v15
    v_cvt_pk_bf16_f32 v162, v16, v17
    v_cvt_pk_bf16_f32 v163, v10, v11
    buffer_store_dwordx4 v[160:163], v1, s[4:7], s11 offen offset:0 sc1
    v_lshlrev_b32 v12, 16, v164
    v_and_b32 v13, 0xffff0000, v164
    v_lshlrev_b32 v14, 16, v165
    v_and_b32 v15, 0xffff0000, v165
    v_lshlrev_b32 v16, 16, v166
    v_and_b32 v17, 0xffff0000, v166
    v_lshlrev_b32 v10, 16, v167
    v_and_b32 v11, 0xffff0000, v167
    v_fma_f32 v12, v12, v45, v44
    v_fma_f32 v13, v13, v45, v44
    v_fma_f32 v14, v14, v45, v44
    v_fma_f32 v15, v15, v45, v44
    v_fma_f32 v16, v16, v45, v44
    v_fma_f32 v17, v17, v45, v44
    v_fma_f32 v10, v10, v45, v44
    v_fma_f32 v11, v11, v45, v44
    v_cvt_pk_bf16_f32 v164, v12, v13
    v_cvt_pk_bf16_f32 v165, v14, v15
    v_cvt_pk_bf16_f32 v166, v16, v17
    v_cvt_pk_bf16_f32 v167, v10, v11
    buffer_store_dwordx4 v[164:167], v1, s[4:7], s11 offen offset:2048 sc1
    s_add_u32 s11, s11, 4096
    v_lshlrev_b32 v12, 16, v168
    v_and_b32 v13, 0xffff0000, v168
    v_lshlrev_b32 v14, 16, v169
    v_and_b32 v15, 0xffff0000, v169
    v_lshlrev_b32 v16, 16, v170
    v_and_b32 v17, 0xffff0000, v170
    v_lshlrev_b32 v10, 16, v171
    v_and_b32 v11, 0xffff0000, v171
    v_fma_f32 v12, v12, v45, v44
    v_fma_f32 v13, v13, v45, v44
    v_fma_f32 v14, v14, v45, v44
    v_fma_f32 v15, v15, v45, v44
    v_fma_f32 v16, v16, v45, v44
    v_fma_f32 v17, v17, v45, v44
    v_fma_f32 v10, v10, v45, v44
    v_fma_f32 v11, v11, v45, v44
    v_cvt_pk_bf16_f32 v168, v12, v13
    v_cvt_pk_bf16_f32 v169, v14, v15
    v_cvt_pk_bf16_f32 v170, v16, v17
    v_cvt_pk_bf16_f32 v171, v10, v11
    buffer_store_dwordx4 v[168:171], v1, s[4:7], s11 offen offset:0 sc1
    v_lshlrev_b32 v12, 16, v172
    v_and_b32 v13, 0xffff0000, v172
    v_lshlrev_b32 v14, 16, v173
    v_and_b32 v15, 0xffff0000, v173
    v_lshlrev_b32 v16, 16, v174
    v_and_b32 v17, 0xffff0000, v174
    v_lshlrev_b32 v10, 16, v175
    v_and_b32 v11, 0xffff0000, v175
    v_fma_f32 v12, v12, v45, v44
    v_fma_f32 v13, v13, v45, v44
    v_fma_f32 v14, v14, v45, v44
    v_fma_f32 v15, v15, v45, v44
    v_fma_f32 v16, v16, v45, v44
    v_fma_f32 v17, v17, v45, v44
    v_fma_f32 v10, v10, v45, v44
    v_fma_f32 v11, v11, v45, v44
    v_cvt_pk_bf16_f32 v172, v12, v13
    v_cvt_pk_bf16_f32 v173, v14, v15
    v_cvt_pk_bf16_f32 v174, v16, v17
    v_cvt_pk_bf16_f32 v175, v10, v11
    buffer_store_dwordx4 v[172:175], v1, s[4:7], s11 offen offset:2048 sc1
    s_add_u32 s11, s11, 4096
    v_lshlrev_b32 v12, 16, v176
    v_and_b32 v13, 0xffff0000, v176
    v_lshlrev_b32 v14, 16, v177
    v_and_b32 v15, 0xffff0000, v177
    v_lshlrev_b32 v16, 16, v178
    v_and_b32 v17, 0xffff0000, v178
    v_lshlrev_b32 v10, 16, v179
    v_and_b32 v11, 0xffff0000, v179
    v_fma_f32 v12, v12, v45, v44
    v_fma_f32 v13, v13, v45, v44
    v_fma_f32 v14, v14, v45, v44
    v_fma_f32 v15, v15, v45, v44
    v_fma_f32 v16, v16, v45, v44
    v_fma_f32 v17, v17, v45, v44
    v_fma_f32 v10, v10, v45, v44
    v_fma_f32 v11, v11, v45, v44
    v_cvt_pk_bf16_f32 v176, v12, v13
    v_cvt_pk_bf16_f32 v177, v14, v15
    v_cvt_pk_bf16_f32 v178, v16, v17
    v_cvt_pk_bf16_f32 v179, v10, v11
    buffer_store_dwordx4 v[176:179], v1, s[4:7], s11 offen offset:0 sc1
    v_lshlrev_b32 v12, 16, v180
    v_and_b32 v13, 0xffff0000, v180
    v_lshlrev_b32 v14, 16, v181
    v_and_b32 v15, 0xffff0000, v181
    v_lshlrev_b32 v16, 16, v182
    v_and_b32 v17, 0xffff0000, v182
    v_lshlrev_b32 v10, 16, v183
    v_and_b32 v11, 0xffff0000, v183
    v_fma_f32 v12, v12, v45, v44
    v_fma_f32 v13, v13, v45, v44
    v_fma_f32 v14, v14, v45, v44
    v_fma_f32 v15, v15, v45, v44
    v_fma_f32 v16, v16, v45, v44
    v_fma_f32 v17, v17, v45, v44
    v_fma_f32 v10, v10, v45, v44
    v_fma_f32 v11, v11, v45, v44
    v_cvt_pk_bf16_f32 v180, v12, v13
    v_cvt_pk_bf16_f32 v181, v14, v15
    v_cvt_pk_bf16_f32 v182, v16, v17
    v_cvt_pk_bf16_f32 v183, v10, v11
    buffer_store_dwordx4 v[180:183], v1, s[4:7], s11 offen offset:2048 sc1
    s_add_u32 s11, s11, 4096
    v_lshlrev_b32 v12, 16, v184
    v_and_b32 v13, 0xffff0000, v184
    v_lshlrev_b32 v14, 16, v185
    v_and_b32 v15, 0xffff0000, v185
    v_lshlrev_b32 v16, 16, v186
    v_and_b32 v17, 0xffff0000, v186
    v_lshlrev_b32 v10, 16, v187
    v_and_b32 v11, 0xffff0000, v187
    v_fma_f32 v12, v12, v45, v44
    v_fma_f32 v13, v13, v45, v44
    v_fma_f32 v14, v14, v45, v44
    v_fma_f32 v15, v15, v45, v44
    v_fma_f32 v16, v16, v45, v44
    v_fma_f32 v17, v17, v45, v44
    v_fma_f32 v10, v10, v45, v44
    v_fma_f32 v11, v11, v45, v44
    v_cvt_pk_bf16_f32 v184, v12, v13
    v_cvt_pk_bf16_f32 v185, v14, v15
    v_cvt_pk_bf16_f32 v186, v16, v17
    v_cvt_pk_bf16_f32 v187, v10, v11
    buffer_store_dwordx4 v[184:187], v1, s[4:7], s11 offen offset:0 sc1
    v_lshlrev_b32 v12, 16, v188
    v_and_b32 v13, 0xffff0000, v188
    v_lshlrev_b32 v14, 16, v189
    v_and_b32 v15, 0xffff0000, v189
    v_lshlrev_b32 v16, 16, v190
    v_and_b32 v17, 0xffff0000, v190
    v_lshlrev_b32 v10, 16, v191
    v_and_b32 v11, 0xffff0000, v191
    v_fma_f32 v12, v12, v45, v44
    v_fma_f32 v13, v13, v45, v44
    v_fma_f32 v14, v14, v45, v44
    v_fma_f32 v15, v15, v45, v44
    v_fma_f32 v16, v16, v45, v44
    v_fma_f32 v17, v17, v45, v44
    v_fma_f32 v10, v10, v45, v44
    v_fma_f32 v11, v11, v45, v44
    v_cvt_pk_bf16_f32 v188, v12, v13
    v_cvt_pk_bf16_f32 v189, v14, v15
    v_cvt_pk_bf16_f32 v190, v16, v17
    v_cvt_pk_bf16_f32 v191, v10, v11
    buffer_store_dwordx4 v[188:191], v1, s[4:7], s11 offen offset:2048 sc1
    s_cmp_lg_u32 s95, 0
    s_cbranch_scc1 O_RWB
    s_mov_b32 s94, 0
    v_mbcnt_lo_u32_b32 v118, -1, 0
    v_mbcnt_hi_u32_b32 v118, -1, v118
    v_and_b32 v120, 7, v118
    v_lshrrev_b32 v119, 2, v120
    v_lshlrev_b32 v119, 7, v119
    v_and_b32 v120, 3, v120
    v_lshlrev_b32 v120, 2, v120
    v_add_u32 v120, v120, v119
O_RW:
    global_load_dword v121, v120, s[88:89] sc1
    s_add_u32 s94, s94, 1
    s_cmp_gt_u32 s94, 200000
    s_cbranch_scc1 K_FAIL
    s_waitcnt vmcnt(0)
    s_mov_b32 s93, 0
    v_readlane_b32 s92, v121, 0
    s_nop 0
    s_add_u32 s93, s93, s92
    v_readlane_b32 s92, v121, 1
    s_nop 0
    s_add_u32 s93, s93, s92
    v_readlane_b32 s92, v121, 2
    s_nop 0
    s_add_u32 s93, s93, s92
    v_readlane_b32 s92, v121, 3
    s_nop 0
    s_add_u32 s93, s93, s92
    v_readlane_b32 s92, v121, 4
    s_nop 0
    s_add_u32 s93, s93, s92
    v_readlane_b32 s92, v121, 5
    s_nop 0
    s_add_u32 s93, s93, s92
    v_readlane_b32 s92, v121, 6
    s_nop 0
    s_add_u32 s93, s93, s92
    v_readlane_b32 s92, v121, 7
    s_nop 0
    s_add_u32 s93, s93, s92
    s_cmp_ge_u32 s93, 256
    s_cbranch_scc1 O_RWD
    s_sleep 2
    s_branch O_RW
O_RWD:
    v_cmp_ne_u32 vcc, 32, v121
    s_nop 0
    s_cmp_eq_u64 vcc, 0
    s_cselect_b32 s92, 0, 1
    v_mov_b32 v120, 163836
    v_mov_b32 v121, s92
    ds_write_b32 v120, v121
    s_waitcnt lgkmcnt(0)
O_RWB:
    s_barrier
    v_mov_b32 v120, 163836
    ds_read_b32 v121, v120
    s_waitcnt lgkmcnt(0)
    v_readfirstlane_b32 s92, v121
    s_nop 0
    s_and_b32 s92, s92, 1
    s_barrier
    s_waitcnt vmcnt(0)
    s_mul_i32 s12, s57, 128
    s_add_u32 s12, s12, 114688
    v_mov_b32 v10, 1
    buffer_store_dword v10, off, s[4:7], s12 sc1
    s_mov_b32 s54, 3
    v_lshrrev_b32 v11, 4, v0
    v_and_b32 v12, 7, v11
    v_lshrrev_b32 v13, 1, v12
    v_bfe_u32 v14, v11, 4, 1
    s_and_b32 s11, s9, 1
    s_lshl_b32 s11, s11, 1
    v_or_b32 v14, s11, v14
    v_xor_b32 v13, v13, v14
    v_lshlrev_b32 v13, 1, v13
    v_and_b32 v12, 1, v12
    v_or_b32 v13, v13, v12
    v_lshlrev_b32 v13, 4, v13
    v_lshrrev_b32 v12, 3, v11
    v_mul_u32_u24 v15, 3072, v12
    v_add_u32 v15, v15, v13
    v_mul_u32_u24 v16, 1024, v12
    v_add_u32 v16, v16, v13
    s_load_dwordx2 s[16:17], s[0:1], 8
    s_load_dwordx2 s[64:65], s[0:1], 16
    s_mov_b32 s18, 1572864
    s_mov_b32 s19, 0x20000
    s_mov_b32 s66, 524288
    s_mov_b32 s67, 0x20000
    s_waitcnt lgkmcnt(0)
    s_mul_i32 s11, s91, 49152
    s_mul_i32 s12, s9, 12288
    s_add_u32 s11, s11, s12
    s_lshl_b32 s13, s91, 14
    s_lshl_b32 s12, s9, 12
    s_add_u32 s13, s13, s12
    buffer_load_dwordx4 v[128:131], v0, s[16:19], s11 offen offset:0
    buffer_load_dwordx4 v[132:135], v0, s[16:19], s11 offen offset:1024
    buffer_load_dwordx4 v[136:139], v0, s[16:19], s11 offen offset:2048
    buffer_load_dwordx4 v[140:143], v0, s[16:19], s11 offen offset:3072
    s_add_u32 s11, s11, 4096
    buffer_load_dwordx4 v[144:147], v0, s[16:19], s11 offen offset:0
    buffer_load_dwordx4 v[148:151], v0, s[16:19], s11 offen offset:1024
    buffer_load_dwordx4 v[152:155], v0, s[16:19], s11 offen offset:2048
    buffer_load_dwordx4 v[156:159], v0, s[16:19], s11 offen offset:3072
    s_add_u32 s11, s11, 4096
    buffer_load_dwordx4 v[160:163], v0, s[16:19], s11 offen offset:0
    buffer_load_dwordx4 v[164:167], v0, s[16:19], s11 offen offset:1024
    buffer_load_dwordx4 v[168:171], v0, s[16:19], s11 offen offset:2048
    buffer_load_dwordx4 v[172:175], v0, s[16:19], s11 offen offset:3072
    s_add_u32 s11, s11, 4096
    buffer_load_dwordx4 v[176:179], v0, s[64:67], s13 offen offset:0
    buffer_load_dwordx4 v[180:183], v0, s[64:67], s13 offen offset:1024
    buffer_load_dwordx4 v[184:187], v0, s[64:67], s13 offen offset:2048
    buffer_load_dwordx4 v[188:191], v0, s[64:67], s13 offen offset:3072
    s_mul_i32 s12, s9, 24576
    s_lshl_b32 s13, s55, 7
    s_add_u32 s12, s12, s13
    s_lshl_b32 s11, s9, 10
    s_add_u32 s11, s11, 0
    s_mov_b32 s15, 0
awd_1:
    s_mov_b32 m0, s11
    s_add_u32 s11, s11, 4096
    buffer_load_dwordx4 v15, s[16:19], s12 offen  lds
    s_add_u32 s12, s12, 98304
    s_add_u32 s15, s15, 1
    s_cmp_lt_u32 s15, 16
    s_cbranch_scc1 awd_1
    s_mul_i32 s12, s9, 24576
    s_lshl_b32 s13, s55, 7
    s_add_u32 s12, s12, s13
    s_add_u32 s12, s12, 1024
    s_lshl_b32 s11, s9, 10
    s_add_u32 s11, s11, 65536
    s_mov_b32 s15, 0
awd_2:
    s_mov_b32 m0, s11
    s_add_u32 s11, s11, 4096
    buffer_load_dwordx4 v15, s[16:19], s12 offen  lds
    s_add_u32 s12, s12, 98304
    s_add_u32 s15, s15, 1
    s_cmp_lt_u32 s15, 16
    s_cbranch_scc1 awd_2
    s_waitcnt vmcnt(16)
    s_barrier
    v_add_u32 v17, 0, v5
    ds_read_b64_tr_b16 a[0:1], v17 offset:0
    ds_read_b64_tr_b16 a[2:3], v17 offset:512
    ds_read_b64_tr_b16 a[4:5], v17 offset:4096
    ds_read_b64_tr_b16 a[6:7], v17 offset:4608
    ds_read_b64_tr_b16 a[8:9], v17 offset:8192
    ds_read_b64_tr_b16 a[10:11], v17 offset:8704
    ds_read_b64_tr_b16 a[12:13], v17 offset:12288
    ds_read_b64_tr_b16 a[14:15], v17 offset:12800
    s_waitcnt lgkmcnt(4)
    ds_read_b64_tr_b16 a[16:17], v17 offset:16384
    ds_read_b64_tr_b16 a[18:19], v17 offset:16896
    ds_read_b64_tr_b16 a[20:21], v17 offset:20480
    ds_read_b64_tr_b16 a[22:23], v17 offset:20992
    ds_read_b64_tr_b16 a[24:25], v17 offset:24576
    ds_read_b64_tr_b16 a[26:27], v17 offset:25088
    ds_read_b64_tr_b16 a[28:29], v17 offset:28672
    ds_read_b64_tr_b16 a[30:31], v17 offset:29184
    s_waitcnt lgkmcnt(4)
    ds_read_b64_tr_b16 a[32:33], v17 offset:32768
    ds_read_b64_tr_b16 a[34:35], v17 offset:33280
    ds_read_b64_tr_b16 a[36:37], v17 offset:36864
    ds_read_b64_tr_b16 a[38:39], v17 offset:37376
    ds_read_b64_tr_b16 a[40:41], v17 offset:40960
    ds_read_b64_tr_b16 a[42:43], v17 offset:41472
    ds_read_b64_tr_b16 a[44:45], v17 offset:45056
    ds_read_b64_tr_b16 a[46:47], v17 offset:45568
    s_waitcnt lgkmcnt(4)
    ds_read_b64_tr_b16 a[48:49], v17 offset:49152
    ds_read_b64_tr_b16 a[50:51], v17 offset:49664
    ds_read_b64_tr_b16 a[52:53], v17 offset:53248
    ds_read_b64_tr_b16 a[54:55], v17 offset:53760
    ds_read_b64_tr_b16 a[56:57], v17 offset:57344
    ds_read_b64_tr_b16 a[58:59], v17 offset:57856
    ds_read_b64_tr_b16 a[60:61], v17 offset:61440
    ds_read_b64_tr_b16 a[62:63], v17 offset:61952
    s_waitcnt lgkmcnt(4)
    s_waitcnt lgkmcnt(0)
    s_barrier
    s_mul_i32 s12, s9, 24576
    s_lshl_b32 s13, s55, 7
    s_add_u32 s12, s12, s13
    s_add_u32 s12, s12, 2048
    s_lshl_b32 s11, s9, 10
    s_add_u32 s11, s11, 0
    s_mov_b32 s15, 0
awd_3:
    s_mov_b32 m0, s11
    s_add_u32 s11, s11, 4096
    buffer_load_dwordx4 v15, s[16:19], s12 offen  lds
    s_add_u32 s12, s12, 98304
    s_add_u32 s15, s15, 1
    s_cmp_lt_u32 s15, 16
    s_cbranch_scc1 awd_3
    s_waitcnt vmcnt(16)
    s_barrier
    v_add_u32 v17, 65536, v5
    ds_read_b64_tr_b16 a[64:65], v17 offset:0
    ds_read_b64_tr_b16 a[66:67], v17 offset:512
    ds_read_b64_tr_b16 a[68:69], v17 offset:4096
    ds_read_b64_tr_b16 a[70:71], v17 offset:4608
    ds_read_b64_tr_b16 a[72:73], v17 offset:8192
    ds_read_b64_tr_b16 a[74:75], v17 offset:8704
    ds_read_b64_tr_b16 a[76:77], v17 offset:12288
    ds_read_b64_tr_b16 a[78:79], v17 offset:12800
    s_waitcnt lgkmcnt(4)
    ds_read_b64_tr_b16 a[80:81], v17 offset:16384
    ds_read_b64_tr_b16 a[82:83], v17 offset:16896
    ds_read_b64_tr_b16 a[84:85], v17 offset:20480
    ds_read_b64_tr_b16 a[86:87], v17 offset:20992
    ds_read_b64_tr_b16 a[88:89], v17 offset:24576
    ds_read_b64_tr_b16 a[90:91], v17 offset:25088
    ds_read_b64_tr_b16 a[92:93], v17 offset:28672
    ds_read_b64_tr_b16 a[94:95], v17 offset:29184
    s_waitcnt lgkmcnt(4)
    ds_read_b64_tr_b16 a[96:97], v17 offset:32768
    ds_read_b64_tr_b16 a[98:99], v17 offset:33280
    ds_read_b64_tr_b16 a[100:101], v17 offset:36864
    ds_read_b64_tr_b16 a[102:103], v17 offset:37376
    ds_read_b64_tr_b16 a[104:105], v17 offset:40960
    ds_read_b64_tr_b16 a[106:107], v17 offset:41472
    ds_read_b64_tr_b16 a[108:109], v17 offset:45056
    ds_read_b64_tr_b16 a[110:111], v17 offset:45568
    s_waitcnt lgkmcnt(4)
    ds_read_b64_tr_b16 a[112:113], v17 offset:49152
    ds_read_b64_tr_b16 a[114:115], v17 offset:49664
    ds_read_b64_tr_b16 a[116:117], v17 offset:53248
    ds_read_b64_tr_b16 a[118:119], v17 offset:53760
    ds_read_b64_tr_b16 a[120:121], v17 offset:57344
    ds_read_b64_tr_b16 a[122:123], v17 offset:57856
    ds_read_b64_tr_b16 a[124:125], v17 offset:61440
    ds_read_b64_tr_b16 a[126:127], v17 offset:61952
    s_waitcnt lgkmcnt(4)
    s_waitcnt lgkmcnt(0)
    s_barrier
    s_mul_i32 s12, s9, 8192
    s_lshl_b32 s13, s55, 7
    s_add_u32 s12, s12, s13
    s_lshl_b32 s11, s9, 10
    s_add_u32 s11, s11, 65536
    s_mov_b32 s15, 0
awd_4:
    s_mov_b32 m0, s11
    s_add_u32 s11, s11, 4096
    buffer_load_dwordx4 v16, s[64:67], s12 offen  lds
    s_add_u32 s12, s12, 32768
    s_add_u32 s15, s15, 1
    s_cmp_lt_u32 s15, 16
    s_cbranch_scc1 awd_4
    s_waitcnt vmcnt(16)
    s_barrier
    v_add_u32 v17, 0, v5
    ds_read_b64_tr_b16 a[128:129], v17 offset:0
    ds_read_b64_tr_b16 a[130:131], v17 offset:512
    ds_read_b64_tr_b16 a[132:133], v17 offset:4096
    ds_read_b64_tr_b16 a[134:135], v17 offset:4608
    ds_read_b64_tr_b16 a[136:137], v17 offset:8192
    ds_read_b64_tr_b16 a[138:139], v17 offset:8704
    ds_read_b64_tr_b16 a[140:141], v17 offset:12288
    ds_read_b64_tr_b16 a[142:143], v17 offset:12800
    s_waitcnt lgkmcnt(4)
    ds_read_b64_tr_b16 a[144:145], v17 offset:16384
    ds_read_b64_tr_b16 a[146:147], v17 offset:16896
    ds_read_b64_tr_b16 a[148:149], v17 offset:20480
    ds_read_b64_tr_b16 a[150:151], v17 offset:20992
    ds_read_b64_tr_b16 a[152:153], v17 offset:24576
    ds_read_b64_tr_b16 a[154:155], v17 offset:25088
    ds_read_b64_tr_b16 a[156:157], v17 offset:28672
    ds_read_b64_tr_b16 a[158:159], v17 offset:29184
    s_waitcnt lgkmcnt(4)
    ds_read_b64_tr_b16 a[160:161], v17 offset:32768
    ds_read_b64_tr_b16 a[162:163], v17 offset:33280
    ds_read_b64_tr_b16 a[164:165], v17 offset:36864
    ds_read_b64_tr_b16 a[166:167], v17 offset:37376
    ds_read_b64_tr_b16 a[168:169], v17 offset:40960
    ds_read_b64_tr_b16 a[170:171], v17 offset:41472
    ds_read_b64_tr_b16 a[172:173], v17 offset:45056
    ds_read_b64_tr_b16 a[174:175], v17 offset:45568
    s_waitcnt lgkmcnt(4)
    ds_read_b64_tr_b16 a[176:177], v17 offset:49152
    ds_read_b64_tr_b16 a[178:179], v17 offset:49664
    ds_read_b64_tr_b16 a[180:181], v17 offset:53248
    ds_read_b64_tr_b16 a[182:183], v17 offset:53760
    ds_read_b64_tr_b16 a[184:185], v17 offset:57344
    ds_read_b64_tr_b16 a[186:187], v17 offset:57856
    ds_read_b64_tr_b16 a[188:189], v17 offset:61440
    ds_read_b64_tr_b16 a[190:191], v17 offset:61952
    s_waitcnt lgkmcnt(4)
    s_waitcnt lgkmcnt(0)
    s_barrier
    s_waitcnt vmcnt(0)
    s_barrier
    v_add_u32 v17, 65536, v5
    ds_read_b64_tr_b16 a[192:193], v17 offset:0
    ds_read_b64_tr_b16 a[194:195], v17 offset:512
    ds_read_b64_tr_b16 a[196:197], v17 offset:4096
    ds_read_b64_tr_b16 a[198:199], v17 offset:4608
    ds_read_b64_tr_b16 a[200:201], v17 offset:8192
    ds_read_b64_tr_b16 a[202:203], v17 offset:8704
    ds_read_b64_tr_b16 a[204:205], v17 offset:12288
    ds_read_b64_tr_b16 a[206:207], v17 offset:12800
    s_waitcnt lgkmcnt(4)
    ds_read_b64_tr_b16 a[208:209], v17 offset:16384
    ds_read_b64_tr_b16 a[210:211], v17 offset:16896
    ds_read_b64_tr_b16 a[212:213], v17 offset:20480
    ds_read_b64_tr_b16 a[214:215], v17 offset:20992
    ds_read_b64_tr_b16 a[216:217], v17 offset:24576
    ds_read_b64_tr_b16 a[218:219], v17 offset:25088
    ds_read_b64_tr_b16 a[220:221], v17 offset:28672
    ds_read_b64_tr_b16 a[222:223], v17 offset:29184
    s_waitcnt lgkmcnt(4)
    ds_read_b64_tr_b16 a[224:225], v17 offset:32768
    ds_read_b64_tr_b16 a[226:227], v17 offset:33280
    ds_read_b64_tr_b16 a[228:229], v17 offset:36864
    ds_read_b64_tr_b16 a[230:231], v17 offset:37376
    ds_read_b64_tr_b16 a[232:233], v17 offset:40960
    ds_read_b64_tr_b16 a[234:235], v17 offset:41472
    ds_read_b64_tr_b16 a[236:237], v17 offset:45056
    ds_read_b64_tr_b16 a[238:239], v17 offset:45568
    s_waitcnt lgkmcnt(4)
    ds_read_b64_tr_b16 a[240:241], v17 offset:49152
    ds_read_b64_tr_b16 a[242:243], v17 offset:49664
    ds_read_b64_tr_b16 a[244:245], v17 offset:53248
    ds_read_b64_tr_b16 a[246:247], v17 offset:53760
    ds_read_b64_tr_b16 a[248:249], v17 offset:57344
    ds_read_b64_tr_b16 a[250:251], v17 offset:57856
    ds_read_b64_tr_b16 a[252:253], v17 offset:61440
    ds_read_b64_tr_b16 a[254:255], v17 offset:61952
    s_waitcnt lgkmcnt(4)
    s_waitcnt lgkmcnt(0)
    s_barrier
    s_branch L1_GO
TEAM4:
    s_mov_b32 s36, 0
    s_mov_b32 s10, 0
    s_mov_b32 s8, s91
    s_branch ROLE_H
TEAM5:
    s_mov_b32 s36, 0
    s_mov_b32 s10, 1
    s_mov_b32 s8, s91
    s_branch ROLE_H
TEAM6:
    s_mov_b32 s94, 1
    s_branch PHASE_L1
TEAM7:
    s_mov_b32 s94, 2
    s_branch PHASE_L1
PHASE_L1:
    s_mov_b32 s54, s94
    v_mbcnt_lo_u32_b32 v0, -1, 0
    v_mbcnt_hi_u32_b32 v0, -1, v0
    s_lshl_b32 s93, s95, 6
    v_add_u32 v0, s93, v0
    s_load_dwordx2 s[4:5], s[0:1], 96
    s_load_dwordx2 s[20:21], s[0:1], 80
    s_mov_b32 s9, s95
    s_lshr_b32 s53, s91, 3
    s_and_b32 s55, s91, 7
    s_lshl_b32 s8, s55, 2
    s_add_u32 s8, s8, s9
    s_mov_b32 s6, 268435456
    s_mov_b32 s7, 0x20000
    s_mov_b32 s22, 2097152
    s_mov_b32 s23, 0x20000
    v_and_b32 v11, 63, v0
    v_lshlrev_b32 v0, 4, v11
    v_lshrrev_b32 v12, 4, v11
    v_and_b32 v13, 15, v11
    v_lshlrev_b32 v14, 9, v12
    v_lshlrev_b32 v15, 4, v13
    v_add_u32 v1, v14, v15
    v_lshrrev_b32 v15, 2, v13
    v_lshlrev_b32 v14, 3, v12
    v_add_u32 v14, v14, v15
    v_lshlrev_b32 v14, 7, v14
    v_lshrrev_b32 v15, 1, v15
    v_and_b32 v16, 1, v12
    v_lshlrev_b32 v16, 1, v16
    v_or_b32 v15, v15, v16
    v_xor_b32 v15, s9, v15
    v_lshlrev_b32 v15, 5, v15
    v_add_u32 v14, v14, v15
    v_and_b32 v15, 3, v11
    v_lshlrev_b32 v15, 3, v15
    v_add_u32 v5, v14, v15
    v_and_b32 v14, 7, v11
    v_lshlrev_b32 v2, 2, v14
    v_and_b32 v14, 31, v11
    v_lshrrev_b32 v15, 5, v11
    v_lshlrev_b32 v16, 10, v14
    v_lshlrev_b32 v17, 4, v15
    s_lshl_b32 s11, s8, 5
    v_add3_u32 v3, v16, v17, s11
    v_lshlrev_b32 v17, 4, v14
    s_lshr_b32 s11, s55, 1
    s_lshl_b32 s11, s11, 9
    s_and_b32 s12, s55, 1
    s_lshl_b32 s12, s12, 3
    s_add_u32 s11, s11, s12
    v_add_u32 v4, s11, v17
    v_and_b32 v14, 7, v11
    v_lshlrev_b32 v14, 8, v14
    s_lshr_b32 s11, s8, 4
    s_lshl_b32 s11, s11, 7
    s_bfe_u32 s12, s8, 0x20002
    s_lshl_b32 s12, s12, 2
    s_add_u32 s11, s11, s12
    v_add_u32 v7, s11, v14
    s_mov_b32 s24, -1
    s_mov_b32 s25, 0
    v_mov_b32 v18, -1
    v_mov_b32 v19, -1
    s_waitcnt lgkmcnt(0)
    v_lshrrev_b32 v11, 4, v0
    v_and_b32 v12, 7, v11
    v_lshrrev_b32 v13, 1, v12
    v_bfe_u32 v14, v11, 4, 1
    s_and_b32 s11, s9, 1
    s_lshl_b32 s11, s11, 1
    v_or_b32 v14, s11, v14
    v_xor_b32 v13, v13, v14
    v_lshlrev_b32 v13, 1, v13
    v_and_b32 v12, 1, v12
    v_or_b32 v13, v13, v12
    v_lshlrev_b32 v13, 4, v13
    v_lshrrev_b32 v12, 3, v11
    v_mul_u32_u24 v15, 3072, v12
    v_add_u32 v15, v15, v13
    v_mul_u32_u24 v16, 1024, v12
    v_add_u32 v16, v16, v13
    s_load_dwordx2 s[16:17], s[0:1], 8
    s_load_dwordx2 s[64:65], s[0:1], 16
    s_mov_b32 s18, 1572864
    s_mov_b32 s19, 0x20000
    s_mov_b32 s66, 524288
    s_mov_b32 s67, 0x20000
    s_waitcnt lgkmcnt(0)
    s_mul_i32 s11, s91, 49152
    s_mul_i32 s12, s9, 12288
    s_add_u32 s11, s11, s12
    s_lshl_b32 s13, s91, 14
    s_lshl_b32 s12, s9, 12
    s_add_u32 s13, s13, s12
    buffer_load_dwordx4 v[128:131], v0, s[16:19], s11 offen offset:0
    buffer_load_dwordx4 v[132:135], v0, s[16:19], s11 offen offset:1024
    buffer_load_dwordx4 v[136:139], v0, s[16:19], s11 offen offset:2048
    buffer_load_dwordx4 v[140:143], v0, s[16:19], s11 offen offset:3072
    s_add_u32 s11, s11, 4096
    buffer_load_dwordx4 v[144:147], v0, s[16:19], s11 offen offset:0
    buffer_load_dwordx4 v[148:151], v0, s[16:19], s11 offen offset:1024
    buffer_load_dwordx4 v[152:155], v0, s[16:19], s11 offen offset:2048
    buffer_load_dwordx4 v[156:159], v0, s[16:19], s11 offen offset:3072
    s_add_u32 s11, s11, 4096
    buffer_load_dwordx4 v[160:163], v0, s[16:19], s11 offen offset:0
    buffer_load_dwordx4 v[164:167], v0, s[16:19], s11 offen offset:1024
    buffer_load_dwordx4 v[168:171], v0, s[16:19], s11 offen offset:2048
    buffer_load_dwordx4 v[172:175], v0, s[16:19], s11 offen offset:3072
    s_add_u32 s11, s11, 4096
    buffer_load_dwordx4 v[176:179], v0, s[64:67], s13 offen offset:0
    buffer_load_dwordx4 v[180:183], v0, s[64:67], s13 offen offset:1024
    buffer_load_dwordx4 v[184:187], v0, s[64:67], s13 offen offset:2048
    buffer_load_dwordx4 v[188:191], v0, s[64:67], s13 offen offset:3072
    s_mul_i32 s12, s9, 24576
    s_lshl_b32 s13, s55, 7
    s_add_u32 s12, s12, s13
    s_lshl_b32 s11, s9, 10
    s_add_u32 s11, s11, 0
    s_mov_b32 s15, 0
awd_5:
    s_mov_b32 m0, s11
    s_add_u32 s11, s11, 4096
    buffer_load_dwordx4 v15, s[16:19], s12 offen  lds
    s_add_u32 s12, s12, 98304
    s_add_u32 s15, s15, 1
    s_cmp_lt_u32 s15, 16
    s_cbranch_scc1 awd_5
    s_mul_i32 s12, s9, 24576
    s_lshl_b32 s13, s55, 7
    s_add_u32 s12, s12, s13
    s_add_u32 s12, s12, 1024
    s_lshl_b32 s11, s9, 10
    s_add_u32 s11, s11, 65536
    s_mov_b32 s15, 0
awd_6:
    s_mov_b32 m0, s11
    s_add_u32 s11, s11, 4096
    buffer_load_dwordx4 v15, s[16:19], s12 offen  lds
    s_add_u32 s12, s12, 98304
    s_add_u32 s15, s15, 1
    s_cmp_lt_u32 s15, 16
    s_cbranch_scc1 awd_6
    s_waitcnt vmcnt(16)
    s_barrier
    v_add_u32 v17, 0, v5
    ds_read_b64_tr_b16 a[0:1], v17 offset:0
    ds_read_b64_tr_b16 a[2:3], v17 offset:512
    ds_read_b64_tr_b16 a[4:5], v17 offset:4096
    ds_read_b64_tr_b16 a[6:7], v17 offset:4608
    ds_read_b64_tr_b16 a[8:9], v17 offset:8192
    ds_read_b64_tr_b16 a[10:11], v17 offset:8704
    ds_read_b64_tr_b16 a[12:13], v17 offset:12288
    ds_read_b64_tr_b16 a[14:15], v17 offset:12800
    s_waitcnt lgkmcnt(4)
    ds_read_b64_tr_b16 a[16:17], v17 offset:16384
    ds_read_b64_tr_b16 a[18:19], v17 offset:16896
    ds_read_b64_tr_b16 a[20:21], v17 offset:20480
    ds_read_b64_tr_b16 a[22:23], v17 offset:20992
    ds_read_b64_tr_b16 a[24:25], v17 offset:24576
    ds_read_b64_tr_b16 a[26:27], v17 offset:25088
    ds_read_b64_tr_b16 a[28:29], v17 offset:28672
    ds_read_b64_tr_b16 a[30:31], v17 offset:29184
    s_waitcnt lgkmcnt(4)
    ds_read_b64_tr_b16 a[32:33], v17 offset:32768
    ds_read_b64_tr_b16 a[34:35], v17 offset:33280
    ds_read_b64_tr_b16 a[36:37], v17 offset:36864
    ds_read_b64_tr_b16 a[38:39], v17 offset:37376
    ds_read_b64_tr_b16 a[40:41], v17 offset:40960
    ds_read_b64_tr_b16 a[42:43], v17 offset:41472
    ds_read_b64_tr_b16 a[44:45], v17 offset:45056
    ds_read_b64_tr_b16 a[46:47], v17 offset:45568
    s_waitcnt lgkmcnt(4)
    ds_read_b64_tr_b16 a[48:49], v17 offset:49152
    ds_read_b64_tr_b16 a[50:51], v17 offset:49664
    ds_read_b64_tr_b16 a[52:53], v17 offset:53248
    ds_read_b64_tr_b16 a[54:55], v17 offset:53760
    ds_read_b64_tr_b16 a[56:57], v17 offset:57344
    ds_read_b64_tr_b16 a[58:59], v17 offset:57856
    ds_read_b64_tr_b16 a[60:61], v17 offset:61440
    ds_read_b64_tr_b16 a[62:63], v17 offset:61952
    s_waitcnt lgkmcnt(4)
    s_waitcnt lgkmcnt(0)
    s_barrier
    s_mul_i32 s12, s9, 24576
    s_lshl_b32 s13, s55, 7
    s_add_u32 s12, s12, s13
    s_add_u32 s12, s12, 2048
    s_lshl_b32 s11, s9, 10
    s_add_u32 s11, s11, 0
    s_mov_b32 s15, 0
awd_7:
    s_mov_b32 m0, s11
    s_add_u32 s11, s11, 4096
    buffer_load_dwordx4 v15, s[16:19], s12 offen  lds
    s_add_u32 s12, s12, 98304
    s_add_u32 s15, s15, 1
    s_cmp_lt_u32 s15, 16
    s_cbranch_scc1 awd_7
    s_waitcnt vmcnt(16)
    s_barrier
    v_add_u32 v17, 65536, v5
    ds_read_b64_tr_b16 a[64:65], v17 offset:0
    ds_read_b64_tr_b16 a[66:67], v17 offset:512
    ds_read_b64_tr_b16 a[68:69], v17 offset:4096
    ds_read_b64_tr_b16 a[70:71], v17 offset:4608
    ds_read_b64_tr_b16 a[72:73], v17 offset:8192
    ds_read_b64_tr_b16 a[74:75], v17 offset:8704
    ds_read_b64_tr_b16 a[76:77], v17 offset:12288
    ds_read_b64_tr_b16 a[78:79], v17 offset:12800
    s_waitcnt lgkmcnt(4)
    ds_read_b64_tr_b16 a[80:81], v17 offset:16384
    ds_read_b64_tr_b16 a[82:83], v17 offset:16896
    ds_read_b64_tr_b16 a[84:85], v17 offset:20480
    ds_read_b64_tr_b16 a[86:87], v17 offset:20992
    ds_read_b64_tr_b16 a[88:89], v17 offset:24576
    ds_read_b64_tr_b16 a[90:91], v17 offset:25088
    ds_read_b64_tr_b16 a[92:93], v17 offset:28672
    ds_read_b64_tr_b16 a[94:95], v17 offset:29184
    s_waitcnt lgkmcnt(4)
    ds_read_b64_tr_b16 a[96:97], v17 offset:32768
    ds_read_b64_tr_b16 a[98:99], v17 offset:33280
    ds_read_b64_tr_b16 a[100:101], v17 offset:36864
    ds_read_b64_tr_b16 a[102:103], v17 offset:37376
    ds_read_b64_tr_b16 a[104:105], v17 offset:40960
    ds_read_b64_tr_b16 a[106:107], v17 offset:41472
    ds_read_b64_tr_b16 a[108:109], v17 offset:45056
    ds_read_b64_tr_b16 a[110:111], v17 offset:45568
    s_waitcnt lgkmcnt(4)
    ds_read_b64_tr_b16 a[112:113], v17 offset:49152
    ds_read_b64_tr_b16 a[114:115], v17 offset:49664
    ds_read_b64_tr_b16 a[116:117], v17 offset:53248
    ds_read_b64_tr_b16 a[118:119], v17 offset:53760
    ds_read_b64_tr_b16 a[120:121], v17 offset:57344
    ds_read_b64_tr_b16 a[122:123], v17 offset:57856
    ds_read_b64_tr_b16 a[124:125], v17 offset:61440
    ds_read_b64_tr_b16 a[126:127], v17 offset:61952
    s_waitcnt lgkmcnt(4)
    s_waitcnt lgkmcnt(0)
    s_barrier
    s_mul_i32 s12, s9, 8192
    s_lshl_b32 s13, s55, 7
    s_add_u32 s12, s12, s13
    s_lshl_b32 s11, s9, 10
    s_add_u32 s11, s11, 65536
    s_mov_b32 s15, 0
awd_8:
    s_mov_b32 m0, s11
    s_add_u32 s11, s11, 4096
    buffer_load_dwordx4 v16, s[64:67], s12 offen  lds
    s_add_u32 s12, s12, 32768
    s_add_u32 s15, s15, 1
    s_cmp_lt_u32 s15, 16
    s_cbranch_scc1 awd_8
    s_waitcnt vmcnt(16)
    s_barrier
    v_add_u32 v17, 0, v5
    ds_read_b64_tr_b16 a[128:129], v17 offset:0
    ds_read_b64_tr_b16 a[130:131], v17 offset:512
    ds_read_b64_tr_b16 a[132:133], v17 offset:4096
    ds_read_b64_tr_b16 a[134:135], v17 offset:4608
    ds_read_b64_tr_b16 a[136:137], v17 offset:8192
    ds_read_b64_tr_b16 a[138:139], v17 offset:8704
    ds_read_b64_tr_b16 a[140:141], v17 offset:12288
    ds_read_b64_tr_b16 a[142:143], v17 offset:12800
    s_waitcnt lgkmcnt(4)
    ds_read_b64_tr_b16 a[144:145], v17 offset:16384
    ds_read_b64_tr_b16 a[146:147], v17 offset:16896
    ds_read_b64_tr_b16 a[148:149], v17 offset:20480
    ds_read_b64_tr_b16 a[150:151], v17 offset:20992
    ds_read_b64_tr_b16 a[152:153], v17 offset:24576
    ds_read_b64_tr_b16 a[154:155], v17 offset:25088
    ds_read_b64_tr_b16 a[156:157], v17 offset:28672
    ds_read_b64_tr_b16 a[158:159], v17 offset:29184
    s_waitcnt lgkmcnt(4)
    ds_read_b64_tr_b16 a[160:161], v17 offset:32768
    ds_read_b64_tr_b16 a[162:163], v17 offset:33280
    ds_read_b64_tr_b16 a[164:165], v17 offset:36864
    ds_read_b64_tr_b16 a[166:167], v17 offset:37376
    ds_read_b64_tr_b16 a[168:169], v17 offset:40960
    ds_read_b64_tr_b16 a[170:171], v17 offset:41472
    ds_read_b64_tr_b16 a[172:173], v17 offset:45056
    ds_read_b64_tr_b16 a[174:175], v17 offset:45568
    s_waitcnt lgkmcnt(4)
    ds_read_b64_tr_b16 a[176:177], v17 offset:49152
    ds_read_b64_tr_b16 a[178:179], v17 offset:49664
    ds_read_b64_tr_b16 a[180:181], v17 offset:53248
    ds_read_b64_tr_b16 a[182:183], v17 offset:53760
    ds_read_b64_tr_b16 a[184:185], v17 offset:57344
    ds_read_b64_tr_b16 a[186:187], v17 offset:57856
    ds_read_b64_tr_b16 a[188:189], v17 offset:61440
    ds_read_b64_tr_b16 a[190:191], v17 offset:61952
    s_waitcnt lgkmcnt(4)
    s_waitcnt lgkmcnt(0)
    s_barrier
    s_waitcnt vmcnt(0)
    s_barrier
    v_add_u32 v17, 65536, v5
    ds_read_b64_tr_b16 a[192:193], v17 offset:0
    ds_read_b64_tr_b16 a[194:195], v17 offset:512
    ds_read_b64_tr_b16 a[196:197], v17 offset:4096
    ds_read_b64_tr_b16 a[198:199], v17 offset:4608
    ds_read_b64_tr_b16 a[200:201], v17 offset:8192
    ds_read_b64_tr_b16 a[202:203], v17 offset:8704
    ds_read_b64_tr_b16 a[204:205], v17 offset:12288
    ds_read_b64_tr_b16 a[206:207], v17 offset:12800
    s_waitcnt lgkmcnt(4)
    ds_read_b64_tr_b16 a[208:209], v17 offset:16384
    ds_read_b64_tr_b16 a[210:211], v17 offset:16896
    ds_read_b64_tr_b16 a[212:213], v17 offset:20480
    ds_read_b64_tr_b16 a[214:215], v17 offset:20992
    ds_read_b64_tr_b16 a[216:217], v17 offset:24576
    ds_read_b64_tr_b16 a[218:219], v17 offset:25088
    ds_read_b64_tr_b16 a[220:221], v17 offset:28672
    ds_read_b64_tr_b16 a[222:223], v17 offset:29184
    s_waitcnt lgkmcnt(4)
    ds_read_b64_tr_b16 a[224:225], v17 offset:32768
    ds_read_b64_tr_b16 a[226:227], v17 offset:33280
    ds_read_b64_tr_b16 a[228:229], v17 offset:36864
    ds_read_b64_tr_b16 a[230:231], v17 offset:37376
    ds_read_b64_tr_b16 a[232:233], v17 offset:40960
    ds_read_b64_tr_b16 a[234:235], v17 offset:41472
    ds_read_b64_tr_b16 a[236:237], v17 offset:45056
    ds_read_b64_tr_b16 a[238:239], v17 offset:45568
    s_waitcnt lgkmcnt(4)
    ds_read_b64_tr_b16 a[240:241], v17 offset:49152
    ds_read_b64_tr_b16 a[242:243], v17 offset:49664
    ds_read_b64_tr_b16 a[244:245], v17 offset:53248
    ds_read_b64_tr_b16 a[246:247], v17 offset:53760
    ds_read_b64_tr_b16 a[248:249], v17 offset:57344
    ds_read_b64_tr_b16 a[250:251], v17 offset:57856
    ds_read_b64_tr_b16 a[252:253], v17 offset:61440
    ds_read_b64_tr_b16 a[254:255], v17 offset:61952
    s_waitcnt lgkmcnt(4)
    s_waitcnt lgkmcnt(0)
    s_barrier
    s_cmp_lg_u32 s95, 0
    s_cbranch_scc1 A_RWB
    s_mov_b32 s94, 0
    v_mbcnt_lo_u32_b32 v118, -1, 0
    v_mbcnt_hi_u32_b32 v118, -1, v118
    v_and_b32 v120, 7, v118
    v_lshrrev_b32 v119, 2, v120
    v_lshlrev_b32 v119, 7, v119
    v_and_b32 v120, 3, v120
    v_lshlrev_b32 v120, 2, v120
    v_add_u32 v120, v120, v119
A_RW:
    global_load_dword v121, v120, s[88:89] sc1
    s_add_u32 s94, s94, 1
    s_cmp_gt_u32 s94, 200000
    s_cbranch_scc1 K_FAIL
    s_waitcnt vmcnt(0)
    s_mov_b32 s93, 0
    v_readlane_b32 s92, v121, 0
    s_nop 0
    s_add_u32 s93, s93, s92
    v_readlane_b32 s92, v121, 1
    s_nop 0
    s_add_u32 s93, s93, s92
    v_readlane_b32 s92, v121, 2
    s_nop 0
    s_add_u32 s93, s93, s92
    v_readlane_b32 s92, v121, 3
    s_nop 0
    s_add_u32 s93, s93, s92
    v_readlane_b32 s92, v121, 4
    s_nop 0
    s_add_u32 s93, s93, s92
    v_readlane_b32 s92, v121, 5
    s_nop 0
    s_add_u32 s93, s93, s92
    v_readlane_b32 s92, v121, 6
    s_nop 0
    s_add_u32 s93, s93, s92
    v_readlane_b32 s92, v121, 7
    s_nop 0
    s_add_u32 s93, s93, s92
    s_cmp_ge_u32 s93, 256
    s_cbranch_scc1 A_RWD
    s_sleep 2
    s_branch A_RW
A_RWD:
    v_cmp_ne_u32 vcc, 32, v121
    s_nop 0
    s_cmp_eq_u64 vcc, 0
    s_cselect_b32 s92, 0, 1
    v_mov_b32 v120, 163836
    v_mov_b32 v121, s92
    ds_write_b32 v120, v121
    s_waitcnt lgkmcnt(0)
A_RWB:
    s_barrier
    v_mov_b32 v120, 163836
    ds_read_b32 v121, v120
    s_waitcnt lgkmcnt(0)
    v_readfirstlane_b32 s92, v121
    s_nop 0
    s_and_b32 s92, s92, 1
    s_barrier
L1_GO:
    s_cmp_eq_u32 s92, 0
    s_cbranch_scc0 L1_SAFE
    v_lshrrev_b32 v11, 4, v0
    v_and_b32 v12, 15, v11
    v_lshrrev_b32 v13, 4, v11
    v_lshlrev_b32 v13, 2, v13
    v_add_u32 v14, 0, v13
    v_sub_u32 v15, v12, v14
    v_and_b32 v16, 0xfffffff1, v15
    v_cmp_eq_u32 s[36:37], 0, v16
    v_add_u32 v15, 16, v15
    v_and_b32 v16, 0xfffffff1, v15
    v_cmp_eq_u32 s[28:29], 0, v16
    v_add_u32 v14, 1, v13
    v_sub_u32 v15, v12, v14
    v_and_b32 v16, 0xfffffff1, v15
    v_cmp_eq_u32 s[38:39], 0, v16
    v_add_u32 v15, 16, v15
    v_and_b32 v16, 0xfffffff1, v15
    v_cmp_eq_u32 s[30:31], 0, v16
    v_add_u32 v14, 2, v13
    v_sub_u32 v15, v12, v14
    v_and_b32 v16, 0xfffffff1, v15
    v_cmp_eq_u32 s[40:41], 0, v16
    v_add_u32 v15, 16, v15
    v_and_b32 v16, 0xfffffff1, v15
    v_cmp_eq_u32 s[32:33], 0, v16
    v_add_u32 v14, 3, v13
    v_sub_u32 v15, v12, v14
    v_and_b32 v16, 0xfffffff1, v15
    v_cmp_eq_u32 s[42:43], 0, v16
    v_add_u32 v15, 16, v15
    v_and_b32 v16, 0xfffffff1, v15
    v_cmp_eq_u32 s[34:35], 0, v16
    s_mov_b32 s26, 0x3eb8aa3b
    s_mov_b32 s27, 0xbeb8aa3b
    s_load_dwordx2 s[16:17], s[0:1], 0
    s_mov_b32 s18, 2097152
    s_mov_b32 s19, 0x20000
    s_waitcnt lgkmcnt(0)
    s_mov_b32 s10, 0
    s_mov_b32 s70, 4
    s_cmp_eq_u32 s54, 1
    s_cselect_b32 s10, 16, s10
    s_cselect_b32 s70, 4, s70
    s_cmp_eq_u32 s54, 2
    s_cselect_b32 s10, 32, s10
    s_cselect_b32 s70, 4, s70
    s_cmp_eq_u32 s54, 3
    s_cselect_b32 s10, 48, s10
    s_cselect_b32 s70, 2, s70
    s_cmp_eq_u32 s54, 4
    s_cselect_b32 s10, 56, s10
    s_cselect_b32 s70, 2, s70
    s_add_u32 s10, s10, s53
    s_mov_b32 s56, 0
    s_lshl_b32 s63, s54, 2
    s_add_u32 s63, s63, s53
    s_lshl_b32 s60, s63, 3
    s_add_u32 s60, s60, s55
    s_lshl_b32 s60, s60, 7
    s_add_u32 s60, s60, 65536
    v_lshrrev_b32 v15, 4, v0
    v_and_b32 v16, 3, v15
    v_min_u32 v16, 2, v16
    v_bfe_u32 v15, v15, 2, 3
    s_sub_u32 s11, s70, 1
    v_min_u32 v15, s11, v15
    v_lshlrev_b32 v15, 3, v15
    v_add_u32 v16, v16, v15
    s_lshl_b32 s11, s10, 1
    v_add_u32 v16, s11, v16
    v_max_u32 v16, 1, v16
    v_subrev_u32 v16, 1, v16
    v_lshlrev_b32 v16, 7, v16
    s_mov_b32 s59, 114688
    s_mov_b32 s57, 0
    s_mov_b32 s15, 0
aw_9:
    buffer_load_dword v10, v16, s[4:7], s59 offen sc1
    s_add_u32 s15, s15, 1
    s_cmp_gt_u32 s15, 200000
    s_cbranch_scc1 K_FAIL
    s_waitcnt vmcnt(0)
    v_cmp_ge_u32 vcc, s57, v10
    s_cbranch_vccz awok_10
    s_sleep 1
    s_branch aw_9
awok_10:
    s_mov_b32 s68, 0
    s_mov_b32 s69, 65536
    s_lshl_b32 s61, s10, 15
    s_add_u32 s61, s61, 8388608
    s_lshl_b32 s11, s9, 13
    s_add_u32 s12, s61, s11
    s_add_u32 s11, s11, s68
    s_mov_b32 m0, s11
    s_nop 0
    buffer_load_dwordx4 v0, s[4:7], s12 offen offset:0 sc1 lds
    buffer_load_dwordx4 v0, s[4:7], s12 offen offset:1024 sc1 lds
    buffer_load_dwordx4 v0, s[4:7], s12 offen offset:2048 sc1 lds
    buffer_load_dwordx4 v0, s[4:7], s12 offen offset:3072 sc1 lds
    s_add_u32 s11, s11, 4096
    s_add_u32 s12, s12, 4096
    s_mov_b32 m0, s11
    s_nop 0
    buffer_load_dwordx4 v0, s[4:7], s12 offen offset:0 sc1 lds
    buffer_load_dwordx4 v0, s[4:7], s12 offen offset:1024 sc1 lds
    buffer_load_dwordx4 v0, s[4:7], s12 offen offset:2048 sc1 lds
    buffer_load_dwordx4 v0, s[4:7], s12 offen offset:3072 sc1 lds
    s_cmp_eq_u32 s10, 0
    s_cselect_b32 s11, 0, 32768
    s_sub_u32 s61, s61, s11
    s_lshl_b32 s11, s9, 13
    s_add_u32 s12, s61, s11
    s_add_u32 s12, s12, 256
    s_lshl_b32 s11, s9, 12
    s_add_u32 s11, s11, s69
    s_mov_b32 m0, s11
    s_nop 0
    buffer_load_dwordx4 v1, s[4:7], s12 offen sc1 lds
    s_add_u32 s11, s11, 1024
    s_add_u32 s12, s12, 2048
    s_mov_b32 m0, s11
    s_nop 0
    buffer_load_dwordx4 v1, s[4:7], s12 offen sc1 lds
    s_add_u32 s11, s11, 1024
    s_add_u32 s12, s12, 2048
    s_mov_b32 m0, s11
    s_nop 0
    buffer_load_dwordx4 v1, s[4:7], s12 offen sc1 lds
    s_add_u32 s11, s11, 1024
    s_add_u32 s12, s12, 2048
    s_mov_b32 m0, s11
    s_nop 0
    buffer_load_dwordx4 v1, s[4:7], s12 offen sc1 lds
L1F_SEG:
    s_waitcnt vmcnt(0)
    s_barrier
    s_cmp_eq_u32 s56, 0
    s_cbranch_scc1 dp_11
    s_cmp_lg_u32 s9, 0
    s_cbranch_scc1 dp_11
    s_sub_u32 s11, s10, 3
    v_mov_b32 v10, s11
    buffer_store_dword v10, off, s[4:7], s60 sc1
dp_11:
    s_cmp_eq_u32 s10, 0
    s_cbranch_scc1 nh_12
    v_add_u32 v8, s69, v0
    ds_read_b128 v[128:131], v8 offset:0
    ds_read_b128 v[132:135], v8 offset:1024
    ds_read_b128 v[136:139], v8 offset:2048
    ds_read_b128 v[140:143], v8 offset:3072
    s_waitcnt lgkmcnt(3)
    v_mfma_f32_16x16x32_bf16 v[32:35], a[64:67], v[128:131], 0
    ds_read_b128 v[144:147], v8 offset:4096
    v_mfma_f32_16x16x32_bf16 v[40:43], v[128:131], a[128:131], 0
    s_waitcnt lgkmcnt(3)
    v_mfma_f32_16x16x32_bf16 v[32:35], a[68:71], v[132:135], v[32:35]
    ds_read_b128 v[148:151], v8 offset:5120
    v_mfma_f32_16x16x32_bf16 v[40:43], v[132:135], a[132:135], v[40:43]
    s_waitcnt lgkmcnt(3)
    v_mfma_f32_16x16x32_bf16 v[32:35], a[72:75], v[136:139], v[32:35]
    ds_read_b128 v[128:131], v8 offset:6144
    v_mfma_f32_16x16x32_bf16 v[40:43], v[136:139], a[136:139], v[40:43]
    s_waitcnt lgkmcnt(3)
    v_mfma_f32_16x16x32_bf16 v[32:35], a[76:79], v[140:143], v[32:35]
    ds_read_b128 v[132:135], v8 offset:7168
    v_mfma_f32_16x16x32_bf16 v[40:43], v[140:143], a[140:143], v[40:43]
    s_waitcnt lgkmcnt(3)
    v_mfma_f32_16x16x32_bf16 v[32:35], a[80:83], v[144:147], v[32:35]
    ds_read_b128 v[136:139], v8 offset:8192
    v_mfma_f32_16x16x32_bf16 v[40:43], v[144:147], a[144:147], v[40:43]
    s_waitcnt lgkmcnt(3)
    v_mfma_f32_16x16x32_bf16 v[32:35], a[84:87], v[148:151], v[32:35]
    ds_read_b128 v[140:143], v8 offset:9216
    v_mfma_f32_16x16x32_bf16 v[40:43], v[148:151], a[148:151], v[40:43]
    s_waitcnt lgkmcnt(3)
    v_mfma_f32_16x16x32_bf16 v[32:35], a[88:91], v[128:131], v[32:35]
    ds_read_b128 v[144:147], v8 offset:10240
    v_mfma_f32_16x16x32_bf16 v[40:43], v[128:131], a[152:155], v[40:43]
    s_waitcnt lgkmcnt(3)
    v_mfma_f32_16x16x32_bf16 v[32:35], a[92:95], v[132:135], v[32:35]
    ds_read_b128 v[148:151], v8 offset:11264
    v_mfma_f32_16x16x32_bf16 v[40:43], v[132:135], a[156:159], v[40:43]
    s_waitcnt lgkmcnt(3)
    v_mfma_f32_16x16x32_bf16 v[32:35], a[96:99], v[136:139], v[32:35]
    ds_read_b128 v[128:131], v8 offset:12288
    v_mfma_f32_16x16x32_bf16 v[40:43], v[136:139], a[160:163], v[40:43]
    s_waitcnt lgkmcnt(3)
    v_mfma_f32_16x16x32_bf16 v[32:35], a[100:103], v[140:143], v[32:35]
    ds_read_b128 v[132:135], v8 offset:13312
    v_mfma_f32_16x16x32_bf16 v[40:43], v[140:143], a[164:167], v[40:43]
    s_waitcnt lgkmcnt(3)
    v_mfma_f32_16x16x32_bf16 v[32:35], a[104:107], v[144:147], v[32:35]
    ds_read_b128 v[136:139], v8 offset:14336
    v_mfma_f32_16x16x32_bf16 v[40:43], v[144:147], a[168:171], v[40:43]
    s_waitcnt lgkmcnt(3)
    v_mfma_f32_16x16x32_bf16 v[32:35], a[108:111], v[148:151], v[32:35]
    ds_read_b128 v[140:143], v8 offset:15360
    v_mfma_f32_16x16x32_bf16 v[40:43], v[148:151], a[172:175], v[40:43]
    s_waitcnt lgkmcnt(3)
    v_mfma_f32_16x16x32_bf16 v[32:35], a[112:115], v[128:131], v[32:35]
    v_mfma_f32_16x16x32_bf16 v[40:43], v[128:131], a[176:179], v[40:43]
    s_waitcnt lgkmcnt(2)
    v_mfma_f32_16x16x32_bf16 v[32:35], a[116:119], v[132:135], v[32:35]
    v_mfma_f32_16x16x32_bf16 v[40:43], v[132:135], a[180:183], v[40:43]
    s_waitcnt lgkmcnt(1)
    v_mfma_f32_16x16x32_bf16 v[32:35], a[120:123], v[136:139], v[32:35]
    v_mfma_f32_16x16x32_bf16 v[40:43], v[136:139], a[184:187], v[40:43]
    s_waitcnt lgkmcnt(0)
    v_mfma_f32_16x16x32_bf16 v[32:35], a[124:127], v[140:143], v[32:35]
    v_mfma_f32_16x16x32_bf16 v[40:43], v[140:143], a[188:191], v[40:43]
    s_nop 6
    v_cvt_pk_bf16_f32 v48, v32, v33
    v_cvt_pk_bf16_f32 v49, v34, v35
    v_cvt_pk_bf16_f32 v54, v40, v41
    v_cvt_pk_bf16_f32 v55, v42, v43
    s_branch nh_13
nh_12:
    v_mov_b32 v48, 0
    v_mov_b32 v49, 0
    v_mov_b32 v54, 0
    v_mov_b32 v55, 0
nh_13:
    v_add_u32 v8, s68, v1
    ds_read_b128 v[128:131], v8 offset:0
    ds_read_b128 v[132:135], v8 offset:256
    ds_read_b128 v[136:139], v8 offset:2048
    ds_read_b128 v[140:143], v8 offset:2304
    ds_read_b128 v[144:147], v8 offset:4096
    ds_read_b128 v[148:151], v8 offset:4352
    s_waitcnt lgkmcnt(4)
    v_mfma_f32_16x16x32_bf16 v[20:23], a[0:3], v[128:131], 0
    v_mfma_f32_16x16x32_bf16 v[28:31], a[64:67], v[128:131], 0
    v_mfma_f32_16x16x32_bf16 v[36:39], v[128:131], a[128:131], 0
    v_mfma_f32_16x16x32_bf16 v[24:27], a[0:3], v[132:135], 0
    v_mfma_f32_16x16x32_bf16 v[32:35], a[64:67], v[132:135], 0
    v_mfma_f32_16x16x32_bf16 v[40:43], v[132:135], a[128:131], 0
    ds_read_b128 v[128:131], v8 offset:6144
    ds_read_b128 v[132:135], v8 offset:6400
    s_waitcnt lgkmcnt(4)
    v_mfma_f32_16x16x32_bf16 v[20:23], a[4:7], v[136:139], v[20:23]
    v_mfma_f32_16x16x32_bf16 v[28:31], a[68:71], v[136:139], v[28:31]
    v_mfma_f32_16x16x32_bf16 v[36:39], v[136:139], a[132:135], v[36:39]
    v_mfma_f32_16x16x32_bf16 v[24:27], a[4:7], v[140:143], v[24:27]
    v_mfma_f32_16x16x32_bf16 v[32:35], a[68:71], v[140:143], v[32:35]
    v_mfma_f32_16x16x32_bf16 v[40:43], v[140:143], a[132:135], v[40:43]
    ds_read_b128 v[136:139], v8 offset:8192
    ds_read_b128 v[140:143], v8 offset:8448
    s_waitcnt lgkmcnt(4)
    v_mfma_f32_16x16x32_bf16 v[20:23], a[8:11], v[144:147], v[20:23]
    v_mfma_f32_16x16x32_bf16 v[28:31], a[72:75], v[144:147], v[28:31]
    v_mfma_f32_16x16x32_bf16 v[36:39], v[144:147], a[136:139], v[36:39]
    v_mfma_f32_16x16x32_bf16 v[24:27], a[8:11], v[148:151], v[24:27]
    v_mfma_f32_16x16x32_bf16 v[32:35], a[72:75], v[148:151], v[32:35]
    v_mfma_f32_16x16x32_bf16 v[40:43], v[148:151], a[136:139], v[40:43]
    ds_read_b128 v[144:147], v8 offset:10240
    ds_read_b128 v[148:151], v8 offset:10496
    s_waitcnt lgkmcnt(4)
    v_mfma_f32_16x16x32_bf16 v[20:23], a[12:15], v[128:131], v[20:23]
    v_mfma_f32_16x16x32_bf16 v[28:31], a[76:79], v[128:131], v[28:31]
    v_mfma_f32_16x16x32_bf16 v[36:39], v[128:131], a[140:143], v[36:39]
    v_mfma_f32_16x16x32_bf16 v[24:27], a[12:15], v[132:135], v[24:27]
    v_mfma_f32_16x16x32_bf16 v[32:35], a[76:79], v[132:135], v[32:35]
    v_mfma_f32_16x16x32_bf16 v[40:43], v[132:135], a[140:143], v[40:43]
    ds_read_b128 v[128:131], v8 offset:12288
    ds_read_b128 v[132:135], v8 offset:12544
    s_waitcnt lgkmcnt(4)
    v_mfma_f32_16x16x32_bf16 v[20:23], a[16:19], v[136:139], v[20:23]
    v_mfma_f32_16x16x32_bf16 v[28:31], a[80:83], v[136:139], v[28:31]
    v_mfma_f32_16x16x32_bf16 v[36:39], v[136:139], a[144:147], v[36:39]
    v_mfma_f32_16x16x32_bf16 v[24:27], a[16:19], v[140:143], v[24:27]
    v_mfma_f32_16x16x32_bf16 v[32:35], a[80:83], v[140:143], v[32:35]
    v_mfma_f32_16x16x32_bf16 v[40:43], v[140:143], a[144:147], v[40:43]
    ds_read_b128 v[136:139], v8 offset:14336
    ds_read_b128 v[140:143], v8 offset:14592
    s_waitcnt lgkmcnt(4)
    v_mfma_f32_16x16x32_bf16 v[20:23], a[20:23], v[144:147], v[20:23]
    v_mfma_f32_16x16x32_bf16 v[28:31], a[84:87], v[144:147], v[28:31]
    v_mfma_f32_16x16x32_bf16 v[36:39], v[144:147], a[148:151], v[36:39]
    v_mfma_f32_16x16x32_bf16 v[24:27], a[20:23], v[148:151], v[24:27]
    v_mfma_f32_16x16x32_bf16 v[32:35], a[84:87], v[148:151], v[32:35]
    v_mfma_f32_16x16x32_bf16 v[40:43], v[148:151], a[148:151], v[40:43]
    ds_read_b128 v[144:147], v8 offset:16384
    ds_read_b128 v[148:151], v8 offset:16640
    s_waitcnt lgkmcnt(4)
    v_mfma_f32_16x16x32_bf16 v[20:23], a[24:27], v[128:131], v[20:23]
    v_mfma_f32_16x16x32_bf16 v[28:31], a[88:91], v[128:131], v[28:31]
    v_mfma_f32_16x16x32_bf16 v[36:39], v[128:131], a[152:155], v[36:39]
    v_mfma_f32_16x16x32_bf16 v[24:27], a[24:27], v[132:135], v[24:27]
    v_mfma_f32_16x16x32_bf16 v[32:35], a[88:91], v[132:135], v[32:35]
    v_mfma_f32_16x16x32_bf16 v[40:43], v[132:135], a[152:155], v[40:43]
    ds_read_b128 v[128:131], v8 offset:18432
    ds_read_b128 v[132:135], v8 offset:18688
    s_waitcnt lgkmcnt(4)
    v_mfma_f32_16x16x32_bf16 v[20:23], a[28:31], v[136:139], v[20:23]
    v_mfma_f32_16x16x32_bf16 v[28:31], a[92:95], v[136:139], v[28:31]
    v_mfma_f32_16x16x32_bf16 v[36:39], v[136:139], a[156:159], v[36:39]
    v_mfma_f32_16x16x32_bf16 v[24:27], a[28:31], v[140:143], v[24:27]
    v_mfma_f32_16x16x32_bf16 v[32:35], a[92:95], v[140:143], v[32:35]
    v_mfma_f32_16x16x32_bf16 v[40:43], v[140:143], a[156:159], v[40:43]
    ds_read_b128 v[136:139], v8 offset:20480
    ds_read_b128 v[140:143], v8 offset:20736
    s_waitcnt lgkmcnt(4)
    v_mfma_f32_16x16x32_bf16 v[20:23], a[32:35], v[144:147], v[20:23]
    v_mfma_f32_16x16x32_bf16 v[28:31], a[96:99], v[144:147], v[28:31]
    v_mfma_f32_16x16x32_bf16 v[36:39], v[144:147], a[160:163], v[36:39]
    v_mfma_f32_16x16x32_bf16 v[24:27], a[32:35], v[148:151], v[24:27]
    v_mfma_f32_16x16x32_bf16 v[32:35], a[96:99], v[148:151], v[32:35]
    v_mfma_f32_16x16x32_bf16 v[40:43], v[148:151], a[160:163], v[40:43]
    ds_read_b128 v[144:147], v8 offset:22528
    ds_read_b128 v[148:151], v8 offset:22784
    s_waitcnt lgkmcnt(4)
    v_mfma_f32_16x16x32_bf16 v[20:23], a[36:39], v[128:131], v[20:23]
    v_mfma_f32_16x16x32_bf16 v[28:31], a[100:103], v[128:131], v[28:31]
    v_mfma_f32_16x16x32_bf16 v[36:39], v[128:131], a[164:167], v[36:39]
    v_mfma_f32_16x16x32_bf16 v[24:27], a[36:39], v[132:135], v[24:27]
    v_mfma_f32_16x16x32_bf16 v[32:35], a[100:103], v[132:135], v[32:35]
    v_mfma_f32_16x16x32_bf16 v[40:43], v[132:135], a[164:167], v[40:43]
    ds_read_b128 v[128:131], v8 offset:24576
    ds_read_b128 v[132:135], v8 offset:24832
    s_waitcnt lgkmcnt(4)
    v_mfma_f32_16x16x32_bf16 v[20:23], a[40:43], v[136:139], v[20:23]
    v_mfma_f32_16x16x32_bf16 v[28:31], a[104:107], v[136:139], v[28:31]
    v_mfma_f32_16x16x32_bf16 v[36:39], v[136:139], a[168:171], v[36:39]
    v_mfma_f32_16x16x32_bf16 v[24:27], a[40:43], v[140:143], v[24:27]
    v_mfma_f32_16x16x32_bf16 v[32:35], a[104:107], v[140:143], v[32:35]
    v_mfma_f32_16x16x32_bf16 v[40:43], v[140:143], a[168:171], v[40:43]
    ds_read_b128 v[136:139], v8 offset:26624
    ds_read_b128 v[140:143], v8 offset:26880
    s_waitcnt lgkmcnt(4)
    v_mfma_f32_16x16x32_bf16 v[20:23], a[44:47], v[144:147], v[20:23]
    v_mfma_f32_16x16x32_bf16 v[28:31], a[108:111], v[144:147], v[28:31]
    v_mfma_f32_16x16x32_bf16 v[36:39], v[144:147], a[172:175], v[36:39]
    v_mfma_f32_16x16x32_bf16 v[24:27], a[44:47], v[148:151], v[24:27]
    v_mfma_f32_16x16x32_bf16 v[32:35], a[108:111], v[148:151], v[32:35]
    v_mfma_f32_16x16x32_bf16 v[40:43], v[148:151], a[172:175], v[40:43]
    ds_read_b128 v[144:147], v8 offset:28672
    ds_read_b128 v[148:151], v8 offset:28928
    s_waitcnt lgkmcnt(4)
    v_mfma_f32_16x16x32_bf16 v[20:23], a[48:51], v[128:131], v[20:23]
    v_mfma_f32_16x16x32_bf16 v[28:31], a[112:115], v[128:131], v[28:31]
    v_mfma_f32_16x16x32_bf16 v[36:39], v[128:131], a[176:179], v[36:39]
    v_mfma_f32_16x16x32_bf16 v[24:27], a[48:51], v[132:135], v[24:27]
    v_mfma_f32_16x16x32_bf16 v[32:35], a[112:115], v[132:135], v[32:35]
    v_mfma_f32_16x16x32_bf16 v[40:43], v[132:135], a[176:179], v[40:43]
    ds_read_b128 v[128:131], v8 offset:30720
    ds_read_b128 v[132:135], v8 offset:30976
    s_waitcnt lgkmcnt(4)
    v_mfma_f32_16x16x32_bf16 v[20:23], a[52:55], v[136:139], v[20:23]
    v_mfma_f32_16x16x32_bf16 v[28:31], a[116:119], v[136:139], v[28:31]
    v_mfma_f32_16x16x32_bf16 v[36:39], v[136:139], a[180:183], v[36:39]
    v_mfma_f32_16x16x32_bf16 v[24:27], a[52:55], v[140:143], v[24:27]
    v_mfma_f32_16x16x32_bf16 v[32:35], a[116:119], v[140:143], v[32:35]
    v_mfma_f32_16x16x32_bf16 v[40:43], v[140:143], a[180:183], v[40:43]
    s_waitcnt lgkmcnt(2)
    v_mfma_f32_16x16x32_bf16 v[20:23], a[56:59], v[144:147], v[20:23]
    v_mfma_f32_16x16x32_bf16 v[28:31], a[120:123], v[144:147], v[28:31]
    v_mfma_f32_16x16x32_bf16 v[36:39], v[144:147], a[184:187], v[36:39]
    v_mfma_f32_16x16x32_bf16 v[24:27], a[56:59], v[148:151], v[24:27]
    v_mfma_f32_16x16x32_bf16 v[32:35], a[120:123], v[148:151], v[32:35]
    v_mfma_f32_16x16x32_bf16 v[40:43], v[148:151], a[184:187], v[40:43]
    s_waitcnt lgkmcnt(0)
    v_mfma_f32_16x16x32_bf16 v[20:23], a[60:63], v[128:131], v[20:23]
    v_mfma_f32_16x16x32_bf16 v[28:31], a[124:127], v[128:131], v[28:31]
    v_mfma_f32_16x16x32_bf16 v[36:39], v[128:131], a[188:191], v[36:39]
    v_mfma_f32_16x16x32_bf16 v[24:27], a[60:63], v[132:135], v[24:27]
    v_mfma_f32_16x16x32_bf16 v[32:35], a[124:127], v[132:135], v[32:35]
    v_mfma_f32_16x16x32_bf16 v[40:43], v[132:135], a[188:191], v[40:43]
    s_nop 2
    v_cvt_pk_bf16_f32 v44, v20, v21
    v_cvt_pk_bf16_f32 v45, v22, v23
    v_cvt_pk_bf16_f32 v50, v28, v29
    v_cvt_pk_bf16_f32 v51, v30, v31
    v_cvt_pk_bf16_f32 v56, v36, v37
    v_cvt_pk_bf16_f32 v57, v38, v39
    v_cvt_pk_bf16_f32 v46, v24, v25
    v_cvt_pk_bf16_f32 v47, v26, v27
    v_cvt_pk_bf16_f32 v52, v32, v33
    v_cvt_pk_bf16_f32 v53, v34, v35
    v_cvt_pk_bf16_f32 v58, v40, v41
    v_cvt_pk_bf16_f32 v59, v42, v43
    v_mfma_f32_16x16x16_bf16 v[60:63], v[48:49], v[44:45], 0
    v_mfma_f32_16x16x16_bf16 v[64:67], v[50:51], v[44:45], 0
    v_mfma_f32_16x16x16_bf16 v[84:87], v[50:51], v[46:47], 0
    v_mfma_f32_16x16x16_bf16 v[88:91], v[52:53], v[46:47], 0
    s_cmp_eq_u32 s10, 0
    s_cselect_b64 s[44:45], 0, s[28:29]
    s_cselect_b64 s[46:47], 0, s[30:31]
    s_cselect_b64 s[48:49], 0, s[32:33]
    s_cselect_b64 s[50:51], 0, s[34:35]
    v_mov_b32 v11, 0xf149f2ca
    v_cndmask_b32 v60, v11, v60, s[44:45]
    v_cndmask_b32 v84, v11, v84, s[28:29]
    v_cndmask_b32 v61, v11, v61, s[46:47]
    v_cndmask_b32 v85, v11, v85, s[30:31]
    v_cndmask_b32 v62, v11, v62, s[48:49]
    v_cndmask_b32 v86, v11, v86, s[32:33]
    v_cndmask_b32 v63, v11, v63, s[50:51]
    v_cndmask_b32 v87, v11, v87, s[34:35]
    v_cndmask_b32 v64, v11, v64, s[36:37]
    v_cndmask_b32 v88, v11, v88, s[36:37]
    v_cndmask_b32 v65, v11, v65, s[38:39]
    v_cndmask_b32 v89, v11, v89, s[38:39]
    v_cndmask_b32 v66, v11, v66, s[40:41]
    v_cndmask_b32 v90, v11, v90, s[40:41]
    v_cndmask_b32 v67, v11, v67, s[42:43]
    v_cndmask_b32 v91, v11, v91, s[42:43]
    v_max3_f32 v12, v60, v61, v62
    v_max3_f32 v92, v84, v85, v86
    v_max3_f32 v13, v63, v64, v65
    v_max3_f32 v93, v87, v88, v89
    v_max3_f32 v12, v12, v66, v67
    v_max3_f32 v92, v92, v90, v91
    v_max_f32 v12, v12, v13
    v_max_f32 v92, v92, v93
    v_mov_b32 v13, v12
    v_mov_b32 v93, v92
    s_nop 0
    v_permlane16_swap_b32 v12, v13
    v_permlane16_swap_b32 v92, v93
    v_max_f32 v12, v12, v13
    v_max_f32 v92, v92, v93
    v_mov_b32 v13, v12
    v_mov_b32 v93, v92
    s_nop 0
    v_permlane32_swap_b32 v12, v13
    v_permlane32_swap_b32 v92, v93
    v_max_f32 v12, v12, v13
    v_max_f32 v92, v92, v93
    v_mul_f32 v12, s27, v12
    v_mul_f32 v92, s27, v92
    v_fma_f32 v60, v60, s26, v12
    v_fma_f32 v84, v84, s26, v92
    v_fma_f32 v61, v61, s26, v12
    v_fma_f32 v85, v85, s26, v92
    v_fma_f32 v62, v62, s26, v12
    v_fma_f32 v86, v86, s26, v92
    v_fma_f32 v63, v63, s26, v12
    v_fma_f32 v87, v87, s26, v92
    v_fma_f32 v64, v64, s26, v12
    v_fma_f32 v88, v88, s26, v92
    v_fma_f32 v65, v65, s26, v12
    v_fma_f32 v89, v89, s26, v92
    v_fma_f32 v66, v66, s26, v12
    v_fma_f32 v90, v90, s26, v92
    v_fma_f32 v67, v67, s26, v12
    v_fma_f32 v91, v91, s26, v92
    v_exp_f32 v60, v60
    v_exp_f32 v84, v84
    v_exp_f32 v61, v61
    v_exp_f32 v85, v85
    v_exp_f32 v62, v62
    v_exp_f32 v86, v86
    v_exp_f32 v63, v63
    v_exp_f32 v87, v87
    v_exp_f32 v64, v64
    v_exp_f32 v88, v88
    v_exp_f32 v65, v65
    v_exp_f32 v89, v89
    v_exp_f32 v66, v66
    v_exp_f32 v90, v90
    v_exp_f32 v67, v67
    v_exp_f32 v91, v91
    v_cvt_pk_bf16_f32 v68, v60, v61
    v_cvt_pk_bf16_f32 v96, v84, v85
    v_cvt_pk_bf16_f32 v69, v62, v63
    v_cvt_pk_bf16_f32 v97, v86, v87
    v_cvt_pk_bf16_f32 v70, v64, v65
    v_cvt_pk_bf16_f32 v98, v88, v89
    v_cvt_pk_bf16_f32 v71, v66, v67
    v_cvt_pk_bf16_f32 v99, v90, v91
    s_nop 0
    v_mfma_f32_16x16x32_bf16 v[72:75], v[54:57], v[68:71], 0
    v_mfma_f32_16x16x32_bf16 v[76:79], v[56:59], v[96:99], 0
    v_add_f32 v12, v60, v61
    v_add_f32 v92, v84, v85
    v_add_f32 v13, v62, v63
    v_add_f32 v93, v86, v87
    v_add_f32 v14, v64, v65
    v_add_f32 v94, v88, v89
    v_add_f32 v15, v66, v67
    v_add_f32 v95, v90, v91
    v_add_f32 v12, v12, v13
    v_add_f32 v92, v92, v93
    v_add_f32 v14, v14, v15
    v_add_f32 v94, v94, v95
    v_add_f32 v12, v12, v14
    v_add_f32 v92, v92, v94
    v_mov_b32 v13, v12
    v_mov_b32 v93, v92
    s_nop 0
    v_permlane16_swap_b32 v12, v13
    v_permlane16_swap_b32 v92, v93
    v_add_f32 v12, v12, v13
    v_add_f32 v92, v92, v93
    v_mov_b32 v13, v12
    v_mov_b32 v93, v92
    s_nop 0
    v_permlane32_swap_b32 v12, v13
    v_permlane32_swap_b32 v92, v93
    v_add_f32 v12, v12, v13
    v_add_f32 v92, v92, v93
    v_rcp_f32 v12, v12
    v_rcp_f32 v92, v92
    v_mul_f32 v72, v72, v12
    v_mul_f32 v76, v76, v92
    v_mul_f32 v73, v73, v12
    v_mul_f32 v77, v77, v92
    v_mul_f32 v74, v74, v12
    v_mul_f32 v78, v78, v92
    v_mul_f32 v75, v75, v12
    v_mul_f32 v79, v79, v92
    v_permlane16_swap_b32 v72, v76
    v_permlane16_swap_b32 v73, v77
    v_permlane16_swap_b32 v74, v78
    v_permlane16_swap_b32 v75, v79
    v_cvt_pk_bf16_f32 v80, v72, v73
    v_cvt_pk_bf16_f32 v81, v74, v75
    v_cvt_pk_bf16_f32 v82, v76, v77
    v_cvt_pk_bf16_f32 v83, v78, v79
    s_lshl_b32 s11, s10, 15
    s_add_u32 s11, s11, 10485760
    s_lshl_b32 s14, s8, 10
    s_add_u32 s11, s11, s14
    buffer_store_dwordx4 v[80:83], v0, s[4:7], s11 offen
    s_add_u32 s59, s63, 0
    s_lshl_b32 s59, s59, 7
    s_add_u32 s59, s59, 98304
    s_lshl_b32 s14, s55, 2
    s_add_u32 s59, s59, s14
    s_waitcnt vmcnt(0)
    s_barrier
    s_cmp_lg_u32 s9, 0
    s_cbranch_scc1 pb_14
    s_add_u32 s11, s10, 1
    v_mov_b32 v10, s11
    buffer_store_dword v10, off, s[4:7], s59
pb_14:
    s_xor_b32 s68, s68, 116736
    s_xor_b32 s69, s69, 18432
    s_add_u32 s59, s63, 0
    s_lshl_b32 s59, s59, 7
    s_add_u32 s59, s59, 98304
    s_mov_b32 s15, 0
aw_15:
    buffer_load_dword v10, v2, s[4:7], s59 offen sc1
    s_add_u32 s15, s15, 1
    s_cmp_gt_u32 s15, 200000
    s_cbranch_scc1 K_FAIL
    s_waitcnt vmcnt(0)
    v_cmp_ge_u32 vcc, s10, v10
    s_cbranch_vccz awok_16
    s_sleep 1
    s_branch aw_15
awok_16:
    s_lshl_b32 s61, s10, 15
    s_add_u32 s61, s61, 10485760
    s_lshl_b32 s11, s9, 13
    s_add_u32 s12, s61, s11
    s_add_u32 s11, s11, 32768
    s_mov_b32 m0, s11
    s_nop 0
    buffer_load_dwordx4 v0, s[4:7], s12 offen offset:0 sc1 lds
    buffer_load_dwordx4 v0, s[4:7], s12 offen offset:1024 sc1 lds
    buffer_load_dwordx4 v0, s[4:7], s12 offen offset:2048 sc1 lds
    buffer_load_dwordx4 v0, s[4:7], s12 offen offset:3072 sc1 lds
    s_add_u32 s11, s11, 4096
    s_add_u32 s12, s12, 4096
    s_mov_b32 m0, s11
    s_nop 0
    buffer_load_dwordx4 v0, s[4:7], s12 offen offset:0 sc1 lds
    buffer_load_dwordx4 v0, s[4:7], s12 offen offset:1024 sc1 lds
    buffer_load_dwordx4 v0, s[4:7], s12 offen offset:2048 sc1 lds
    buffer_load_dwordx4 v0, s[4:7], s12 offen offset:3072 sc1 lds
    s_lshl_b32 s11, s10, 15
    buffer_load_dwordx4 v[28:31], v3, s[16:19], s11 offen
    s_add_u32 s11, s56, 1
    s_cmp_ge_u32 s11, s70
    s_cbranch_scc1 nf_17
    s_add_u32 s57, s10, 4
    s_lshl_b32 s61, s57, 15
    s_add_u32 s61, s61, 8388608
    s_lshl_b32 s11, s9, 13
    s_add_u32 s12, s61, s11
    s_add_u32 s11, s11, s68
    s_mov_b32 m0, s11
    s_nop 0
    buffer_load_dwordx4 v0, s[4:7], s12 offen offset:0 sc1 lds
    buffer_load_dwordx4 v0, s[4:7], s12 offen offset:1024 sc1 lds
    buffer_load_dwordx4 v0, s[4:7], s12 offen offset:2048 sc1 lds
    buffer_load_dwordx4 v0, s[4:7], s12 offen offset:3072 sc1 lds
    s_add_u32 s11, s11, 4096
    s_add_u32 s12, s12, 4096
    s_mov_b32 m0, s11
    s_nop 0
    buffer_load_dwordx4 v0, s[4:7], s12 offen offset:0 sc1 lds
    buffer_load_dwordx4 v0, s[4:7], s12 offen offset:1024 sc1 lds
    buffer_load_dwordx4 v0, s[4:7], s12 offen offset:2048 sc1 lds
    buffer_load_dwordx4 v0, s[4:7], s12 offen offset:3072 sc1 lds
    s_cmp_eq_u32 s57, 0
    s_cselect_b32 s11, 0, 32768
    s_sub_u32 s61, s61, s11
    s_lshl_b32 s11, s9, 13
    s_add_u32 s12, s61, s11
    s_add_u32 s12, s12, 256
    s_lshl_b32 s11, s9, 12
    s_add_u32 s11, s11, s69
    s_mov_b32 m0, s11
    s_nop 0
    buffer_load_dwordx4 v1, s[4:7], s12 offen sc1 lds
    s_add_u32 s11, s11, 1024
    s_add_u32 s12, s12, 2048
    s_mov_b32 m0, s11
    s_nop 0
    buffer_load_dwordx4 v1, s[4:7], s12 offen sc1 lds
    s_add_u32 s11, s11, 1024
    s_add_u32 s12, s12, 2048
    s_mov_b32 m0, s11
    s_nop 0
    buffer_load_dwordx4 v1, s[4:7], s12 offen sc1 lds
    s_add_u32 s11, s11, 1024
    s_add_u32 s12, s12, 2048
    s_mov_b32 m0, s11
    s_nop 0
    buffer_load_dwordx4 v1, s[4:7], s12 offen sc1 lds
    s_waitcnt vmcnt(12)
    s_branch nf_18
nf_17:
    s_waitcnt vmcnt(0)
nf_18:
    s_barrier
    v_add_u32 v8, 32768, v1
    ds_read_b128 v[128:131], v8 offset:0
    ds_read_b128 v[132:135], v8 offset:256
    ds_read_b128 v[136:139], v8 offset:2048
    ds_read_b128 v[140:143], v8 offset:2304
    ds_read_b128 v[144:147], v8 offset:4096
    ds_read_b128 v[148:151], v8 offset:4352
    s_waitcnt lgkmcnt(4)
    v_mfma_f32_16x16x32_bf16 v[112:115], a[192:195], v[128:131], 0
    v_mfma_f32_16x16x32_bf16 v[116:119], a[192:195], v[132:135], 0
    ds_read_b128 v[128:131], v8 offset:6144
    ds_read_b128 v[132:135], v8 offset:6400
    s_waitcnt lgkmcnt(4)
    v_mfma_f32_16x16x32_bf16 v[112:115], a[196:199], v[136:139], v[112:115]
    v_mfma_f32_16x16x32_bf16 v[116:119], a[196:199], v[140:143], v[116:119]
    ds_read_b128 v[136:139], v8 offset:8192
    ds_read_b128 v[140:143], v8 offset:8448
    s_waitcnt lgkmcnt(4)
    v_mfma_f32_16x16x32_bf16 v[112:115], a[200:203], v[144:147], v[112:115]
    v_mfma_f32_16x16x32_bf16 v[116:119], a[200:203], v[148:151], v[116:119]
    ds_read_b128 v[144:147], v8 offset:10240
    ds_read_b128 v[148:151], v8 offset:10496
    s_waitcnt lgkmcnt(4)
    v_mfma_f32_16x16x32_bf16 v[112:115], a[204:207], v[128:131], v[112:115]
    v_mfma_f32_16x16x32_bf16 v[116:119], a[204:207], v[132:135], v[116:119]
    ds_read_b128 v[128:131], v8 offset:12288
    ds_read_b128 v[132:135], v8 offset:12544
    s_waitcnt lgkmcnt(4)
    v_mfma_f32_16x16x32_bf16 v[112:115], a[208:211], v[136:139], v[112:115]
    v_mfma_f32_16x16x32_bf16 v[116:119], a[208:211], v[140:143], v[116:119]
    ds_read_b128 v[136:139], v8 offset:14336
    ds_read_b128 v[140:143], v8 offset:14592
    s_waitcnt lgkmcnt(4)
    v_mfma_f32_16x16x32_bf16 v[112:115], a[212:215], v[144:147], v[112:115]
    v_mfma_f32_16x16x32_bf16 v[116:119], a[212:215], v[148:151], v[116:119]
    ds_read_b128 v[144:147], v8 offset:16384
    ds_read_b128 v[148:151], v8 offset:16640
    s_waitcnt lgkmcnt(4)
    v_mfma_f32_16x16x32_bf16 v[112:115], a[216:219], v[128:131], v[112:115]
    v_mfma_f32_16x16x32_bf16 v[116:119], a[216:219], v[132:135], v[116:119]
    ds_read_b128 v[128:131], v8 offset:18432
    ds_read_b128 v[132:135], v8 offset:18688
    s_waitcnt lgkmcnt(4)
    v_mfma_f32_16x16x32_bf16 v[112:115], a[220:223], v[136:139], v[112:115]
    v_mfma_f32_16x16x32_bf16 v[116:119], a[220:223], v[140:143], v[116:119]
    ds_read_b128 v[136:139], v8 offset:20480
    ds_read_b128 v[140:143], v8 offset:20736
    s_waitcnt lgkmcnt(4)
    v_mfma_f32_16x16x32_bf16 v[112:115], a[224:227], v[144:147], v[112:115]
    v_mfma_f32_16x16x32_bf16 v[116:119], a[224:227], v[148:151], v[116:119]
    ds_read_b128 v[144:147], v8 offset:22528
    ds_read_b128 v[148:151], v8 offset:22784
    s_waitcnt lgkmcnt(4)
    v_mfma_f32_16x16x32_bf16 v[112:115], a[228:231], v[128:131], v[112:115]
    v_mfma_f32_16x16x32_bf16 v[116:119], a[228:231], v[132:135], v[116:119]
    ds_read_b128 v[128:131], v8 offset:24576
    ds_read_b128 v[132:135], v8 offset:24832
    s_waitcnt lgkmcnt(4)
    v_mfma_f32_16x16x32_bf16 v[112:115], a[232:235], v[136:139], v[112:115]
    v_mfma_f32_16x16x32_bf16 v[116:119], a[232:235], v[140:143], v[116:119]
    ds_read_b128 v[136:139], v8 offset:26624
    ds_read_b128 v[140:143], v8 offset:26880
    s_waitcnt lgkmcnt(4)
    v_mfma_f32_16x16x32_bf16 v[112:115], a[236:239], v[144:147], v[112:115]
    v_mfma_f32_16x16x32_bf16 v[116:119], a[236:239], v[148:151], v[116:119]
    ds_read_b128 v[144:147], v8 offset:28672
    ds_read_b128 v[148:151], v8 offset:28928
    s_waitcnt lgkmcnt(4)
    v_mfma_f32_16x16x32_bf16 v[112:115], a[240:243], v[128:131], v[112:115]
    v_mfma_f32_16x16x32_bf16 v[116:119], a[240:243], v[132:135], v[116:119]
    ds_read_b128 v[128:131], v8 offset:30720
    ds_read_b128 v[132:135], v8 offset:30976
    s_waitcnt lgkmcnt(4)
    v_mfma_f32_16x16x32_bf16 v[112:115], a[244:247], v[136:139], v[112:115]
    v_mfma_f32_16x16x32_bf16 v[116:119], a[244:247], v[140:143], v[116:119]
    s_waitcnt lgkmcnt(2)
    v_mfma_f32_16x16x32_bf16 v[112:115], a[248:251], v[144:147], v[112:115]
    v_mfma_f32_16x16x32_bf16 v[116:119], a[248:251], v[148:151], v[116:119]
    s_waitcnt lgkmcnt(0)
    v_mfma_f32_16x16x32_bf16 v[112:115], a[252:255], v[128:131], v[112:115]
    v_mfma_f32_16x16x32_bf16 v[116:119], a[252:255], v[132:135], v[116:119]
    s_nop 7
    v_permlane16_swap_b32 v112, v116
    v_permlane16_swap_b32 v113, v117
    v_permlane16_swap_b32 v114, v118
    v_permlane16_swap_b32 v115, v119
    v_mov_b32 v20, v112
    v_mov_b32 v24, v116
    v_mov_b32 v21, v113
    v_mov_b32 v25, v117
    v_mov_b32 v22, v114
    v_mov_b32 v26, v118
    v_mov_b32 v23, v115
    v_mov_b32 v27, v119
    v_cvt_pk_bf16_f32 v40, v20, v21
    v_cvt_pk_bf16_f32 v41, v22, v23
    v_cvt_pk_bf16_f32 v42, v24, v25
    v_cvt_pk_bf16_f32 v43, v26, v27
    v_lshlrev_b32 v20, 16, v40
    v_and_b32 v21, 0xffff0000, v40
    v_lshlrev_b32 v22, 16, v41
    v_and_b32 v23, 0xffff0000, v41
    v_lshlrev_b32 v24, 16, v42
    v_and_b32 v25, 0xffff0000, v42
    v_lshlrev_b32 v26, 16, v43
    v_and_b32 v27, 0xffff0000, v43
    v_lshlrev_b32 v32, 16, v28
    v_and_b32 v33, 0xffff0000, v28
    v_lshlrev_b32 v34, 16, v29
    v_and_b32 v35, 0xffff0000, v29
    v_lshlrev_b32 v36, 16, v30
    v_and_b32 v37, 0xffff0000, v30
    v_lshlrev_b32 v38, 16, v31
    v_and_b32 v39, 0xffff0000, v31
    v_add_f32 v20, v20, v32
    v_add_f32 v21, v21, v33
    v_add_f32 v22, v22, v34
    v_add_f32 v23, v23, v35
    v_add_f32 v24, v24, v36
    v_add_f32 v25, v25, v37
    v_add_f32 v26, v26, v38
    v_add_f32 v27, v27, v39
    v_cvt_pk_bf16_f32 v40, v20, v21
    v_cvt_pk_bf16_f32 v41, v22, v23
    v_cvt_pk_bf16_f32 v42, v24, v25
    v_cvt_pk_bf16_f32 v43, v26, v27
    v_lshlrev_b32 v32, 16, v40
    v_and_b32 v33, 0xffff0000, v40
    v_lshlrev_b32 v34, 16, v41
    v_and_b32 v35, 0xffff0000, v41
    v_lshlrev_b32 v36, 16, v42
    v_and_b32 v37, 0xffff0000, v42
    v_lshlrev_b32 v38, 16, v43
    v_and_b32 v39, 0xffff0000, v43
    v_mov_b32 v100, v40
    v_mov_b32 v101, v41
    v_mov_b32 v102, v42
    v_mov_b32 v103, v43
    v_add_f32 v44, v32, v33
    v_mul_f32 v45, v32, v32
    v_add_f32 v12, v34, v35
    v_fmac_f32 v45, v33, v33
    v_add_f32 v13, v36, v37
    v_mul_f32 v15, v34, v34
    v_add_f32 v14, v38, v39
    v_fmac_f32 v15, v35, v35
    v_add_f32 v44, v44, v12
    v_fmac_f32 v45, v36, v36
    v_add_f32 v13, v13, v14
    v_fmac_f32 v15, v37, v37
    v_add_f32 v44, v44, v13
    v_fmac_f32 v45, v38, v38
    v_fmac_f32 v15, v39, v39
    v_add_f32 v45, v45, v15
    v_mov_b32 v12, v44
    v_mov_b32 v13, v45
    s_nop 0
    v_permlane32_swap_b32 v44, v12
    v_permlane32_swap_b32 v45, v13
    v_add_f32 v44, v44, v12
    v_add_f32 v45, v45, v13
    v_lshrrev_b32 v14, 1, v0
    v_and_b32 v14, 0xff, v14
    s_lshl_b32 s11, s9, 8
    s_add_u32 s11, s11, 81920
    v_add_u32 v15, s11, v14
    ds_write_b64 v15, v[44:45]
    s_waitcnt lgkmcnt(0)
    s_barrier
    v_add_u32 v14, 81920, v14
    ds_read_b64 v[104:105], v14 offset:0
    ds_read_b64 v[106:107], v14 offset:256
    ds_read_b64 v[108:109], v14 offset:512
    ds_read_b64 v[110:111], v14 offset:768
    s_add_u32 s11, s56, 0
    s_and_b32 s11, s11, 3
    s_lshl_b32 s14, s63, 2
    s_add_u32 s11, s11, s14
    s_lshl_b32 s11, s11, 11
    s_add_u32 s11, s11, 2162688
    s_add_u32 s12, s56, 0
    s_and_b32 s12, s12, 3
    s_lshl_b32 s14, s63, 2
    s_add_u32 s12, s12, s14
    s_lshl_b32 s12, s12, 11
    s_add_u32 s12, s12, 2162688
    s_mov_b32 s13, s11
    s_waitcnt lgkmcnt(0)
    v_add_f32 v104, v104, v106
    v_add_f32 v105, v105, v107
    v_add_f32 v108, v108, v110
    v_add_f32 v109, v109, v111
    v_add_f32 v44, v104, v108
    v_add_f32 v45, v105, v109
    s_cmp_lg_u32 s9, 0
    s_cbranch_scc1 lnp_19
    s_mov_b64 exec, s[24:25]
    buffer_store_dwordx2 v[44:45], v4, s[4:7], s11 offen
    s_mov_b64 exec, -1
lnp_19:
    s_mov_b32 s15, 0
sg_20:
    buffer_load_dwordx4 v[104:107], v0, s[4:7], s13 offen offset:0 sc1
    buffer_load_dwordx4 v[108:111], v0, s[4:7], s13 offen offset:1024 sc1
    s_add_u32 s15, s15, 1
    s_cmp_gt_u32 s15, 200000
    s_cbranch_scc1 K_FAIL
    s_waitcnt vmcnt(0)
    v_add_f32 v104, v104, v108
    v_add_f32 v105, v105, v109
    v_add_f32 v106, v106, v110
    v_add_f32 v107, v107, v111
    v_add_f32 v44, v104, v106
    v_add_f32 v45, v105, v107
    v_cmp_u_f32 vcc, v44, v45
    s_cbranch_vccz sgok_21
    s_branch sg_20
sgok_21:
    s_cmp_lg_u32 s9, 0
    s_cbranch_scc1 lnr_22
    s_add_u32 s11, s56, 3
    s_and_b32 s11, s11, 3
    s_lshl_b32 s14, s63, 2
    s_add_u32 s11, s11, s14
    s_lshl_b32 s11, s11, 11
    s_add_u32 s11, s11, 2162688
    s_mov_b64 exec, s[24:25]
    buffer_store_dwordx2 v[18:19], v4, s[4:7], s11 offen
    s_mov_b64 exec, -1
lnr_22:
    v_mov_b32 v12, v44
    v_mov_b32 v13, v45
    s_nop 0
    v_permlane32_swap_b32 v44, v12
    v_permlane32_swap_b32 v45, v13
    v_add_f32 v44, v44, v12
    v_add_f32 v45, v45, v13
    v_mul_f32 v44, 0x3b000000, v44
    v_mul_f32 v45, 0x3b000000, v45
    v_fma_f32 v45, -v44, v44, v45
    v_max_f32 v45, 0, v45
    v_add_f32 v45, 0x3727c5ac, v45
    v_rsq_f32 v45, v45
    v_sub_f32 v32, v32, v44
    v_sub_f32 v33, v33, v44
    v_sub_f32 v34, v34, v44
    v_sub_f32 v35, v35, v44
    v_sub_f32 v36, v36, v44
    v_sub_f32 v37, v37, v44
    v_sub_f32 v38, v38, v44
    v_sub_f32 v39, v39, v44
    v_mul_f32 v32, v32, v45
    v_mul_f32 v33, v33, v45
    v_mul_f32 v34, v34, v45
    v_mul_f32 v35, v35, v45
    v_mul_f32 v36, v36, v45
    v_mul_f32 v37, v37, v45
    v_mul_f32 v38, v38, v45
    v_mul_f32 v39, v39, v45
    v_cvt_pk_bf16_f32 v40, v32, v33
    v_cvt_pk_bf16_f32 v41, v34, v35
    v_cvt_pk_bf16_f32 v42, v36, v37
    v_cvt_pk_bf16_f32 v43, v38, v39
    s_lshl_b32 s11, s10, 15
    s_add_u32 s11, s11, 6291456
    s_lshl_b32 s14, s8, 10
    s_add_u32 s11, s11, s14
    buffer_store_dwordx4 v[40:43], v0, s[4:7], s11 offen sc1
    s_lshl_b32 s11, s10, 15
    s_add_u32 s11, s11, 4194304
    s_lshl_b32 s14, s8, 10
    s_add_u32 s11, s11, s14
    buffer_store_dwordx4 v[100:103], v0, s[4:7], s11 offen sc1
    s_cmp_eq_u32 s56, 0
    s_cbranch_scc0 fp_23
    s_waitcnt vmcnt(0)
    s_barrier
    s_cmp_lg_u32 s9, 0
    s_cbranch_scc1 pb_24
    s_add_u32 s11, s10, 1
    v_mov_b32 v10, s11
    buffer_store_dword v10, off, s[4:7], s60 sc1
pb_24:
fp_23:
    s_add_u32 s10, s10, 4
    s_add_u32 s56, s56, 1
    s_cmp_lt_u32 s56, s70
    s_cbranch_scc1 L1F_SEG
L1F_END:
    s_sub_u32 s10, s10, 4
    s_waitcnt vmcnt(0)
    s_barrier
    s_cmp_lg_u32 s9, 0
    s_cbranch_scc1 pb_25
    s_add_u32 s11, s10, 1
    v_mov_b32 v10, s11
    buffer_store_dword v10, off, s[4:7], s60 sc1
pb_25:
    s_branch L1_END
L1_SAFE:
    v_lshrrev_b32 v11, 4, v0
    v_and_b32 v12, 15, v11
    v_lshrrev_b32 v13, 4, v11
    v_lshlrev_b32 v13, 2, v13
    v_add_u32 v14, 0, v13
    v_sub_u32 v15, v12, v14
    v_and_b32 v16, 0xfffffff1, v15
    v_cmp_eq_u32 s[36:37], 0, v16
    v_add_u32 v15, 16, v15
    v_and_b32 v16, 0xfffffff1, v15
    v_cmp_eq_u32 s[28:29], 0, v16
    v_add_u32 v14, 1, v13
    v_sub_u32 v15, v12, v14
    v_and_b32 v16, 0xfffffff1, v15
    v_cmp_eq_u32 s[38:39], 0, v16
    v_add_u32 v15, 16, v15
    v_and_b32 v16, 0xfffffff1, v15
    v_cmp_eq_u32 s[30:31], 0, v16
    v_add_u32 v14, 2, v13
    v_sub_u32 v15, v12, v14
    v_and_b32 v16, 0xfffffff1, v15
    v_cmp_eq_u32 s[40:41], 0, v16
    v_add_u32 v15, 16, v15
    v_and_b32 v16, 0xfffffff1, v15
    v_cmp_eq_u32 s[32:33], 0, v16
    v_add_u32 v14, 3, v13
    v_sub_u32 v15, v12, v14
    v_and_b32 v16, 0xfffffff1, v15
    v_cmp_eq_u32 s[42:43], 0, v16
    v_add_u32 v15, 16, v15
    v_and_b32 v16, 0xfffffff1, v15
    v_cmp_eq_u32 s[34:35], 0, v16
    s_mov_b32 s26, 0x3eb8aa3b
    s_mov_b32 s27, 0xbeb8aa3b
    s_load_dwordx2 s[16:17], s[0:1], 0
    s_mov_b32 s18, 2097152
    s_mov_b32 s19, 0x20000
    s_waitcnt lgkmcnt(0)
    s_mov_b32 s10, 0
    s_mov_b32 s70, 4
    s_cmp_eq_u32 s54, 1
    s_cselect_b32 s10, 16, s10
    s_cselect_b32 s70, 4, s70
    s_cmp_eq_u32 s54, 2
    s_cselect_b32 s10, 32, s10
    s_cselect_b32 s70, 4, s70
    s_cmp_eq_u32 s54, 3
    s_cselect_b32 s10, 48, s10
    s_cselect_b32 s70, 2, s70
    s_cmp_eq_u32 s54, 4
    s_cselect_b32 s10, 56, s10
    s_cselect_b32 s70, 2, s70
    s_add_u32 s10, s10, s53
    s_mov_b32 s56, 0
    s_lshl_b32 s63, s54, 2
    s_add_u32 s63, s63, s53
    s_lshl_b32 s60, s63, 3
    s_add_u32 s60, s60, s55
    s_lshl_b32 s60, s60, 7
    s_add_u32 s60, s60, 65536
    v_lshrrev_b32 v15, 4, v0
    v_and_b32 v16, 3, v15
    v_min_u32 v16, 2, v16
    v_bfe_u32 v15, v15, 2, 3
    s_sub_u32 s11, s70, 1
    v_min_u32 v15, s11, v15
    v_lshlrev_b32 v15, 3, v15
    v_add_u32 v16, v16, v15
    s_lshl_b32 s11, s10, 1
    v_add_u32 v16, s11, v16
    v_max_u32 v16, 1, v16
    v_subrev_u32 v16, 1, v16
    v_lshlrev_b32 v16, 7, v16
    s_mov_b32 s59, 114688
    s_mov_b32 s57, 0
    s_mov_b32 s15, 0
aw_26:
    buffer_load_dword v10, v16, s[4:7], s59 offen sc1
    s_add_u32 s15, s15, 1
    s_cmp_gt_u32 s15, 200000
    s_cbranch_scc1 K_FAIL
    s_waitcnt vmcnt(0)
    v_cmp_ge_u32 vcc, s57, v10
    s_cbranch_vccz awok_27
    s_sleep 1
    s_branch aw_26
awok_27:
    s_mov_b32 s68, 0
    s_mov_b32 s69, 65536
    s_lshl_b32 s61, s10, 15
    s_add_u32 s61, s61, 8388608
    s_lshl_b32 s11, s9, 13
    s_add_u32 s12, s61, s11
    s_add_u32 s11, s11, s68
    s_mov_b32 m0, s11
    s_nop 0
    buffer_load_dwordx4 v0, s[4:7], s12 offen offset:0 sc1 lds
    buffer_load_dwordx4 v0, s[4:7], s12 offen offset:1024 sc1 lds
    buffer_load_dwordx4 v0, s[4:7], s12 offen offset:2048 sc1 lds
    buffer_load_dwordx4 v0, s[4:7], s12 offen offset:3072 sc1 lds
    s_add_u32 s11, s11, 4096
    s_add_u32 s12, s12, 4096
    s_mov_b32 m0, s11
    s_nop 0
    buffer_load_dwordx4 v0, s[4:7], s12 offen offset:0 sc1 lds
    buffer_load_dwordx4 v0, s[4:7], s12 offen offset:1024 sc1 lds
    buffer_load_dwordx4 v0, s[4:7], s12 offen offset:2048 sc1 lds
    buffer_load_dwordx4 v0, s[4:7], s12 offen offset:3072 sc1 lds
    s_cmp_eq_u32 s10, 0
    s_cselect_b32 s11, 0, 32768
    s_sub_u32 s61, s61, s11
    s_lshl_b32 s11, s9, 13
    s_add_u32 s12, s61, s11
    s_add_u32 s12, s12, 256
    s_lshl_b32 s11, s9, 12
    s_add_u32 s11, s11, s69
    s_mov_b32 m0, s11
    s_nop 0
    buffer_load_dwordx4 v1, s[4:7], s12 offen sc1 lds
    s_add_u32 s11, s11, 1024
    s_add_u32 s12, s12, 2048
    s_mov_b32 m0, s11
    s_nop 0
    buffer_load_dwordx4 v1, s[4:7], s12 offen sc1 lds
    s_add_u32 s11, s11, 1024
    s_add_u32 s12, s12, 2048
    s_mov_b32 m0, s11
    s_nop 0
    buffer_load_dwordx4 v1, s[4:7], s12 offen sc1 lds
    s_add_u32 s11, s11, 1024
    s_add_u32 s12, s12, 2048
    s_mov_b32 m0, s11
    s_nop 0
    buffer_load_dwordx4 v1, s[4:7], s12 offen sc1 lds
L1S_SEG:
    s_waitcnt vmcnt(0)
    s_barrier
    s_cmp_eq_u32 s56, 0
    s_cbranch_scc1 dp_28
    s_cmp_lg_u32 s9, 0
    s_cbranch_scc1 dp_28
    s_sub_u32 s11, s10, 3
    v_mov_b32 v10, s11
    buffer_store_dword v10, off, s[4:7], s60 sc1
dp_28:
    s_cmp_eq_u32 s10, 0
    s_cbranch_scc1 nh_29
    v_add_u32 v8, s69, v0
    ds_read_b128 v[128:131], v8 offset:0
    ds_read_b128 v[132:135], v8 offset:1024
    ds_read_b128 v[136:139], v8 offset:2048
    ds_read_b128 v[140:143], v8 offset:3072
    s_waitcnt lgkmcnt(3)
    v_mfma_f32_16x16x32_bf16 v[32:35], a[64:67], v[128:131], 0
    ds_read_b128 v[144:147], v8 offset:4096
    v_mfma_f32_16x16x32_bf16 v[40:43], v[128:131], a[128:131], 0
    s_waitcnt lgkmcnt(3)
    v_mfma_f32_16x16x32_bf16 v[32:35], a[68:71], v[132:135], v[32:35]
    ds_read_b128 v[148:151], v8 offset:5120
    v_mfma_f32_16x16x32_bf16 v[40:43], v[132:135], a[132:135], v[40:43]
    s_waitcnt lgkmcnt(3)
    v_mfma_f32_16x16x32_bf16 v[32:35], a[72:75], v[136:139], v[32:35]
    ds_read_b128 v[128:131], v8 offset:6144
    v_mfma_f32_16x16x32_bf16 v[40:43], v[136:139], a[136:139], v[40:43]
    s_waitcnt lgkmcnt(3)
    v_mfma_f32_16x16x32_bf16 v[32:35], a[76:79], v[140:143], v[32:35]
    ds_read_b128 v[132:135], v8 offset:7168
    v_mfma_f32_16x16x32_bf16 v[40:43], v[140:143], a[140:143], v[40:43]
    s_waitcnt lgkmcnt(3)
    v_mfma_f32_16x16x32_bf16 v[32:35], a[80:83], v[144:147], v[32:35]
    ds_read_b128 v[136:139], v8 offset:8192
    v_mfma_f32_16x16x32_bf16 v[40:43], v[144:147], a[144:147], v[40:43]
    s_waitcnt lgkmcnt(3)
    v_mfma_f32_16x16x32_bf16 v[32:35], a[84:87], v[148:151], v[32:35]
    ds_read_b128 v[140:143], v8 offset:9216
    v_mfma_f32_16x16x32_bf16 v[40:43], v[148:151], a[148:151], v[40:43]
    s_waitcnt lgkmcnt(3)
    v_mfma_f32_16x16x32_bf16 v[32:35], a[88:91], v[128:131], v[32:35]
    ds_read_b128 v[144:147], v8 offset:10240
    v_mfma_f32_16x16x32_bf16 v[40:43], v[128:131], a[152:155], v[40:43]
    s_waitcnt lgkmcnt(3)
    v_mfma_f32_16x16x32_bf16 v[32:35], a[92:95], v[132:135], v[32:35]
    ds_read_b128 v[148:151], v8 offset:11264
    v_mfma_f32_16x16x32_bf16 v[40:43], v[132:135], a[156:159], v[40:43]
    s_waitcnt lgkmcnt(3)
    v_mfma_f32_16x16x32_bf16 v[32:35], a[96:99], v[136:139], v[32:35]
    ds_read_b128 v[128:131], v8 offset:12288
    v_mfma_f32_16x16x32_bf16 v[40:43], v[136:139], a[160:163], v[40:43]
    s_waitcnt lgkmcnt(3)
    v_mfma_f32_16x16x32_bf16 v[32:35], a[100:103], v[140:143], v[32:35]
    ds_read_b128 v[132:135], v8 offset:13312
    v_mfma_f32_16x16x32_bf16 v[40:43], v[140:143], a[164:167], v[40:43]
    s_waitcnt lgkmcnt(3)
    v_mfma_f32_16x16x32_bf16 v[32:35], a[104:107], v[144:147], v[32:35]
    ds_read_b128 v[136:139], v8 offset:14336
    v_mfma_f32_16x16x32_bf16 v[40:43], v[144:147], a[168:171], v[40:43]
    s_waitcnt lgkmcnt(3)
    v_mfma_f32_16x16x32_bf16 v[32:35], a[108:111], v[148:151], v[32:35]
    ds_read_b128 v[140:143], v8 offset:15360
    v_mfma_f32_16x16x32_bf16 v[40:43], v[148:151], a[172:175], v[40:43]
    s_waitcnt lgkmcnt(3)
    v_mfma_f32_16x16x32_bf16 v[32:35], a[112:115], v[128:131], v[32:35]
    v_mfma_f32_16x16x32_bf16 v[40:43], v[128:131], a[176:179], v[40:43]
    s_waitcnt lgkmcnt(2)
    v_mfma_f32_16x16x32_bf16 v[32:35], a[116:119], v[132:135], v[32:35]
    v_mfma_f32_16x16x32_bf16 v[40:43], v[132:135], a[180:183], v[40:43]
    s_waitcnt lgkmcnt(1)
    v_mfma_f32_16x16x32_bf16 v[32:35], a[120:123], v[136:139], v[32:35]
    v_mfma_f32_16x16x32_bf16 v[40:43], v[136:139], a[184:187], v[40:43]
    s_waitcnt lgkmcnt(0)
    v_mfma_f32_16x16x32_bf16 v[32:35], a[124:127], v[140:143], v[32:35]
    v_mfma_f32_16x16x32_bf16 v[40:43], v[140:143], a[188:191], v[40:43]
    s_nop 6
    v_cvt_pk_bf16_f32 v48, v32, v33
    v_cvt_pk_bf16_f32 v49, v34, v35
    v_cvt_pk_bf16_f32 v54, v40, v41
    v_cvt_pk_bf16_f32 v55, v42, v43
    s_branch nh_30
nh_29:
    v_mov_b32 v48, 0
    v_mov_b32 v49, 0
    v_mov_b32 v54, 0
    v_mov_b32 v55, 0
nh_30:
    v_add_u32 v8, s68, v1
    ds_read_b128 v[128:131], v8 offset:0
    ds_read_b128 v[132:135], v8 offset:256
    ds_read_b128 v[136:139], v8 offset:2048
    ds_read_b128 v[140:143], v8 offset:2304
    ds_read_b128 v[144:147], v8 offset:4096
    ds_read_b128 v[148:151], v8 offset:4352
    s_waitcnt lgkmcnt(4)
    v_mfma_f32_16x16x32_bf16 v[20:23], a[0:3], v[128:131], 0
    v_mfma_f32_16x16x32_bf16 v[28:31], a[64:67], v[128:131], 0
    v_mfma_f32_16x16x32_bf16 v[36:39], v[128:131], a[128:131], 0
    v_mfma_f32_16x16x32_bf16 v[24:27], a[0:3], v[132:135], 0
    v_mfma_f32_16x16x32_bf16 v[32:35], a[64:67], v[132:135], 0
    v_mfma_f32_16x16x32_bf16 v[40:43], v[132:135], a[128:131], 0
    ds_read_b128 v[128:131], v8 offset:6144
    ds_read_b128 v[132:135], v8 offset:6400
    s_waitcnt lgkmcnt(4)
    v_mfma_f32_16x16x32_bf16 v[20:23], a[4:7], v[136:139], v[20:23]
    v_mfma_f32_16x16x32_bf16 v[28:31], a[68:71], v[136:139], v[28:31]
    v_mfma_f32_16x16x32_bf16 v[36:39], v[136:139], a[132:135], v[36:39]
    v_mfma_f32_16x16x32_bf16 v[24:27], a[4:7], v[140:143], v[24:27]
    v_mfma_f32_16x16x32_bf16 v[32:35], a[68:71], v[140:143], v[32:35]
    v_mfma_f32_16x16x32_bf16 v[40:43], v[140:143], a[132:135], v[40:43]
    ds_read_b128 v[136:139], v8 offset:8192
    ds_read_b128 v[140:143], v8 offset:8448
    s_waitcnt lgkmcnt(4)
    v_mfma_f32_16x16x32_bf16 v[20:23], a[8:11], v[144:147], v[20:23]
    v_mfma_f32_16x16x32_bf16 v[28:31], a[72:75], v[144:147], v[28:31]
    v_mfma_f32_16x16x32_bf16 v[36:39], v[144:147], a[136:139], v[36:39]
    v_mfma_f32_16x16x32_bf16 v[24:27], a[8:11], v[148:151], v[24:27]
    v_mfma_f32_16x16x32_bf16 v[32:35], a[72:75], v[148:151], v[32:35]
    v_mfma_f32_16x16x32_bf16 v[40:43], v[148:151], a[136:139], v[40:43]
    ds_read_b128 v[144:147], v8 offset:10240
    ds_read_b128 v[148:151], v8 offset:10496
    s_waitcnt lgkmcnt(4)
    v_mfma_f32_16x16x32_bf16 v[20:23], a[12:15], v[128:131], v[20:23]
    v_mfma_f32_16x16x32_bf16 v[28:31], a[76:79], v[128:131], v[28:31]
    v_mfma_f32_16x16x32_bf16 v[36:39], v[128:131], a[140:143], v[36:39]
    v_mfma_f32_16x16x32_bf16 v[24:27], a[12:15], v[132:135], v[24:27]
    v_mfma_f32_16x16x32_bf16 v[32:35], a[76:79], v[132:135], v[32:35]
    v_mfma_f32_16x16x32_bf16 v[40:43], v[132:135], a[140:143], v[40:43]
    ds_read_b128 v[128:131], v8 offset:12288
    ds_read_b128 v[132:135], v8 offset:12544
    s_waitcnt lgkmcnt(4)
    v_mfma_f32_16x16x32_bf16 v[20:23], a[16:19], v[136:139], v[20:23]
    v_mfma_f32_16x16x32_bf16 v[28:31], a[80:83], v[136:139], v[28:31]
    v_mfma_f32_16x16x32_bf16 v[36:39], v[136:139], a[144:147], v[36:39]
    v_mfma_f32_16x16x32_bf16 v[24:27], a[16:19], v[140:143], v[24:27]
    v_mfma_f32_16x16x32_bf16 v[32:35], a[80:83], v[140:143], v[32:35]
    v_mfma_f32_16x16x32_bf16 v[40:43], v[140:143], a[144:147], v[40:43]
    ds_read_b128 v[136:139], v8 offset:14336
    ds_read_b128 v[140:143], v8 offset:14592
    s_waitcnt lgkmcnt(4)
    v_mfma_f32_16x16x32_bf16 v[20:23], a[20:23], v[144:147], v[20:23]
    v_mfma_f32_16x16x32_bf16 v[28:31], a[84:87], v[144:147], v[28:31]
    v_mfma_f32_16x16x32_bf16 v[36:39], v[144:147], a[148:151], v[36:39]
    v_mfma_f32_16x16x32_bf16 v[24:27], a[20:23], v[148:151], v[24:27]
    v_mfma_f32_16x16x32_bf16 v[32:35], a[84:87], v[148:151], v[32:35]
    v_mfma_f32_16x16x32_bf16 v[40:43], v[148:151], a[148:151], v[40:43]
    ds_read_b128 v[144:147], v8 offset:16384
    ds_read_b128 v[148:151], v8 offset:16640
    s_waitcnt lgkmcnt(4)
    v_mfma_f32_16x16x32_bf16 v[20:23], a[24:27], v[128:131], v[20:23]
    v_mfma_f32_16x16x32_bf16 v[28:31], a[88:91], v[128:131], v[28:31]
    v_mfma_f32_16x16x32_bf16 v[36:39], v[128:131], a[152:155], v[36:39]
    v_mfma_f32_16x16x32_bf16 v[24:27], a[24:27], v[132:135], v[24:27]
    v_mfma_f32_16x16x32_bf16 v[32:35], a[88:91], v[132:135], v[32:35]
    v_mfma_f32_16x16x32_bf16 v[40:43], v[132:135], a[152:155], v[40:43]
    ds_read_b128 v[128:131], v8 offset:18432
    ds_read_b128 v[132:135], v8 offset:18688
    s_waitcnt lgkmcnt(4)
    v_mfma_f32_16x16x32_bf16 v[20:23], a[28:31], v[136:139], v[20:23]
    v_mfma_f32_16x16x32_bf16 v[28:31], a[92:95], v[136:139], v[28:31]
    v_mfma_f32_16x16x32_bf16 v[36:39], v[136:139], a[156:159], v[36:39]
    v_mfma_f32_16x16x32_bf16 v[24:27], a[28:31], v[140:143], v[24:27]
    v_mfma_f32_16x16x32_bf16 v[32:35], a[92:95], v[140:143], v[32:35]
    v_mfma_f32_16x16x32_bf16 v[40:43], v[140:143], a[156:159], v[40:43]
    ds_read_b128 v[136:139], v8 offset:20480
    ds_read_b128 v[140:143], v8 offset:20736
    s_waitcnt lgkmcnt(4)
    v_mfma_f32_16x16x32_bf16 v[20:23], a[32:35], v[144:147], v[20:23]
    v_mfma_f32_16x16x32_bf16 v[28:31], a[96:99], v[144:147], v[28:31]
    v_mfma_f32_16x16x32_bf16 v[36:39], v[144:147], a[160:163], v[36:39]
    v_mfma_f32_16x16x32_bf16 v[24:27], a[32:35], v[148:151], v[24:27]
    v_mfma_f32_16x16x32_bf16 v[32:35], a[96:99], v[148:151], v[32:35]
    v_mfma_f32_16x16x32_bf16 v[40:43], v[148:151], a[160:163], v[40:43]
    ds_read_b128 v[144:147], v8 offset:22528
    ds_read_b128 v[148:151], v8 offset:22784
    s_waitcnt lgkmcnt(4)
    v_mfma_f32_16x16x32_bf16 v[20:23], a[36:39], v[128:131], v[20:23]
    v_mfma_f32_16x16x32_bf16 v[28:31], a[100:103], v[128:131], v[28:31]
    v_mfma_f32_16x16x32_bf16 v[36:39], v[128:131], a[164:167], v[36:39]
    v_mfma_f32_16x16x32_bf16 v[24:27], a[36:39], v[132:135], v[24:27]
    v_mfma_f32_16x16x32_bf16 v[32:35], a[100:103], v[132:135], v[32:35]
    v_mfma_f32_16x16x32_bf16 v[40:43], v[132:135], a[164:167], v[40:43]
    ds_read_b128 v[128:131], v8 offset:24576
    ds_read_b128 v[132:135], v8 offset:24832
    s_waitcnt lgkmcnt(4)
    v_mfma_f32_16x16x32_bf16 v[20:23], a[40:43], v[136:139], v[20:23]
    v_mfma_f32_16x16x32_bf16 v[28:31], a[104:107], v[136:139], v[28:31]
    v_mfma_f32_16x16x32_bf16 v[36:39], v[136:139], a[168:171], v[36:39]
    v_mfma_f32_16x16x32_bf16 v[24:27], a[40:43], v[140:143], v[24:27]
    v_mfma_f32_16x16x32_bf16 v[32:35], a[104:107], v[140:143], v[32:35]
    v_mfma_f32_16x16x32_bf16 v[40:43], v[140:143], a[168:171], v[40:43]
    ds_read_b128 v[136:139], v8 offset:26624
    ds_read_b128 v[140:143], v8 offset:26880
    s_waitcnt lgkmcnt(4)
    v_mfma_f32_16x16x32_bf16 v[20:23], a[44:47], v[144:147], v[20:23]
    v_mfma_f32_16x16x32_bf16 v[28:31], a[108:111], v[144:147], v[28:31]
    v_mfma_f32_16x16x32_bf16 v[36:39], v[144:147], a[172:175], v[36:39]
    v_mfma_f32_16x16x32_bf16 v[24:27], a[44:47], v[148:151], v[24:27]
    v_mfma_f32_16x16x32_bf16 v[32:35], a[108:111], v[148:151], v[32:35]
    v_mfma_f32_16x16x32_bf16 v[40:43], v[148:151], a[172:175], v[40:43]
    ds_read_b128 v[144:147], v8 offset:28672
    ds_read_b128 v[148:151], v8 offset:28928
    s_waitcnt lgkmcnt(4)
    v_mfma_f32_16x16x32_bf16 v[20:23], a[48:51], v[128:131], v[20:23]
    v_mfma_f32_16x16x32_bf16 v[28:31], a[112:115], v[128:131], v[28:31]
    v_mfma_f32_16x16x32_bf16 v[36:39], v[128:131], a[176:179], v[36:39]
    v_mfma_f32_16x16x32_bf16 v[24:27], a[48:51], v[132:135], v[24:27]
    v_mfma_f32_16x16x32_bf16 v[32:35], a[112:115], v[132:135], v[32:35]
    v_mfma_f32_16x16x32_bf16 v[40:43], v[132:135], a[176:179], v[40:43]
    ds_read_b128 v[128:131], v8 offset:30720
    ds_read_b128 v[132:135], v8 offset:30976
    s_waitcnt lgkmcnt(4)
    v_mfma_f32_16x16x32_bf16 v[20:23], a[52:55], v[136:139], v[20:23]
    v_mfma_f32_16x16x32_bf16 v[28:31], a[116:119], v[136:139], v[28:31]
    v_mfma_f32_16x16x32_bf16 v[36:39], v[136:139], a[180:183], v[36:39]
    v_mfma_f32_16x16x32_bf16 v[24:27], a[52:55], v[140:143], v[24:27]
    v_mfma_f32_16x16x32_bf16 v[32:35], a[116:119], v[140:143], v[32:35]
    v_mfma_f32_16x16x32_bf16 v[40:43], v[140:143], a[180:183], v[40:43]
    s_waitcnt lgkmcnt(2)
    v_mfma_f32_16x16x32_bf16 v[20:23], a[56:59], v[144:147], v[20:23]
    v_mfma_f32_16x16x32_bf16 v[28:31], a[120:123], v[144:147], v[28:31]
    v_mfma_f32_16x16x32_bf16 v[36:39], v[144:147], a[184:187], v[36:39]
    v_mfma_f32_16x16x32_bf16 v[24:27], a[56:59], v[148:151], v[24:27]
    v_mfma_f32_16x16x32_bf16 v[32:35], a[120:123], v[148:151], v[32:35]
    v_mfma_f32_16x16x32_bf16 v[40:43], v[148:151], a[184:187], v[40:43]
    s_waitcnt lgkmcnt(0)
    v_mfma_f32_16x16x32_bf16 v[20:23], a[60:63], v[128:131], v[20:23]
    v_mfma_f32_16x16x32_bf16 v[28:31], a[124:127], v[128:131], v[28:31]
    v_mfma_f32_16x16x32_bf16 v[36:39], v[128:131], a[188:191], v[36:39]
    v_mfma_f32_16x16x32_bf16 v[24:27], a[60:63], v[132:135], v[24:27]
    v_mfma_f32_16x16x32_bf16 v[32:35], a[124:127], v[132:135], v[32:35]
    v_mfma_f32_16x16x32_bf16 v[40:43], v[132:135], a[188:191], v[40:43]
    s_nop 2
    v_cvt_pk_bf16_f32 v44, v20, v21
    v_cvt_pk_bf16_f32 v45, v22, v23
    v_cvt_pk_bf16_f32 v50, v28, v29
    v_cvt_pk_bf16_f32 v51, v30, v31
    v_cvt_pk_bf16_f32 v56, v36, v37
    v_cvt_pk_bf16_f32 v57, v38, v39
    v_cvt_pk_bf16_f32 v46, v24, v25
    v_cvt_pk_bf16_f32 v47, v26, v27
    v_cvt_pk_bf16_f32 v52, v32, v33
    v_cvt_pk_bf16_f32 v53, v34, v35
    v_cvt_pk_bf16_f32 v58, v40, v41
    v_cvt_pk_bf16_f32 v59, v42, v43
    v_mfma_f32_16x16x16_bf16 v[60:63], v[48:49], v[44:45], 0
    v_mfma_f32_16x16x16_bf16 v[64:67], v[50:51], v[44:45], 0
    v_mfma_f32_16x16x16_bf16 v[84:87], v[50:51], v[46:47], 0
    v_mfma_f32_16x16x16_bf16 v[88:91], v[52:53], v[46:47], 0
    s_cmp_eq_u32 s10, 0
    s_cselect_b64 s[44:45], 0, s[28:29]
    s_cselect_b64 s[46:47], 0, s[30:31]
    s_cselect_b64 s[48:49], 0, s[32:33]
    s_cselect_b64 s[50:51], 0, s[34:35]
    v_mov_b32 v11, 0xf149f2ca
    v_cndmask_b32 v60, v11, v60, s[44:45]
    v_cndmask_b32 v84, v11, v84, s[28:29]
    v_cndmask_b32 v61, v11, v61, s[46:47]
    v_cndmask_b32 v85, v11, v85, s[30:31]
    v_cndmask_b32 v62, v11, v62, s[48:49]
    v_cndmask_b32 v86, v11, v86, s[32:33]
    v_cndmask_b32 v63, v11, v63, s[50:51]
    v_cndmask_b32 v87, v11, v87, s[34:35]
    v_cndmask_b32 v64, v11, v64, s[36:37]
    v_cndmask_b32 v88, v11, v88, s[36:37]
    v_cndmask_b32 v65, v11, v65, s[38:39]
    v_cndmask_b32 v89, v11, v89, s[38:39]
    v_cndmask_b32 v66, v11, v66, s[40:41]
    v_cndmask_b32 v90, v11, v90, s[40:41]
    v_cndmask_b32 v67, v11, v67, s[42:43]
    v_cndmask_b32 v91, v11, v91, s[42:43]
    v_max3_f32 v12, v60, v61, v62
    v_max3_f32 v92, v84, v85, v86
    v_max3_f32 v13, v63, v64, v65
    v_max3_f32 v93, v87, v88, v89
    v_max3_f32 v12, v12, v66, v67
    v_max3_f32 v92, v92, v90, v91
    v_max_f32 v12, v12, v13
    v_max_f32 v92, v92, v93
    v_mov_b32 v13, v12
    v_mov_b32 v93, v92
    s_nop 0
    v_permlane16_swap_b32 v12, v13
    v_permlane16_swap_b32 v92, v93
    v_max_f32 v12, v12, v13
    v_max_f32 v92, v92, v93
    v_mov_b32 v13, v12
    v_mov_b32 v93, v92
    s_nop 0
    v_permlane32_swap_b32 v12, v13
    v_permlane32_swap_b32 v92, v93
    v_max_f32 v12, v12, v13
    v_max_f32 v92, v92, v93
    v_mul_f32 v12, s27, v12
    v_mul_f32 v92, s27, v92
    v_fma_f32 v60, v60, s26, v12
    v_fma_f32 v84, v84, s26, v92
    v_fma_f32 v61, v61, s26, v12
    v_fma_f32 v85, v85, s26, v92
    v_fma_f32 v62, v62, s26, v12
    v_fma_f32 v86, v86, s26, v92
    v_fma_f32 v63, v63, s26, v12
    v_fma_f32 v87, v87, s26, v92
    v_fma_f32 v64, v64, s26, v12
    v_fma_f32 v88, v88, s26, v92
    v_fma_f32 v65, v65, s26, v12
    v_fma_f32 v89, v89, s26, v92
    v_fma_f32 v66, v66, s26, v12
    v_fma_f32 v90, v90, s26, v92
    v_fma_f32 v67, v67, s26, v12
    v_fma_f32 v91, v91, s26, v92
    v_exp_f32 v60, v60
    v_exp_f32 v84, v84
    v_exp_f32 v61, v61
    v_exp_f32 v85, v85
    v_exp_f32 v62, v62
    v_exp_f32 v86, v86
    v_exp_f32 v63, v63
    v_exp_f32 v87, v87
    v_exp_f32 v64, v64
    v_exp_f32 v88, v88
    v_exp_f32 v65, v65
    v_exp_f32 v89, v89
    v_exp_f32 v66, v66
    v_exp_f32 v90, v90
    v_exp_f32 v67, v67
    v_exp_f32 v91, v91
    v_cvt_pk_bf16_f32 v68, v60, v61
    v_cvt_pk_bf16_f32 v96, v84, v85
    v_cvt_pk_bf16_f32 v69, v62, v63
    v_cvt_pk_bf16_f32 v97, v86, v87
    v_cvt_pk_bf16_f32 v70, v64, v65
    v_cvt_pk_bf16_f32 v98, v88, v89
    v_cvt_pk_bf16_f32 v71, v66, v67
    v_cvt_pk_bf16_f32 v99, v90, v91
    s_nop 0
    v_mfma_f32_16x16x32_bf16 v[72:75], v[54:57], v[68:71], 0
    v_mfma_f32_16x16x32_bf16 v[76:79], v[56:59], v[96:99], 0
    v_add_f32 v12, v60, v61
    v_add_f32 v92, v84, v85
    v_add_f32 v13, v62, v63
    v_add_f32 v93, v86, v87
    v_add_f32 v14, v64, v65
    v_add_f32 v94, v88, v89
    v_add_f32 v15, v66, v67
    v_add_f32 v95, v90, v91
    v_add_f32 v12, v12, v13
    v_add_f32 v92, v92, v93
    v_add_f32 v14, v14, v15
    v_add_f32 v94, v94, v95
    v_add_f32 v12, v12, v14
    v_add_f32 v92, v92, v94
    v_mov_b32 v13, v12
    v_mov_b32 v93, v92
    s_nop 0
    v_permlane16_swap_b32 v12, v13
    v_permlane16_swap_b32 v92, v93
    v_add_f32 v12, v12, v13
    v_add_f32 v92, v92, v93
    v_mov_b32 v13, v12
    v_mov_b32 v93, v92
    s_nop 0
    v_permlane32_swap_b32 v12, v13
    v_permlane32_swap_b32 v92, v93
    v_add_f32 v12, v12, v13
    v_add_f32 v92, v92, v93
    v_rcp_f32 v12, v12
    v_rcp_f32 v92, v92
    v_mul_f32 v72, v72, v12
    v_mul_f32 v76, v76, v92
    v_mul_f32 v73, v73, v12
    v_mul_f32 v77, v77, v92
    v_mul_f32 v74, v74, v12
    v_mul_f32 v78, v78, v92
    v_mul_f32 v75, v75, v12
    v_mul_f32 v79, v79, v92
    v_permlane16_swap_b32 v72, v76
    v_permlane16_swap_b32 v73, v77
    v_permlane16_swap_b32 v74, v78
    v_permlane16_swap_b32 v75, v79
    v_cvt_pk_bf16_f32 v80, v72, v73
    v_cvt_pk_bf16_f32 v81, v74, v75
    v_cvt_pk_bf16_f32 v82, v76, v77
    v_cvt_pk_bf16_f32 v83, v78, v79
    s_lshl_b32 s11, s10, 15
    s_add_u32 s11, s11, 10485760
    s_lshl_b32 s14, s8, 10
    s_add_u32 s11, s11, s14
    buffer_store_dwordx4 v[80:83], v0, s[4:7], s11 offen sc1
    s_add_u32 s59, s63, 0
    s_lshl_b32 s59, s59, 7
    s_add_u32 s59, s59, 98304
    s_lshl_b32 s14, s55, 2
    s_add_u32 s59, s59, s14
    s_waitcnt vmcnt(0)
    s_barrier
    s_cmp_lg_u32 s9, 0
    s_cbranch_scc1 pb_31
    s_add_u32 s11, s10, 1
    v_mov_b32 v10, s11
    buffer_store_dword v10, off, s[4:7], s59 sc1
pb_31:
    s_xor_b32 s68, s68, 116736
    s_xor_b32 s69, s69, 18432
    s_add_u32 s59, s63, 0
    s_lshl_b32 s59, s59, 7
    s_add_u32 s59, s59, 98304
    s_mov_b32 s15, 0
aw_32:
    buffer_load_dword v10, v2, s[4:7], s59 offen sc1
    s_add_u32 s15, s15, 1
    s_cmp_gt_u32 s15, 200000
    s_cbranch_scc1 K_FAIL
    s_waitcnt vmcnt(0)
    v_cmp_ge_u32 vcc, s10, v10
    s_cbranch_vccz awok_33
    s_sleep 1
    s_branch aw_32
awok_33:
    s_lshl_b32 s61, s10, 15
    s_add_u32 s61, s61, 10485760
    s_lshl_b32 s11, s9, 13
    s_add_u32 s12, s61, s11
    s_add_u32 s11, s11, 32768
    s_mov_b32 m0, s11
    s_nop 0
    buffer_load_dwordx4 v0, s[4:7], s12 offen offset:0 sc1 lds
    buffer_load_dwordx4 v0, s[4:7], s12 offen offset:1024 sc1 lds
    buffer_load_dwordx4 v0, s[4:7], s12 offen offset:2048 sc1 lds
    buffer_load_dwordx4 v0, s[4:7], s12 offen offset:3072 sc1 lds
    s_add_u32 s11, s11, 4096
    s_add_u32 s12, s12, 4096
    s_mov_b32 m0, s11
    s_nop 0
    buffer_load_dwordx4 v0, s[4:7], s12 offen offset:0 sc1 lds
    buffer_load_dwordx4 v0, s[4:7], s12 offen offset:1024 sc1 lds
    buffer_load_dwordx4 v0, s[4:7], s12 offen offset:2048 sc1 lds
    buffer_load_dwordx4 v0, s[4:7], s12 offen offset:3072 sc1 lds
    s_lshl_b32 s11, s10, 15
    buffer_load_dwordx4 v[28:31], v3, s[16:19], s11 offen
    s_add_u32 s11, s56, 1
    s_cmp_ge_u32 s11, s70
    s_cbranch_scc1 nf_34
    s_add_u32 s57, s10, 4
    s_lshl_b32 s61, s57, 15
    s_add_u32 s61, s61, 8388608
    s_lshl_b32 s11, s9, 13
    s_add_u32 s12, s61, s11
    s_add_u32 s11, s11, s68
    s_mov_b32 m0, s11
    s_nop 0
    buffer_load_dwordx4 v0, s[4:7], s12 offen offset:0 sc1 lds
    buffer_load_dwordx4 v0, s[4:7], s12 offen offset:1024 sc1 lds
    buffer_load_dwordx4 v0, s[4:7], s12 offen offset:2048 sc1 lds
    buffer_load_dwordx4 v0, s[4:7], s12 offen offset:3072 sc1 lds
    s_add_u32 s11, s11, 4096
    s_add_u32 s12, s12, 4096
    s_mov_b32 m0, s11
    s_nop 0
    buffer_load_dwordx4 v0, s[4:7], s12 offen offset:0 sc1 lds
    buffer_load_dwordx4 v0, s[4:7], s12 offen offset:1024 sc1 lds
    buffer_load_dwordx4 v0, s[4:7], s12 offen offset:2048 sc1 lds
    buffer_load_dwordx4 v0, s[4:7], s12 offen offset:3072 sc1 lds
    s_cmp_eq_u32 s57, 0
    s_cselect_b32 s11, 0, 32768
    s_sub_u32 s61, s61, s11
    s_lshl_b32 s11, s9, 13
    s_add_u32 s12, s61, s11
    s_add_u32 s12, s12, 256
    s_lshl_b32 s11, s9, 12
    s_add_u32 s11, s11, s69
    s_mov_b32 m0, s11
    s_nop 0
    buffer_load_dwordx4 v1, s[4:7], s12 offen sc1 lds
    s_add_u32 s11, s11, 1024
    s_add_u32 s12, s12, 2048
    s_mov_b32 m0, s11
    s_nop 0
    buffer_load_dwordx4 v1, s[4:7], s12 offen sc1 lds
    s_add_u32 s11, s11, 1024
    s_add_u32 s12, s12, 2048
    s_mov_b32 m0, s11
    s_nop 0
    buffer_load_dwordx4 v1, s[4:7], s12 offen sc1 lds
    s_add_u32 s11, s11, 1024
    s_add_u32 s12, s12, 2048
    s_mov_b32 m0, s11
    s_nop 0
    buffer_load_dwordx4 v1, s[4:7], s12 offen sc1 lds
    s_waitcnt vmcnt(12)
    s_branch nf_35
nf_34:
    s_waitcnt vmcnt(0)
nf_35:
    s_barrier
    v_add_u32 v8, 32768, v1
    ds_read_b128 v[128:131], v8 offset:0
    ds_read_b128 v[132:135], v8 offset:256
    ds_read_b128 v[136:139], v8 offset:2048
    ds_read_b128 v[140:143], v8 offset:2304
    ds_read_b128 v[144:147], v8 offset:4096
    ds_read_b128 v[148:151], v8 offset:4352
    s_waitcnt lgkmcnt(4)
    v_mfma_f32_16x16x32_bf16 v[112:115], a[192:195], v[128:131], 0
    v_mfma_f32_16x16x32_bf16 v[116:119], a[192:195], v[132:135], 0
    ds_read_b128 v[128:131], v8 offset:6144
    ds_read_b128 v[132:135], v8 offset:6400
    s_waitcnt lgkmcnt(4)
    v_mfma_f32_16x16x32_bf16 v[112:115], a[196:199], v[136:139], v[112:115]
    v_mfma_f32_16x16x32_bf16 v[116:119], a[196:199], v[140:143], v[116:119]
    ds_read_b128 v[136:139], v8 offset:8192
    ds_read_b128 v[140:143], v8 offset:8448
    s_waitcnt lgkmcnt(4)
    v_mfma_f32_16x16x32_bf16 v[112:115], a[200:203], v[144:147], v[112:115]
    v_mfma_f32_16x16x32_bf16 v[116:119], a[200:203], v[148:151], v[116:119]
    ds_read_b128 v[144:147], v8 offset:10240
    ds_read_b128 v[148:151], v8 offset:10496
    s_waitcnt lgkmcnt(4)
    v_mfma_f32_16x16x32_bf16 v[112:115], a[204:207], v[128:131], v[112:115]
    v_mfma_f32_16x16x32_bf16 v[116:119], a[204:207], v[132:135], v[116:119]
    ds_read_b128 v[128:131], v8 offset:12288
    ds_read_b128 v[132:135], v8 offset:12544
    s_waitcnt lgkmcnt(4)
    v_mfma_f32_16x16x32_bf16 v[112:115], a[208:211], v[136:139], v[112:115]
    v_mfma_f32_16x16x32_bf16 v[116:119], a[208:211], v[140:143], v[116:119]
    ds_read_b128 v[136:139], v8 offset:14336
    ds_read_b128 v[140:143], v8 offset:14592
    s_waitcnt lgkmcnt(4)
    v_mfma_f32_16x16x32_bf16 v[112:115], a[212:215], v[144:147], v[112:115]
    v_mfma_f32_16x16x32_bf16 v[116:119], a[212:215], v[148:151], v[116:119]
    ds_read_b128 v[144:147], v8 offset:16384
    ds_read_b128 v[148:151], v8 offset:16640
    s_waitcnt lgkmcnt(4)
    v_mfma_f32_16x16x32_bf16 v[112:115], a[216:219], v[128:131], v[112:115]
    v_mfma_f32_16x16x32_bf16 v[116:119], a[216:219], v[132:135], v[116:119]
    ds_read_b128 v[128:131], v8 offset:18432
    ds_read_b128 v[132:135], v8 offset:18688
    s_waitcnt lgkmcnt(4)
    v_mfma_f32_16x16x32_bf16 v[112:115], a[220:223], v[136:139], v[112:115]
    v_mfma_f32_16x16x32_bf16 v[116:119], a[220:223], v[140:143], v[116:119]
    ds_read_b128 v[136:139], v8 offset:20480
    ds_read_b128 v[140:143], v8 offset:20736
    s_waitcnt lgkmcnt(4)
    v_mfma_f32_16x16x32_bf16 v[112:115], a[224:227], v[144:147], v[112:115]
    v_mfma_f32_16x16x32_bf16 v[116:119], a[224:227], v[148:151], v[116:119]
    ds_read_b128 v[144:147], v8 offset:22528
    ds_read_b128 v[148:151], v8 offset:22784
    s_waitcnt lgkmcnt(4)
    v_mfma_f32_16x16x32_bf16 v[112:115], a[228:231], v[128:131], v[112:115]
    v_mfma_f32_16x16x32_bf16 v[116:119], a[228:231], v[132:135], v[116:119]
    ds_read_b128 v[128:131], v8 offset:24576
    ds_read_b128 v[132:135], v8 offset:24832
    s_waitcnt lgkmcnt(4)
    v_mfma_f32_16x16x32_bf16 v[112:115], a[232:235], v[136:139], v[112:115]
    v_mfma_f32_16x16x32_bf16 v[116:119], a[232:235], v[140:143], v[116:119]
    ds_read_b128 v[136:139], v8 offset:26624
    ds_read_b128 v[140:143], v8 offset:26880
    s_waitcnt lgkmcnt(4)
    v_mfma_f32_16x16x32_bf16 v[112:115], a[236:239], v[144:147], v[112:115]
    v_mfma_f32_16x16x32_bf16 v[116:119], a[236:239], v[148:151], v[116:119]
    ds_read_b128 v[144:147], v8 offset:28672
    ds_read_b128 v[148:151], v8 offset:28928
    s_waitcnt lgkmcnt(4)
    v_mfma_f32_16x16x32_bf16 v[112:115], a[240:243], v[128:131], v[112:115]
    v_mfma_f32_16x16x32_bf16 v[116:119], a[240:243], v[132:135], v[116:119]
    ds_read_b128 v[128:131], v8 offset:30720
    ds_read_b128 v[132:135], v8 offset:30976
    s_waitcnt lgkmcnt(4)
    v_mfma_f32_16x16x32_bf16 v[112:115], a[244:247], v[136:139], v[112:115]
    v_mfma_f32_16x16x32_bf16 v[116:119], a[244:247], v[140:143], v[116:119]
    s_waitcnt lgkmcnt(2)
    v_mfma_f32_16x16x32_bf16 v[112:115], a[248:251], v[144:147], v[112:115]
    v_mfma_f32_16x16x32_bf16 v[116:119], a[248:251], v[148:151], v[116:119]
    s_waitcnt lgkmcnt(0)
    v_mfma_f32_16x16x32_bf16 v[112:115], a[252:255], v[128:131], v[112:115]
    v_mfma_f32_16x16x32_bf16 v[116:119], a[252:255], v[132:135], v[116:119]
    s_nop 7
    v_permlane16_swap_b32 v112, v116
    v_permlane16_swap_b32 v113, v117
    v_permlane16_swap_b32 v114, v118
    v_permlane16_swap_b32 v115, v119
    v_mov_b32 v20, v112
    v_mov_b32 v24, v116
    v_mov_b32 v21, v113
    v_mov_b32 v25, v117
    v_mov_b32 v22, v114
    v_mov_b32 v26, v118
    v_mov_b32 v23, v115
    v_mov_b32 v27, v119
    v_cvt_pk_bf16_f32 v40, v20, v21
    v_cvt_pk_bf16_f32 v41, v22, v23
    v_cvt_pk_bf16_f32 v42, v24, v25
    v_cvt_pk_bf16_f32 v43, v26, v27
    v_lshlrev_b32 v20, 16, v40
    v_and_b32 v21, 0xffff0000, v40
    v_lshlrev_b32 v22, 16, v41
    v_and_b32 v23, 0xffff0000, v41
    v_lshlrev_b32 v24, 16, v42
    v_and_b32 v25, 0xffff0000, v42
    v_lshlrev_b32 v26, 16, v43
    v_and_b32 v27, 0xffff0000, v43
    v_lshlrev_b32 v32, 16, v28
    v_and_b32 v33, 0xffff0000, v28
    v_lshlrev_b32 v34, 16, v29
    v_and_b32 v35, 0xffff0000, v29
    v_lshlrev_b32 v36, 16, v30
    v_and_b32 v37, 0xffff0000, v30
    v_lshlrev_b32 v38, 16, v31
    v_and_b32 v39, 0xffff0000, v31
    v_add_f32 v20, v20, v32
    v_add_f32 v21, v21, v33
    v_add_f32 v22, v22, v34
    v_add_f32 v23, v23, v35
    v_add_f32 v24, v24, v36
    v_add_f32 v25, v25, v37
    v_add_f32 v26, v26, v38
    v_add_f32 v27, v27, v39
    v_cvt_pk_bf16_f32 v40, v20, v21
    v_cvt_pk_bf16_f32 v41, v22, v23
    v_cvt_pk_bf16_f32 v42, v24, v25
    v_cvt_pk_bf16_f32 v43, v26, v27
    v_lshlrev_b32 v32, 16, v40
    v_and_b32 v33, 0xffff0000, v40
    v_lshlrev_b32 v34, 16, v41
    v_and_b32 v35, 0xffff0000, v41
    v_lshlrev_b32 v36, 16, v42
    v_and_b32 v37, 0xffff0000, v42
    v_lshlrev_b32 v38, 16, v43
    v_and_b32 v39, 0xffff0000, v43
    v_mov_b32 v100, v40
    v_mov_b32 v101, v41
    v_mov_b32 v102, v42
    v_mov_b32 v103, v43
    v_add_f32 v44, v32, v33
    v_mul_f32 v45, v32, v32
    v_add_f32 v12, v34, v35
    v_fmac_f32 v45, v33, v33
    v_add_f32 v13, v36, v37
    v_mul_f32 v15, v34, v34
    v_add_f32 v14, v38, v39
    v_fmac_f32 v15, v35, v35
    v_add_f32 v44, v44, v12
    v_fmac_f32 v45, v36, v36
    v_add_f32 v13, v13, v14
    v_fmac_f32 v15, v37, v37
    v_add_f32 v44, v44, v13
    v_fmac_f32 v45, v38, v38
    v_fmac_f32 v15, v39, v39
    v_add_f32 v45, v45, v15
    v_mov_b32 v12, v44
    v_mov_b32 v13, v45
    s_nop 0
    v_permlane32_swap_b32 v44, v12
    v_permlane32_swap_b32 v45, v13
    v_add_f32 v44, v44, v12
    v_add_f32 v45, v45, v13
    v_lshrrev_b32 v14, 1, v0
    v_and_b32 v14, 0xff, v14
    s_lshl_b32 s11, s9, 8
    s_add_u32 s11, s11, 81920
    v_add_u32 v15, s11, v14
    ds_write_b64 v15, v[44:45]
    s_waitcnt lgkmcnt(0)
    s_barrier
    v_add_u32 v14, 81920, v14
    ds_read_b64 v[104:105], v14 offset:0
    ds_read_b64 v[106:107], v14 offset:256
    ds_read_b64 v[108:109], v14 offset:512
    ds_read_b64 v[110:111], v14 offset:768
    s_add_u32 s11, s56, 0
    s_and_b32 s11, s11, 3
    s_lshl_b32 s14, s63, 2
    s_add_u32 s11, s11, s14
    s_lshl_b32 s11, s11, 11
    s_add_u32 s11, s11, 2162688
    s_add_u32 s12, s56, 0
    s_and_b32 s12, s12, 3
    s_lshl_b32 s14, s63, 2
    s_add_u32 s12, s12, s14
    s_lshl_b32 s12, s12, 11
    s_add_u32 s12, s12, 2162688
    s_mov_b32 s13, s11
    s_waitcnt lgkmcnt(0)
    v_add_f32 v104, v104, v106
    v_add_f32 v105, v105, v107
    v_add_f32 v108, v108, v110
    v_add_f32 v109, v109, v111
    v_add_f32 v44, v104, v108
    v_add_f32 v45, v105, v109
    s_cmp_lg_u32 s9, 0
    s_cbranch_scc1 lnp_36
    s_mov_b64 exec, s[24:25]
    buffer_store_dwordx2 v[44:45], v4, s[4:7], s11 offen sc1
    s_mov_b64 exec, -1
lnp_36:
    s_mov_b32 s15, 0
sg_37:
    buffer_load_dwordx4 v[104:107], v0, s[4:7], s13 offen offset:0 sc1
    buffer_load_dwordx4 v[108:111], v0, s[4:7], s13 offen offset:1024 sc1
    s_add_u32 s15, s15, 1
    s_cmp_gt_u32 s15, 200000
    s_cbranch_scc1 K_FAIL
    s_waitcnt vmcnt(0)
    v_add_f32 v104, v104, v108
    v_add_f32 v105, v105, v109
    v_add_f32 v106, v106, v110
    v_add_f32 v107, v107, v111
    v_add_f32 v44, v104, v106
    v_add_f32 v45, v105, v107
    v_cmp_u_f32 vcc, v44, v45
    s_cbranch_vccz sgok_38
    s_branch sg_37
sgok_38:
    s_cmp_lg_u32 s9, 0
    s_cbranch_scc1 lnr_39
    s_add_u32 s11, s56, 3
    s_and_b32 s11, s11, 3
    s_lshl_b32 s14, s63, 2
    s_add_u32 s11, s11, s14
    s_lshl_b32 s11, s11, 11
    s_add_u32 s11, s11, 2162688
    s_mov_b64 exec, s[24:25]
    buffer_store_dwordx2 v[18:19], v4, s[4:7], s11 offen sc1
    s_mov_b64 exec, -1
lnr_39:
    v_mov_b32 v12, v44
    v_mov_b32 v13, v45
    s_nop 0
    v_permlane32_swap_b32 v44, v12
    v_permlane32_swap_b32 v45, v13
    v_add_f32 v44, v44, v12
    v_add_f32 v45, v45, v13
    v_mul_f32 v44, 0x3b000000, v44
    v_mul_f32 v45, 0x3b000000, v45
    v_fma_f32 v45, -v44, v44, v45
    v_max_f32 v45, 0, v45
    v_add_f32 v45, 0x3727c5ac, v45
    v_rsq_f32 v45, v45
    v_sub_f32 v32, v32, v44
    v_sub_f32 v33, v33, v44
    v_sub_f32 v34, v34, v44
    v_sub_f32 v35, v35, v44
    v_sub_f32 v36, v36, v44
    v_sub_f32 v37, v37, v44
    v_sub_f32 v38, v38, v44
    v_sub_f32 v39, v39, v44
    v_mul_f32 v32, v32, v45
    v_mul_f32 v33, v33, v45
    v_mul_f32 v34, v34, v45
    v_mul_f32 v35, v35, v45
    v_mul_f32 v36, v36, v45
    v_mul_f32 v37, v37, v45
    v_mul_f32 v38, v38, v45
    v_mul_f32 v39, v39, v45
    v_cvt_pk_bf16_f32 v40, v32, v33
    v_cvt_pk_bf16_f32 v41, v34, v35
    v_cvt_pk_bf16_f32 v42, v36, v37
    v_cvt_pk_bf16_f32 v43, v38, v39
    s_lshl_b32 s11, s10, 15
    s_add_u32 s11, s11, 6291456
    s_lshl_b32 s14, s8, 10
    s_add_u32 s11, s11, s14
    buffer_store_dwordx4 v[40:43], v0, s[4:7], s11 offen sc1
    s_lshl_b32 s11, s10, 15
    s_add_u32 s11, s11, 4194304
    s_lshl_b32 s14, s8, 10
    s_add_u32 s11, s11, s14
    buffer_store_dwordx4 v[100:103], v0, s[4:7], s11 offen sc1
    s_cmp_eq_u32 s56, 0
    s_cbranch_scc0 fp_40
    s_waitcnt vmcnt(0)
    s_barrier
    s_cmp_lg_u32 s9, 0
    s_cbranch_scc1 pb_41
    s_add_u32 s11, s10, 1
    v_mov_b32 v10, s11
    buffer_store_dword v10, off, s[4:7], s60 sc1
pb_41:
fp_40:
    s_add_u32 s10, s10, 4
    s_add_u32 s56, s56, 1
    s_cmp_lt_u32 s56, s70
    s_cbranch_scc1 L1S_SEG
L1S_END:
    s_sub_u32 s10, s10, 4
    s_waitcnt vmcnt(0)
    s_barrier
    s_cmp_lg_u32 s9, 0
    s_cbranch_scc1 pb_42
    s_add_u32 s11, s10, 1
    v_mov_b32 v10, s11
    buffer_store_dword v10, off, s[4:7], s60 sc1
pb_42:
L1_END:
    s_waitcnt vmcnt(0)
    s_cmp_eq_u32 s90, 2
    s_cbranch_scc1 ROLE_A3
    s_barrier
    v_mbcnt_lo_u32_b32 v0, -1, 0
    v_mbcnt_hi_u32_b32 v0, -1, v0
    s_lshl_b32 s93, s95, 6
    v_add_u32 v0, s93, v0
    s_cmp_eq_u32 s90, 1
    s_cbranch_scc1 ROLE_R2
    s_cmp_eq_u32 s90, 3
    s_cbranch_scc1 ROLE_O
    s_mov_b32 s36, 1
    s_sub_u32 s10, s90, 6
    s_mov_b32 s8, s91
    s_load_dwordx2 s[4:5], s[0:1], 96
    v_lshrrev_b32 v14, 6, v0
    v_and_b32 v15, 63, v0
    v_readfirstlane_b32 s9, v14
    s_mov_b32 s6, 268435456
    s_mov_b32 s7, 0x20000
    v_lshlrev_b32 v0, 4, v15
    s_lshl_b32 s20, s9, 13
    v_add_u32 v1, s20, v0
    s_lshl_b32 s20, s9, 11
    v_add_u32 v2, s20, v0
    v_and_b32 v16, 31, v15
    v_lshrrev_b32 v17, 5, v15
    v_lshrrev_b32 v18, 4, v16
    v_lshlrev_b32 v18, 10, v18
    v_lshlrev_b32 v19, 8, v17
    v_add_u32 v18, v18, v19
    v_and_b32 v19, 15, v16
    v_lshlrev_b32 v19, 4, v19
    s_add_u32 s21, s20, 8192
    v_add3_u32 v3, v18, v19, s21
    s_lshl_b32 s20, s9, 9
    v_add_u32 v4, s20, v0
    v_and_b32 v18, 15, v15
    v_lshrrev_b32 v18, 2, v18
    v_lshlrev_b32 v19, 3, v17
    v_add_u32 v18, v18, v19
    v_lshlrev_b32 v18, 4, v18
    v_and_b32 v19, 1, v15
    v_lshlrev_b32 v19, 3, v19
    s_lshl_b32 s20, s9, 10
    s_add_u32 s20, s20, 159744
    v_add3_u32 v5, v18, v19, s20
    s_lshl_b32 s20, s9, 5
    v_add_u32 v18, s20, v16
    v_lshlrev_b32 v18, 4, v18
    v_lshlrev_b32 v19, 3, v17
    v_add_u32 v18, v18, v19
    v_add_u32 v6, 2048, v18
    s_xor_b32 s20, s9, 0
    s_mul_i32 s20, s20, 5120
    s_add_u32 s20, s20, 139264
    v_add_u32 v7, s20, v0
    s_xor_b32 s20, s9, 1
    s_mul_i32 s20, s20, 5120
    s_add_u32 s20, s20, 139264
    v_add_u32 v8, s20, v0
    s_xor_b32 s20, s9, 2
    s_mul_i32 s20, s20, 5120
    s_add_u32 s20, s20, 139264
    v_add_u32 v9, s20, v0
    s_xor_b32 s20, s9, 3
    s_mul_i32 s20, s20, 5120
    s_add_u32 s20, s20, 139264
    v_add_u32 v10, s20, v0
    s_mul_i32 s20, s9, 6144
    s_add_u32 s20, s20, 65536
    v_add_u32 v11, s20, v0
    v_and_b32 v18, 7, v15
    v_lshlrev_b32 v12, 7, v18
    v_lshlrev_b32 v18, 2, v17
    v_add_u32 v18, 0, v18
    v_cmp_le_u32 s[40:41], v18, v16
    v_lshlrev_b32 v18, 2, v17
    v_add_u32 v18, 1, v18
    v_cmp_le_u32 s[42:43], v18, v16
    v_lshlrev_b32 v18, 2, v17
    v_add_u32 v18, 2, v18
    v_cmp_le_u32 s[44:45], v18, v16
    v_lshlrev_b32 v18, 2, v17
    v_add_u32 v18, 3, v18
    v_cmp_le_u32 s[46:47], v18, v16
    v_lshlrev_b32 v18, 2, v17
    v_add_u32 v18, 8, v18
    v_cmp_le_u32 s[48:49], v18, v16
    v_lshlrev_b32 v18, 2, v17
    v_add_u32 v18, 9, v18
    v_cmp_le_u32 s[50:51], v18, v16
    v_lshlrev_b32 v18, 2, v17
    v_add_u32 v18, 10, v18
    v_cmp_le_u32 s[52:53], v18, v16
    v_lshlrev_b32 v18, 2, v17
    v_add_u32 v18, 11, v18
    v_cmp_le_u32 s[54:55], v18, v16
    v_lshlrev_b32 v18, 2, v17
    v_add_u32 v18, 16, v18
    v_cmp_le_u32 s[56:57], v18, v16
    v_lshlrev_b32 v18, 2, v17
    v_add_u32 v18, 17, v18
    v_cmp_le_u32 s[58:59], v18, v16
    v_lshlrev_b32 v18, 2, v17
    v_add_u32 v18, 18, v18
    v_cmp_le_u32 s[60:61], v18, v16
    v_lshlrev_b32 v18, 2, v17
    v_add_u32 v18, 19, v18
    v_cmp_le_u32 s[62:63], v18, v16
    v_lshlrev_b32 v18, 2, v17
    v_add_u32 v18, 24, v18
    v_cmp_le_u32 s[64:65], v18, v16
    v_lshlrev_b32 v18, 2, v17
    v_add_u32 v18, 25, v18
    v_cmp_le_u32 s[66:67], v18, v16
    v_lshlrev_b32 v18, 2, v17
    v_add_u32 v18, 26, v18
    v_cmp_le_u32 s[68:69], v18, v16
    v_lshlrev_b32 v18, 2, v17
    v_add_u32 v18, 27, v18
    v_cmp_le_u32 s[70:71], v18, v16
    s_mov_b32 s26, 0x3e0293ee
    s_mov_b32 s27, 0xbe0293ee
    s_waitcnt lgkmcnt(0)
    s_branch ROLE_H2
ROLE_A3:
    s_cmp_eq_u32 s92, 0
    s_cbranch_scc0 A_SAFE
    v_lshrrev_b32 v11, 4, v0
    v_and_b32 v12, 15, v11
    v_lshrrev_b32 v13, 4, v11
    v_lshlrev_b32 v13, 2, v13
    v_add_u32 v14, 0, v13
    v_sub_u32 v15, v12, v14
    v_and_b32 v16, 0xfffffff1, v15
    v_cmp_eq_u32 s[36:37], 0, v16
    v_add_u32 v15, 16, v15
    v_and_b32 v16, 0xfffffff1, v15
    v_cmp_eq_u32 s[28:29], 0, v16
    v_add_u32 v14, 1, v13
    v_sub_u32 v15, v12, v14
    v_and_b32 v16, 0xfffffff1, v15
    v_cmp_eq_u32 s[38:39], 0, v16
    v_add_u32 v15, 16, v15
    v_and_b32 v16, 0xfffffff1, v15
    v_cmp_eq_u32 s[30:31], 0, v16
    v_add_u32 v14, 2, v13
    v_sub_u32 v15, v12, v14
    v_and_b32 v16, 0xfffffff1, v15
    v_cmp_eq_u32 s[40:41], 0, v16
    v_add_u32 v15, 16, v15
    v_and_b32 v16, 0xfffffff1, v15
    v_cmp_eq_u32 s[32:33], 0, v16
    v_add_u32 v14, 3, v13
    v_sub_u32 v15, v12, v14
    v_and_b32 v16, 0xfffffff1, v15
    v_cmp_eq_u32 s[42:43], 0, v16
    v_add_u32 v15, 16, v15
    v_and_b32 v16, 0xfffffff1, v15
    v_cmp_eq_u32 s[34:35], 0, v16
    s_mov_b32 s26, 0x3eb8aa3b
    s_mov_b32 s27, 0xbeb8aa3b
    v_mov_b32 v18, -1
    v_mov_b32 v19, -1
    s_mov_b32 s10, s53
    s_mov_b32 s56, 0
    s_mov_b32 s62, s53
AF_SEG:
    s_mov_b32 s60, 0
    s_cmp_ge_u32 s10, 16
    s_cselect_b32 s11, 1, 0
    s_add_u32 s60, s60, s11
    s_cmp_ge_u32 s10, 32
    s_cselect_b32 s11, 1, 0
    s_add_u32 s60, s60, s11
    s_cmp_ge_u32 s10, 48
    s_cselect_b32 s11, 1, 0
    s_add_u32 s60, s60, s11
    s_cmp_ge_u32 s10, 56
    s_cselect_b32 s11, 1, 0
    s_add_u32 s60, s60, s11
    s_lshl_b32 s60, s60, 2
    s_add_u32 s60, s60, s53
    s_lshl_b32 s60, s60, 3
    s_add_u32 s60, s60, s55
    s_lshl_b32 s60, s60, 7
    s_add_u32 s60, s60, 65536
    s_mov_b32 s59, 40960
    s_mov_b32 s15, 0
abw_43:
    buffer_load_dword v10, v7, s[4:7], s59 offen sc1
    buffer_load_dword v16, off, s[4:7], s60 sc1
    s_add_u32 s13, s59, 2048
    buffer_load_dword v17, v7, s[4:7], s13 offen sc1
    s_add_u32 s15, s15, 1
    s_cmp_gt_u32 s15, 200000
    s_cbranch_scc1 K_FAIL
    s_waitcnt vmcnt(1)
    v_min_u32 v10, v10, v16
    v_cmp_ge_u32 vcc, s10, v10
    s_cbranch_vccz abok_44
    s_waitcnt vmcnt(0)
    s_cmp_lt_u32 s62, s10
    s_cbranch_scc0 abn_45
    v_cmp_ge_u32 vcc, s62, v17
    s_cbranch_vccnz abn_45
    s_and_b32 s11, s62, 7
    s_lshl_b32 s11, s11, 18
    s_lshl_b32 s12, s8, 10
    s_add_u32 s11, s11, s12
    s_add_u32 s11, s11, 33554432
    buffer_load_dwordx4 v[160:163], v0, s[4:7], s11 offen sc1
    s_add_u32 s11, s11, 32768
    buffer_load_dwordx4 v[164:167], v0, s[4:7], s11 offen sc1
    s_add_u32 s11, s11, 32768
    buffer_load_dwordx4 v[168:171], v0, s[4:7], s11 offen sc1
    s_add_u32 s11, s11, 32768
    buffer_load_dwordx4 v[172:175], v0, s[4:7], s11 offen sc1
    s_add_u32 s11, s11, 32768
    buffer_load_dwordx4 v[176:179], v0, s[4:7], s11 offen sc1
    s_add_u32 s11, s11, 32768
    buffer_load_dwordx4 v[180:183], v0, s[4:7], s11 offen sc1
    s_add_u32 s11, s11, 32768
    buffer_load_dwordx4 v[184:187], v0, s[4:7], s11 offen sc1
    s_add_u32 s11, s11, 32768
    buffer_load_dwordx4 v[188:191], v0, s[4:7], s11 offen sc1
    s_lshr_b32 s11, s62, 2
    s_and_b32 s11, s11, 7
    s_lshl_b32 s11, s11, 12
    s_lshl_b32 s12, s9, 10
    s_add_u32 s11, s11, s12
    s_add_u32 s11, s11, 83968
    v_add_u32 v14, s11, v0
    ds_read_b128 v[28:31], v14
    s_mov_b32 s57, 0x3f80
    s_mov_b32 s58, 0x3f800000
    v_mov_b32 v20, 0
    v_mov_b32 v21, 0
    v_mov_b32 v22, 0
    v_mov_b32 v23, 0
    v_mov_b32 v24, 0
    v_mov_b32 v25, 0
    v_mov_b32 v26, 0
    v_mov_b32 v27, 0
    s_waitcnt vmcnt(7)
    v_dot2c_f32_bf16 v20, s57, v160
    v_dot2c_f32_bf16 v21, s58, v160
    v_dot2c_f32_bf16 v22, s57, v161
    v_dot2c_f32_bf16 v23, s58, v161
    v_dot2c_f32_bf16 v24, s57, v162
    v_dot2c_f32_bf16 v25, s58, v162
    v_dot2c_f32_bf16 v26, s57, v163
    v_dot2c_f32_bf16 v27, s58, v163
    s_waitcnt vmcnt(6)
    v_dot2c_f32_bf16 v20, s57, v164
    v_dot2c_f32_bf16 v21, s58, v164
    v_dot2c_f32_bf16 v22, s57, v165
    v_dot2c_f32_bf16 v23, s58, v165
    v_dot2c_f32_bf16 v24, s57, v166
    v_dot2c_f32_bf16 v25, s58, v166
    v_dot2c_f32_bf16 v26, s57, v167
    v_dot2c_f32_bf16 v27, s58, v167
    s_waitcnt vmcnt(5)
    v_dot2c_f32_bf16 v20, s57, v168
    v_dot2c_f32_bf16 v21, s58, v168
    v_dot2c_f32_bf16 v22, s57, v169
    v_dot2c_f32_bf16 v23, s58, v169
    v_dot2c_f32_bf16 v24, s57, v170
    v_dot2c_f32_bf16 v25, s58, v170
    v_dot2c_f32_bf16 v26, s57, v171
    v_dot2c_f32_bf16 v27, s58, v171
    s_waitcnt vmcnt(4)
    v_dot2c_f32_bf16 v20, s57, v172
    v_dot2c_f32_bf16 v21, s58, v172
    v_dot2c_f32_bf16 v22, s57, v173
    v_dot2c_f32_bf16 v23, s58, v173
    v_dot2c_f32_bf16 v24, s57, v174
    v_dot2c_f32_bf16 v25, s58, v174
    v_dot2c_f32_bf16 v26, s57, v175
    v_dot2c_f32_bf16 v27, s58, v175
    s_waitcnt vmcnt(3)
    v_dot2c_f32_bf16 v20, s57, v176
    v_dot2c_f32_bf16 v21, s58, v176
    v_dot2c_f32_bf16 v22, s57, v177
    v_dot2c_f32_bf16 v23, s58, v177
    v_dot2c_f32_bf16 v24, s57, v178
    v_dot2c_f32_bf16 v25, s58, v178
    v_dot2c_f32_bf16 v26, s57, v179
    v_dot2c_f32_bf16 v27, s58, v179
    s_waitcnt vmcnt(2)
    v_dot2c_f32_bf16 v20, s57, v180
    v_dot2c_f32_bf16 v21, s58, v180
    v_dot2c_f32_bf16 v22, s57, v181
    v_dot2c_f32_bf16 v23, s58, v181
    v_dot2c_f32_bf16 v24, s57, v182
    v_dot2c_f32_bf16 v25, s58, v182
    v_dot2c_f32_bf16 v26, s57, v183
    v_dot2c_f32_bf16 v27, s58, v183
    s_waitcnt vmcnt(1)
    v_dot2c_f32_bf16 v20, s57, v184
    v_dot2c_f32_bf16 v21, s58, v184
    v_dot2c_f32_bf16 v22, s57, v185
    v_dot2c_f32_bf16 v23, s58, v185
    v_dot2c_f32_bf16 v24, s57, v186
    v_dot2c_f32_bf16 v25, s58, v186
    v_dot2c_f32_bf16 v26, s57, v187
    v_dot2c_f32_bf16 v27, s58, v187
    s_waitcnt vmcnt(0)
    v_dot2c_f32_bf16 v20, s57, v188
    v_dot2c_f32_bf16 v21, s58, v188
    v_dot2c_f32_bf16 v22, s57, v189
    v_dot2c_f32_bf16 v23, s58, v189
    v_dot2c_f32_bf16 v24, s57, v190
    v_dot2c_f32_bf16 v25, s58, v190
    v_dot2c_f32_bf16 v26, s57, v191
    v_dot2c_f32_bf16 v27, s58, v191
    s_lshl_b32 s11, s53, 3
    s_add_u32 s11, s11, s55
    s_lshl_b32 s11, s11, 7
    s_lshl_b32 s12, s9, 2
    s_add_u32 s11, s11, s12
    s_add_u32 s13, s11, 45056
    s_add_u32 s11, s62, 1
    v_mov_b32 v10, s11
    buffer_store_dword v10, off, s[4:7], s13 sc1
    s_waitcnt lgkmcnt(0)
    v_cvt_pk_bf16_f32 v40, v20, v21
    v_cvt_pk_bf16_f32 v41, v22, v23
    v_cvt_pk_bf16_f32 v42, v24, v25
    v_cvt_pk_bf16_f32 v43, v26, v27
    v_lshlrev_b32 v20, 16, v40
    v_and_b32 v21, 0xffff0000, v40
    v_lshlrev_b32 v22, 16, v41
    v_and_b32 v23, 0xffff0000, v41
    v_lshlrev_b32 v24, 16, v42
    v_and_b32 v25, 0xffff0000, v42
    v_lshlrev_b32 v26, 16, v43
    v_and_b32 v27, 0xffff0000, v43
    v_lshlrev_b32 v32, 16, v28
    v_and_b32 v33, 0xffff0000, v28
    v_lshlrev_b32 v34, 16, v29
    v_and_b32 v35, 0xffff0000, v29
    v_lshlrev_b32 v36, 16, v30
    v_and_b32 v37, 0xffff0000, v30
    v_lshlrev_b32 v38, 16, v31
    v_and_b32 v39, 0xffff0000, v31
    v_add_f32 v20, v20, v32
    v_add_f32 v21, v21, v33
    v_add_f32 v22, v22, v34
    v_add_f32 v23, v23, v35
    v_add_f32 v24, v24, v36
    v_add_f32 v25, v25, v37
    v_add_f32 v26, v26, v38
    v_add_f32 v27, v27, v39
    v_cvt_pk_bf16_f32 v40, v20, v21
    v_cvt_pk_bf16_f32 v41, v22, v23
    v_cvt_pk_bf16_f32 v42, v24, v25
    v_cvt_pk_bf16_f32 v43, v26, v27
    v_lshlrev_b32 v32, 16, v40
    v_and_b32 v33, 0xffff0000, v40
    v_lshlrev_b32 v34, 16, v41
    v_and_b32 v35, 0xffff0000, v41
    v_lshlrev_b32 v36, 16, v42
    v_and_b32 v37, 0xffff0000, v42
    v_lshlrev_b32 v38, 16, v43
    v_and_b32 v39, 0xffff0000, v43
    s_lshl_b32 s11, s62, 15
    buffer_store_dwordx4 v[40:43], v3, s[20:23], s11 offen
    s_add_u32 s62, s62, 4
    s_mov_b32 s15, 0
    s_branch abw_43
abn_45:
    s_sleep 1
    s_branch abw_43
abok_44:
    s_and_b32 s11, s10, 7
    s_lshl_b32 s11, s11, 18
    s_lshl_b32 s12, s8, 10
    s_add_u32 s11, s11, s12
    s_add_u32 s11, s11, 31457280
    buffer_load_dwordx4 v[160:163], v0, s[4:7], s11 offen sc1
    s_add_u32 s11, s11, 32768
    buffer_load_dwordx4 v[164:167], v0, s[4:7], s11 offen sc1
    s_add_u32 s11, s11, 32768
    buffer_load_dwordx4 v[168:171], v0, s[4:7], s11 offen sc1
    s_add_u32 s11, s11, 32768
    buffer_load_dwordx4 v[172:175], v0, s[4:7], s11 offen sc1
    s_add_u32 s11, s11, 32768
    buffer_load_dwordx4 v[176:179], v0, s[4:7], s11 offen sc1
    s_add_u32 s11, s11, 32768
    buffer_load_dwordx4 v[180:183], v0, s[4:7], s11 offen sc1
    s_add_u32 s11, s11, 32768
    buffer_load_dwordx4 v[184:187], v0, s[4:7], s11 offen sc1
    s_add_u32 s11, s11, 32768
    buffer_load_dwordx4 v[188:191], v0, s[4:7], s11 offen sc1
    s_lshl_b32 s11, s10, 15
    s_add_u32 s11, s11, 4194304
    s_lshl_b32 s14, s8, 10
    s_add_u32 s11, s11, s14
    buffer_load_dwordx4 v[28:31], v0, s[4:7], s11 offen sc1
    s_mov_b32 s57, 0x3f80
    s_mov_b32 s58, 0x3f800000
    v_mov_b32 v20, 0
    v_mov_b32 v21, 0
    v_mov_b32 v22, 0
    v_mov_b32 v23, 0
    v_mov_b32 v24, 0
    v_mov_b32 v25, 0
    v_mov_b32 v26, 0
    v_mov_b32 v27, 0
    s_waitcnt vmcnt(8)
    v_dot2c_f32_bf16 v20, s57, v160
    v_dot2c_f32_bf16 v21, s58, v160
    v_dot2c_f32_bf16 v22, s57, v161
    v_dot2c_f32_bf16 v23, s58, v161
    v_dot2c_f32_bf16 v24, s57, v162
    v_dot2c_f32_bf16 v25, s58, v162
    v_dot2c_f32_bf16 v26, s57, v163
    v_dot2c_f32_bf16 v27, s58, v163
    s_waitcnt vmcnt(7)
    v_dot2c_f32_bf16 v20, s57, v164
    v_dot2c_f32_bf16 v21, s58, v164
    v_dot2c_f32_bf16 v22, s57, v165
    v_dot2c_f32_bf16 v23, s58, v165
    v_dot2c_f32_bf16 v24, s57, v166
    v_dot2c_f32_bf16 v25, s58, v166
    v_dot2c_f32_bf16 v26, s57, v167
    v_dot2c_f32_bf16 v27, s58, v167
    s_waitcnt vmcnt(6)
    v_dot2c_f32_bf16 v20, s57, v168
    v_dot2c_f32_bf16 v21, s58, v168
    v_dot2c_f32_bf16 v22, s57, v169
    v_dot2c_f32_bf16 v23, s58, v169
    v_dot2c_f32_bf16 v24, s57, v170
    v_dot2c_f32_bf16 v25, s58, v170
    v_dot2c_f32_bf16 v26, s57, v171
    v_dot2c_f32_bf16 v27, s58, v171
    s_waitcnt vmcnt(5)
    v_dot2c_f32_bf16 v20, s57, v172
    v_dot2c_f32_bf16 v21, s58, v172
    v_dot2c_f32_bf16 v22, s57, v173
    v_dot2c_f32_bf16 v23, s58, v173
    v_dot2c_f32_bf16 v24, s57, v174
    v_dot2c_f32_bf16 v25, s58, v174
    v_dot2c_f32_bf16 v26, s57, v175
    v_dot2c_f32_bf16 v27, s58, v175
    s_waitcnt vmcnt(4)
    v_dot2c_f32_bf16 v20, s57, v176
    v_dot2c_f32_bf16 v21, s58, v176
    v_dot2c_f32_bf16 v22, s57, v177
    v_dot2c_f32_bf16 v23, s58, v177
    v_dot2c_f32_bf16 v24, s57, v178
    v_dot2c_f32_bf16 v25, s58, v178
    v_dot2c_f32_bf16 v26, s57, v179
    v_dot2c_f32_bf16 v27, s58, v179
    s_waitcnt vmcnt(3)
    v_dot2c_f32_bf16 v20, s57, v180
    v_dot2c_f32_bf16 v21, s58, v180
    v_dot2c_f32_bf16 v22, s57, v181
    v_dot2c_f32_bf16 v23, s58, v181
    v_dot2c_f32_bf16 v24, s57, v182
    v_dot2c_f32_bf16 v25, s58, v182
    v_dot2c_f32_bf16 v26, s57, v183
    v_dot2c_f32_bf16 v27, s58, v183
    s_waitcnt vmcnt(2)
    v_dot2c_f32_bf16 v20, s57, v184
    v_dot2c_f32_bf16 v21, s58, v184
    v_dot2c_f32_bf16 v22, s57, v185
    v_dot2c_f32_bf16 v23, s58, v185
    v_dot2c_f32_bf16 v24, s57, v186
    v_dot2c_f32_bf16 v25, s58, v186
    v_dot2c_f32_bf16 v26, s57, v187
    v_dot2c_f32_bf16 v27, s58, v187
    s_waitcnt vmcnt(1)
    v_dot2c_f32_bf16 v20, s57, v188
    v_dot2c_f32_bf16 v21, s58, v188
    v_dot2c_f32_bf16 v22, s57, v189
    v_dot2c_f32_bf16 v23, s58, v189
    v_dot2c_f32_bf16 v24, s57, v190
    v_dot2c_f32_bf16 v25, s58, v190
    v_dot2c_f32_bf16 v26, s57, v191
    v_dot2c_f32_bf16 v27, s58, v191
    s_waitcnt vmcnt(0)
    v_cvt_pk_bf16_f32 v40, v20, v21
    v_cvt_pk_bf16_f32 v41, v22, v23
    v_cvt_pk_bf16_f32 v42, v24, v25
    v_cvt_pk_bf16_f32 v43, v26, v27
    v_lshlrev_b32 v20, 16, v40
    v_and_b32 v21, 0xffff0000, v40
    v_lshlrev_b32 v22, 16, v41
    v_and_b32 v23, 0xffff0000, v41
    v_lshlrev_b32 v24, 16, v42
    v_and_b32 v25, 0xffff0000, v42
    v_lshlrev_b32 v26, 16, v43
    v_and_b32 v27, 0xffff0000, v43
    v_lshlrev_b32 v32, 16, v28
    v_and_b32 v33, 0xffff0000, v28
    v_lshlrev_b32 v34, 16, v29
    v_and_b32 v35, 0xffff0000, v29
    v_lshlrev_b32 v36, 16, v30
    v_and_b32 v37, 0xffff0000, v30
    v_lshlrev_b32 v38, 16, v31
    v_and_b32 v39, 0xffff0000, v31
    v_add_f32 v20, v20, v32
    v_add_f32 v21, v21, v33
    v_add_f32 v22, v22, v34
    v_add_f32 v23, v23, v35
    v_add_f32 v24, v24, v36
    v_add_f32 v25, v25, v37
    v_add_f32 v26, v26, v38
    v_add_f32 v27, v27, v39
    v_cvt_pk_bf16_f32 v40, v20, v21
    v_cvt_pk_bf16_f32 v41, v22, v23
    v_cvt_pk_bf16_f32 v42, v24, v25
    v_cvt_pk_bf16_f32 v43, v26, v27
    v_lshlrev_b32 v32, 16, v40
    v_and_b32 v33, 0xffff0000, v40
    v_lshlrev_b32 v34, 16, v41
    v_and_b32 v35, 0xffff0000, v41
    v_lshlrev_b32 v36, 16, v42
    v_and_b32 v37, 0xffff0000, v42
    v_lshlrev_b32 v38, 16, v43
    v_and_b32 v39, 0xffff0000, v43
    v_mov_b32 v100, v40
    v_mov_b32 v101, v41
    v_mov_b32 v102, v42
    v_mov_b32 v103, v43
    s_add_u32 s63, s53, 20
    v_add_f32 v44, v32, v33
    v_mul_f32 v45, v32, v32
    v_add_f32 v12, v34, v35
    v_fmac_f32 v45, v33, v33
    v_add_f32 v13, v36, v37
    v_mul_f32 v15, v34, v34
    v_add_f32 v14, v38, v39
    v_fmac_f32 v15, v35, v35
    v_add_f32 v44, v44, v12
    v_fmac_f32 v45, v36, v36
    v_add_f32 v13, v13, v14
    v_fmac_f32 v15, v37, v37
    v_add_f32 v44, v44, v13
    v_fmac_f32 v45, v38, v38
    v_fmac_f32 v15, v39, v39
    v_add_f32 v45, v45, v15
    v_mov_b32 v12, v44
    v_mov_b32 v13, v45
    s_nop 0
    v_permlane32_swap_b32 v44, v12
    v_permlane32_swap_b32 v45, v13
    v_add_f32 v44, v44, v12
    v_add_f32 v45, v45, v13
    v_lshrrev_b32 v14, 1, v0
    v_and_b32 v14, 0xff, v14
    s_lshl_b32 s11, s9, 8
    s_add_u32 s11, s11, 81920
    v_add_u32 v15, s11, v14
    ds_write_b64 v15, v[44:45]
    s_waitcnt lgkmcnt(0)
    s_barrier
    v_add_u32 v14, 81920, v14
    ds_read_b64 v[104:105], v14 offset:0
    ds_read_b64 v[106:107], v14 offset:256
    ds_read_b64 v[108:109], v14 offset:512
    ds_read_b64 v[110:111], v14 offset:768
    s_add_u32 s11, s56, 0
    s_and_b32 s11, s11, 3
    s_lshl_b32 s14, s63, 2
    s_add_u32 s11, s11, s14
    s_lshl_b32 s11, s11, 11
    s_add_u32 s11, s11, 2162688
    s_add_u32 s12, s56, 0
    s_and_b32 s12, s12, 3
    s_lshl_b32 s14, s63, 2
    s_add_u32 s12, s12, s14
    s_lshl_b32 s12, s12, 11
    s_add_u32 s12, s12, 2162688
    s_mov_b32 s13, s11
    s_waitcnt lgkmcnt(0)
    v_add_f32 v104, v104, v106
    v_add_f32 v105, v105, v107
    v_add_f32 v108, v108, v110
    v_add_f32 v109, v109, v111
    v_add_f32 v44, v104, v108
    v_add_f32 v45, v105, v109
    s_cmp_lg_u32 s9, 0
    s_cbranch_scc1 lnp_46
    s_mov_b64 exec, s[24:25]
    buffer_store_dwordx2 v[44:45], v4, s[4:7], s11 offen
    s_mov_b64 exec, -1
lnp_46:
    s_mov_b32 s15, 0
sg_47:
    buffer_load_dwordx4 v[104:107], v0, s[4:7], s13 offen offset:0 sc1
    buffer_load_dwordx4 v[108:111], v0, s[4:7], s13 offen offset:1024 sc1
    s_add_u32 s15, s15, 1
    s_cmp_gt_u32 s15, 200000
    s_cbranch_scc1 K_FAIL
    s_waitcnt vmcnt(0)
    v_add_f32 v104, v104, v108
    v_add_f32 v105, v105, v109
    v_add_f32 v106, v106, v110
    v_add_f32 v107, v107, v111
    v_add_f32 v44, v104, v106
    v_add_f32 v45, v105, v107
    v_cmp_u_f32 vcc, v44, v45
    s_cbranch_vccz sgok_48
    s_branch sg_47
sgok_48:
    s_cmp_lg_u32 s9, 0
    s_cbranch_scc1 lnr_49
    s_add_u32 s11, s56, 3
    s_and_b32 s11, s11, 3
    s_lshl_b32 s14, s63, 2
    s_add_u32 s11, s11, s14
    s_lshl_b32 s11, s11, 11
    s_add_u32 s11, s11, 2162688
    s_mov_b64 exec, s[24:25]
    buffer_store_dwordx2 v[18:19], v4, s[4:7], s11 offen
    s_mov_b64 exec, -1
lnr_49:
    v_mov_b32 v12, v44
    v_mov_b32 v13, v45
    s_nop 0
    v_permlane32_swap_b32 v44, v12
    v_permlane32_swap_b32 v45, v13
    v_add_f32 v44, v44, v12
    v_add_f32 v45, v45, v13
    v_mul_f32 v44, 0x3b000000, v44
    v_mul_f32 v45, 0x3b000000, v45
    v_fma_f32 v45, -v44, v44, v45
    v_max_f32 v45, 0, v45
    v_add_f32 v45, 0x3727c5ac, v45
    v_rsq_f32 v45, v45
    v_sub_f32 v32, v32, v44
    v_sub_f32 v33, v33, v44
    v_sub_f32 v34, v34, v44
    v_sub_f32 v35, v35, v44
    v_sub_f32 v36, v36, v44
    v_sub_f32 v37, v37, v44
    v_sub_f32 v38, v38, v44
    v_sub_f32 v39, v39, v44
    v_mul_f32 v32, v32, v45
    v_mul_f32 v33, v33, v45
    v_mul_f32 v34, v34, v45
    v_mul_f32 v35, v35, v45
    v_mul_f32 v36, v36, v45
    v_mul_f32 v37, v37, v45
    v_mul_f32 v38, v38, v45
    v_mul_f32 v39, v39, v45
    v_cvt_pk_bf16_f32 v40, v32, v33
    v_cvt_pk_bf16_f32 v41, v34, v35
    v_cvt_pk_bf16_f32 v42, v36, v37
    v_cvt_pk_bf16_f32 v43, v38, v39
    s_and_b32 s11, s10, 15
    s_lshl_b32 s11, s11, 15
    s_add_u32 s11, s11, 12582912
    s_lshl_b32 s14, s8, 10
    s_add_u32 s11, s11, s14
    buffer_store_dwordx4 v[40:43], v0, s[4:7], s11 offen
    s_add_u32 s59, s53, 20
    s_lshl_b32 s59, s59, 7
    s_add_u32 s59, s59, 98304
    s_lshl_b32 s14, s55, 2
    s_add_u32 s59, s59, s14
    s_waitcnt vmcnt(0)
    s_barrier
    s_cmp_lg_u32 s9, 0
    s_cbranch_scc1 pb_50
    s_add_u32 s11, s10, 1
    v_mov_b32 v10, s11
    buffer_store_dword v10, off, s[4:7], s59
pb_50:
    s_add_u32 s59, s53, 20
    s_lshl_b32 s59, s59, 7
    s_add_u32 s59, s59, 98304
    s_sub_u32 s52, s10, 1
    s_and_b32 s60, s52, 3
    s_add_u32 s60, s60, 20
    s_lshl_b32 s60, s60, 7
    s_add_u32 s60, s60, 98304
    s_cmp_eq_u32 s10, 0
    s_cselect_b32 s60, s59, s60
    s_cselect_b32 s58, 0, 1
    s_mov_b32 s15, 0
aw_54:
    buffer_load_dword v10, v2, s[4:7], s59 offen sc1
    buffer_load_dword v16, v2, s[4:7], s60 offen sc1
    s_add_u32 s15, s15, 1
    s_cmp_gt_u32 s15, 200000
    s_cbranch_scc1 K_FAIL
    s_waitcnt vmcnt(0)
    v_add_u32 v16, s58, v16
    v_min_u32 v10, v10, v16
    v_cmp_ge_u32 vcc, s10, v10
    s_cbranch_vccz awok_55
    s_branch aw_54
awok_55:
    s_and_b32 s61, s10, 15
    s_lshl_b32 s61, s61, 15
    s_add_u32 s61, s61, 12582912
    s_lshl_b32 s11, s9, 13
    s_add_u32 s12, s61, s11
    s_add_u32 s11, s11, 0
    s_mov_b32 m0, s11
    s_nop 0
    buffer_load_dwordx4 v0, s[4:7], s12 offen offset:0 sc1 lds
    buffer_load_dwordx4 v0, s[4:7], s12 offen offset:1024 sc1 lds
    buffer_load_dwordx4 v0, s[4:7], s12 offen offset:2048 sc1 lds
    buffer_load_dwordx4 v0, s[4:7], s12 offen offset:3072 sc1 lds
    s_add_u32 s11, s11, 4096
    s_add_u32 s12, s12, 4096
    s_mov_b32 m0, s11
    s_nop 0
    buffer_load_dwordx4 v0, s[4:7], s12 offen offset:0 sc1 lds
    buffer_load_dwordx4 v0, s[4:7], s12 offen offset:1024 sc1 lds
    buffer_load_dwordx4 v0, s[4:7], s12 offen offset:2048 sc1 lds
    buffer_load_dwordx4 v0, s[4:7], s12 offen offset:3072 sc1 lds
    s_cmp_eq_u32 s10, 0
    s_cbranch_scc1 h3_51
    s_and_b32 s61, s52, 15
    s_lshl_b32 s61, s61, 15
    s_add_u32 s61, s61, 12582912
    s_lshl_b32 s11, s9, 13
    s_add_u32 s12, s61, s11
    s_add_u32 s12, s12, 256
    s_lshl_b32 s11, s9, 12
    s_add_u32 s11, s11, 65536
    s_mov_b32 m0, s11
    s_nop 0
    buffer_load_dwordx4 v1, s[4:7], s12 offen sc1 lds
    s_add_u32 s11, s11, 1024
    s_add_u32 s12, s12, 2048
    s_mov_b32 m0, s11
    s_nop 0
    buffer_load_dwordx4 v1, s[4:7], s12 offen sc1 lds
    s_add_u32 s11, s11, 1024
    s_add_u32 s12, s12, 2048
    s_mov_b32 m0, s11
    s_nop 0
    buffer_load_dwordx4 v1, s[4:7], s12 offen sc1 lds
    s_add_u32 s11, s11, 1024
    s_add_u32 s12, s12, 2048
    s_mov_b32 m0, s11
    s_nop 0
    buffer_load_dwordx4 v1, s[4:7], s12 offen sc1 lds
h3_51:
    s_waitcnt vmcnt(0)
    s_barrier
    s_cmp_eq_u32 s10, 0
    s_cbranch_scc1 h3_52
    v_add_u32 v8, 65536, v0
    ds_read_b128 v[128:131], v8 offset:0
    ds_read_b128 v[132:135], v8 offset:1024
    ds_read_b128 v[136:139], v8 offset:2048
    ds_read_b128 v[140:143], v8 offset:3072
    s_waitcnt lgkmcnt(3)
    v_mfma_f32_16x16x32_bf16 v[32:35], a[64:67], v[128:131], 0
    ds_read_b128 v[144:147], v8 offset:4096
    v_mfma_f32_16x16x32_bf16 v[40:43], v[128:131], a[128:131], 0
    s_waitcnt lgkmcnt(3)
    v_mfma_f32_16x16x32_bf16 v[32:35], a[68:71], v[132:135], v[32:35]
    ds_read_b128 v[148:151], v8 offset:5120
    v_mfma_f32_16x16x32_bf16 v[40:43], v[132:135], a[132:135], v[40:43]
    s_waitcnt lgkmcnt(3)
    v_mfma_f32_16x16x32_bf16 v[32:35], a[72:75], v[136:139], v[32:35]
    ds_read_b128 v[128:131], v8 offset:6144
    v_mfma_f32_16x16x32_bf16 v[40:43], v[136:139], a[136:139], v[40:43]
    s_waitcnt lgkmcnt(3)
    v_mfma_f32_16x16x32_bf16 v[32:35], a[76:79], v[140:143], v[32:35]
    ds_read_b128 v[132:135], v8 offset:7168
    v_mfma_f32_16x16x32_bf16 v[40:43], v[140:143], a[140:143], v[40:43]
    s_waitcnt lgkmcnt(3)
    v_mfma_f32_16x16x32_bf16 v[32:35], a[80:83], v[144:147], v[32:35]
    ds_read_b128 v[136:139], v8 offset:8192
    v_mfma_f32_16x16x32_bf16 v[40:43], v[144:147], a[144:147], v[40:43]
    s_waitcnt lgkmcnt(3)
    v_mfma_f32_16x16x32_bf16 v[32:35], a[84:87], v[148:151], v[32:35]
    ds_read_b128 v[140:143], v8 offset:9216
    v_mfma_f32_16x16x32_bf16 v[40:43], v[148:151], a[148:151], v[40:43]
    s_waitcnt lgkmcnt(3)
    v_mfma_f32_16x16x32_bf16 v[32:35], a[88:91], v[128:131], v[32:35]
    ds_read_b128 v[144:147], v8 offset:10240
    v_mfma_f32_16x16x32_bf16 v[40:43], v[128:131], a[152:155], v[40:43]
    s_waitcnt lgkmcnt(3)
    v_mfma_f32_16x16x32_bf16 v[32:35], a[92:95], v[132:135], v[32:35]
    ds_read_b128 v[148:151], v8 offset:11264
    v_mfma_f32_16x16x32_bf16 v[40:43], v[132:135], a[156:159], v[40:43]
    s_waitcnt lgkmcnt(3)
    v_mfma_f32_16x16x32_bf16 v[32:35], a[96:99], v[136:139], v[32:35]
    ds_read_b128 v[128:131], v8 offset:12288
    v_mfma_f32_16x16x32_bf16 v[40:43], v[136:139], a[160:163], v[40:43]
    s_waitcnt lgkmcnt(3)
    v_mfma_f32_16x16x32_bf16 v[32:35], a[100:103], v[140:143], v[32:35]
    ds_read_b128 v[132:135], v8 offset:13312
    v_mfma_f32_16x16x32_bf16 v[40:43], v[140:143], a[164:167], v[40:43]
    s_waitcnt lgkmcnt(3)
    v_mfma_f32_16x16x32_bf16 v[32:35], a[104:107], v[144:147], v[32:35]
    ds_read_b128 v[136:139], v8 offset:14336
    v_mfma_f32_16x16x32_bf16 v[40:43], v[144:147], a[168:171], v[40:43]
    s_waitcnt lgkmcnt(3)
    v_mfma_f32_16x16x32_bf16 v[32:35], a[108:111], v[148:151], v[32:35]
    ds_read_b128 v[140:143], v8 offset:15360
    v_mfma_f32_16x16x32_bf16 v[40:43], v[148:151], a[172:175], v[40:43]
    s_waitcnt lgkmcnt(3)
    v_mfma_f32_16x16x32_bf16 v[32:35], a[112:115], v[128:131], v[32:35]
    v_mfma_f32_16x16x32_bf16 v[40:43], v[128:131], a[176:179], v[40:43]
    s_waitcnt lgkmcnt(2)
    v_mfma_f32_16x16x32_bf16 v[32:35], a[116:119], v[132:135], v[32:35]
    v_mfma_f32_16x16x32_bf16 v[40:43], v[132:135], a[180:183], v[40:43]
    s_waitcnt lgkmcnt(1)
    v_mfma_f32_16x16x32_bf16 v[32:35], a[120:123], v[136:139], v[32:35]
    v_mfma_f32_16x16x32_bf16 v[40:43], v[136:139], a[184:187], v[40:43]
    s_waitcnt lgkmcnt(0)
    v_mfma_f32_16x16x32_bf16 v[32:35], a[124:127], v[140:143], v[32:35]
    v_mfma_f32_16x16x32_bf16 v[40:43], v[140:143], a[188:191], v[40:43]
    s_nop 6
    v_cvt_pk_bf16_f32 v48, v32, v33
    v_cvt_pk_bf16_f32 v49, v34, v35
    v_cvt_pk_bf16_f32 v54, v40, v41
    v_cvt_pk_bf16_f32 v55, v42, v43
    s_branch h3_53
h3_52:
    v_mov_b32 v48, 0
    v_mov_b32 v49, 0
    v_mov_b32 v54, 0
    v_mov_b32 v55, 0
h3_53:
    v_add_u32 v8, 0, v1
    ds_read_b128 v[128:131], v8 offset:0
    ds_read_b128 v[132:135], v8 offset:256
    ds_read_b128 v[136:139], v8 offset:2048
    ds_read_b128 v[140:143], v8 offset:2304
    ds_read_b128 v[144:147], v8 offset:4096
    ds_read_b128 v[148:151], v8 offset:4352
    s_waitcnt lgkmcnt(4)
    v_mfma_f32_16x16x32_bf16 v[20:23], a[0:3], v[128:131], 0
    v_mfma_f32_16x16x32_bf16 v[28:31], a[64:67], v[128:131], 0
    v_mfma_f32_16x16x32_bf16 v[36:39], v[128:131], a[128:131], 0
    v_mfma_f32_16x16x32_bf16 v[24:27], a[0:3], v[132:135], 0
    v_mfma_f32_16x16x32_bf16 v[32:35], a[64:67], v[132:135], 0
    v_mfma_f32_16x16x32_bf16 v[40:43], v[132:135], a[128:131], 0
    ds_read_b128 v[128:131], v8 offset:6144
    ds_read_b128 v[132:135], v8 offset:6400
    s_waitcnt lgkmcnt(4)
    v_mfma_f32_16x16x32_bf16 v[20:23], a[4:7], v[136:139], v[20:23]
    v_mfma_f32_16x16x32_bf16 v[28:31], a[68:71], v[136:139], v[28:31]
    v_mfma_f32_16x16x32_bf16 v[36:39], v[136:139], a[132:135], v[36:39]
    v_mfma_f32_16x16x32_bf16 v[24:27], a[4:7], v[140:143], v[24:27]
    v_mfma_f32_16x16x32_bf16 v[32:35], a[68:71], v[140:143], v[32:35]
    v_mfma_f32_16x16x32_bf16 v[40:43], v[140:143], a[132:135], v[40:43]
    ds_read_b128 v[136:139], v8 offset:8192
    ds_read_b128 v[140:143], v8 offset:8448
    s_waitcnt lgkmcnt(4)
    v_mfma_f32_16x16x32_bf16 v[20:23], a[8:11], v[144:147], v[20:23]
    v_mfma_f32_16x16x32_bf16 v[28:31], a[72:75], v[144:147], v[28:31]
    v_mfma_f32_16x16x32_bf16 v[36:39], v[144:147], a[136:139], v[36:39]
    v_mfma_f32_16x16x32_bf16 v[24:27], a[8:11], v[148:151], v[24:27]
    v_mfma_f32_16x16x32_bf16 v[32:35], a[72:75], v[148:151], v[32:35]
    v_mfma_f32_16x16x32_bf16 v[40:43], v[148:151], a[136:139], v[40:43]
    ds_read_b128 v[144:147], v8 offset:10240
    ds_read_b128 v[148:151], v8 offset:10496
    s_waitcnt lgkmcnt(4)
    v_mfma_f32_16x16x32_bf16 v[20:23], a[12:15], v[128:131], v[20:23]
    v_mfma_f32_16x16x32_bf16 v[28:31], a[76:79], v[128:131], v[28:31]
    v_mfma_f32_16x16x32_bf16 v[36:39], v[128:131], a[140:143], v[36:39]
    v_mfma_f32_16x16x32_bf16 v[24:27], a[12:15], v[132:135], v[24:27]
    v_mfma_f32_16x16x32_bf16 v[32:35], a[76:79], v[132:135], v[32:35]
    v_mfma_f32_16x16x32_bf16 v[40:43], v[132:135], a[140:143], v[40:43]
    ds_read_b128 v[128:131], v8 offset:12288
    ds_read_b128 v[132:135], v8 offset:12544
    s_waitcnt lgkmcnt(4)
    v_mfma_f32_16x16x32_bf16 v[20:23], a[16:19], v[136:139], v[20:23]
    v_mfma_f32_16x16x32_bf16 v[28:31], a[80:83], v[136:139], v[28:31]
    v_mfma_f32_16x16x32_bf16 v[36:39], v[136:139], a[144:147], v[36:39]
    v_mfma_f32_16x16x32_bf16 v[24:27], a[16:19], v[140:143], v[24:27]
    v_mfma_f32_16x16x32_bf16 v[32:35], a[80:83], v[140:143], v[32:35]
    v_mfma_f32_16x16x32_bf16 v[40:43], v[140:143], a[144:147], v[40:43]
    ds_read_b128 v[136:139], v8 offset:14336
    ds_read_b128 v[140:143], v8 offset:14592
    s_waitcnt lgkmcnt(4)
    v_mfma_f32_16x16x32_bf16 v[20:23], a[20:23], v[144:147], v[20:23]
    v_mfma_f32_16x16x32_bf16 v[28:31], a[84:87], v[144:147], v[28:31]
    v_mfma_f32_16x16x32_bf16 v[36:39], v[144:147], a[148:151], v[36:39]
    v_mfma_f32_16x16x32_bf16 v[24:27], a[20:23], v[148:151], v[24:27]
    v_mfma_f32_16x16x32_bf16 v[32:35], a[84:87], v[148:151], v[32:35]
    v_mfma_f32_16x16x32_bf16 v[40:43], v[148:151], a[148:151], v[40:43]
    ds_read_b128 v[144:147], v8 offset:16384
    ds_read_b128 v[148:151], v8 offset:16640
    s_waitcnt lgkmcnt(4)
    v_mfma_f32_16x16x32_bf16 v[20:23], a[24:27], v[128:131], v[20:23]
    v_mfma_f32_16x16x32_bf16 v[28:31], a[88:91], v[128:131], v[28:31]
    v_mfma_f32_16x16x32_bf16 v[36:39], v[128:131], a[152:155], v[36:39]
    v_mfma_f32_16x16x32_bf16 v[24:27], a[24:27], v[132:135], v[24:27]
    v_mfma_f32_16x16x32_bf16 v[32:35], a[88:91], v[132:135], v[32:35]
    v_mfma_f32_16x16x32_bf16 v[40:43], v[132:135], a[152:155], v[40:43]
    ds_read_b128 v[128:131], v8 offset:18432
    ds_read_b128 v[132:135], v8 offset:18688
    s_waitcnt lgkmcnt(4)
    v_mfma_f32_16x16x32_bf16 v[20:23], a[28:31], v[136:139], v[20:23]
    v_mfma_f32_16x16x32_bf16 v[28:31], a[92:95], v[136:139], v[28:31]
    v_mfma_f32_16x16x32_bf16 v[36:39], v[136:139], a[156:159], v[36:39]
    v_mfma_f32_16x16x32_bf16 v[24:27], a[28:31], v[140:143], v[24:27]
    v_mfma_f32_16x16x32_bf16 v[32:35], a[92:95], v[140:143], v[32:35]
    v_mfma_f32_16x16x32_bf16 v[40:43], v[140:143], a[156:159], v[40:43]
    ds_read_b128 v[136:139], v8 offset:20480
    ds_read_b128 v[140:143], v8 offset:20736
    s_waitcnt lgkmcnt(4)
    v_mfma_f32_16x16x32_bf16 v[20:23], a[32:35], v[144:147], v[20:23]
    v_mfma_f32_16x16x32_bf16 v[28:31], a[96:99], v[144:147], v[28:31]
    v_mfma_f32_16x16x32_bf16 v[36:39], v[144:147], a[160:163], v[36:39]
    v_mfma_f32_16x16x32_bf16 v[24:27], a[32:35], v[148:151], v[24:27]
    v_mfma_f32_16x16x32_bf16 v[32:35], a[96:99], v[148:151], v[32:35]
    v_mfma_f32_16x16x32_bf16 v[40:43], v[148:151], a[160:163], v[40:43]
    ds_read_b128 v[144:147], v8 offset:22528
    ds_read_b128 v[148:151], v8 offset:22784
    s_waitcnt lgkmcnt(4)
    v_mfma_f32_16x16x32_bf16 v[20:23], a[36:39], v[128:131], v[20:23]
    v_mfma_f32_16x16x32_bf16 v[28:31], a[100:103], v[128:131], v[28:31]
    v_mfma_f32_16x16x32_bf16 v[36:39], v[128:131], a[164:167], v[36:39]
    v_mfma_f32_16x16x32_bf16 v[24:27], a[36:39], v[132:135], v[24:27]
    v_mfma_f32_16x16x32_bf16 v[32:35], a[100:103], v[132:135], v[32:35]
    v_mfma_f32_16x16x32_bf16 v[40:43], v[132:135], a[164:167], v[40:43]
    ds_read_b128 v[128:131], v8 offset:24576
    ds_read_b128 v[132:135], v8 offset:24832
    s_waitcnt lgkmcnt(4)
    v_mfma_f32_16x16x32_bf16 v[20:23], a[40:43], v[136:139], v[20:23]
    v_mfma_f32_16x16x32_bf16 v[28:31], a[104:107], v[136:139], v[28:31]
    v_mfma_f32_16x16x32_bf16 v[36:39], v[136:139], a[168:171], v[36:39]
    v_mfma_f32_16x16x32_bf16 v[24:27], a[40:43], v[140:143], v[24:27]
    v_mfma_f32_16x16x32_bf16 v[32:35], a[104:107], v[140:143], v[32:35]
    v_mfma_f32_16x16x32_bf16 v[40:43], v[140:143], a[168:171], v[40:43]
    ds_read_b128 v[136:139], v8 offset:26624
    ds_read_b128 v[140:143], v8 offset:26880
    s_waitcnt lgkmcnt(4)
    v_mfma_f32_16x16x32_bf16 v[20:23], a[44:47], v[144:147], v[20:23]
    v_mfma_f32_16x16x32_bf16 v[28:31], a[108:111], v[144:147], v[28:31]
    v_mfma_f32_16x16x32_bf16 v[36:39], v[144:147], a[172:175], v[36:39]
    v_mfma_f32_16x16x32_bf16 v[24:27], a[44:47], v[148:151], v[24:27]
    v_mfma_f32_16x16x32_bf16 v[32:35], a[108:111], v[148:151], v[32:35]
    v_mfma_f32_16x16x32_bf16 v[40:43], v[148:151], a[172:175], v[40:43]
    ds_read_b128 v[144:147], v8 offset:28672
    ds_read_b128 v[148:151], v8 offset:28928
    s_waitcnt lgkmcnt(4)
    v_mfma_f32_16x16x32_bf16 v[20:23], a[48:51], v[128:131], v[20:23]
    v_mfma_f32_16x16x32_bf16 v[28:31], a[112:115], v[128:131], v[28:31]
    v_mfma_f32_16x16x32_bf16 v[36:39], v[128:131], a[176:179], v[36:39]
    v_mfma_f32_16x16x32_bf16 v[24:27], a[48:51], v[132:135], v[24:27]
    v_mfma_f32_16x16x32_bf16 v[32:35], a[112:115], v[132:135], v[32:35]
    v_mfma_f32_16x16x32_bf16 v[40:43], v[132:135], a[176:179], v[40:43]
    ds_read_b128 v[128:131], v8 offset:30720
    ds_read_b128 v[132:135], v8 offset:30976
    s_waitcnt lgkmcnt(4)
    v_mfma_f32_16x16x32_bf16 v[20:23], a[52:55], v[136:139], v[20:23]
    v_mfma_f32_16x16x32_bf16 v[28:31], a[116:119], v[136:139], v[28:31]
    v_mfma_f32_16x16x32_bf16 v[36:39], v[136:139], a[180:183], v[36:39]
    v_mfma_f32_16x16x32_bf16 v[24:27], a[52:55], v[140:143], v[24:27]
    v_mfma_f32_16x16x32_bf16 v[32:35], a[116:119], v[140:143], v[32:35]
    v_mfma_f32_16x16x32_bf16 v[40:43], v[140:143], a[180:183], v[40:43]
    s_waitcnt lgkmcnt(2)
    v_mfma_f32_16x16x32_bf16 v[20:23], a[56:59], v[144:147], v[20:23]
    v_mfma_f32_16x16x32_bf16 v[28:31], a[120:123], v[144:147], v[28:31]
    v_mfma_f32_16x16x32_bf16 v[36:39], v[144:147], a[184:187], v[36:39]
    v_mfma_f32_16x16x32_bf16 v[24:27], a[56:59], v[148:151], v[24:27]
    v_mfma_f32_16x16x32_bf16 v[32:35], a[120:123], v[148:151], v[32:35]
    v_mfma_f32_16x16x32_bf16 v[40:43], v[148:151], a[184:187], v[40:43]
    s_waitcnt lgkmcnt(0)
    v_mfma_f32_16x16x32_bf16 v[20:23], a[60:63], v[128:131], v[20:23]
    v_mfma_f32_16x16x32_bf16 v[28:31], a[124:127], v[128:131], v[28:31]
    v_mfma_f32_16x16x32_bf16 v[36:39], v[128:131], a[188:191], v[36:39]
    v_mfma_f32_16x16x32_bf16 v[24:27], a[60:63], v[132:135], v[24:27]
    v_mfma_f32_16x16x32_bf16 v[32:35], a[124:127], v[132:135], v[32:35]
    v_mfma_f32_16x16x32_bf16 v[40:43], v[132:135], a[188:191], v[40:43]
    s_nop 2
    v_cvt_pk_bf16_f32 v44, v20, v21
    v_cvt_pk_bf16_f32 v45, v22, v23
    v_cvt_pk_bf16_f32 v50, v28, v29
    v_cvt_pk_bf16_f32 v51, v30, v31
    v_cvt_pk_bf16_f32 v56, v36, v37
    v_cvt_pk_bf16_f32 v57, v38, v39
    v_cvt_pk_bf16_f32 v46, v24, v25
    v_cvt_pk_bf16_f32 v47, v26, v27
    v_cvt_pk_bf16_f32 v52, v32, v33
    v_cvt_pk_bf16_f32 v53, v34, v35
    v_cvt_pk_bf16_f32 v58, v40, v41
    v_cvt_pk_bf16_f32 v59, v42, v43
    v_mfma_f32_16x16x16_bf16 v[60:63], v[48:49], v[44:45], 0
    v_mfma_f32_16x16x16_bf16 v[64:67], v[50:51], v[44:45], 0
    v_mfma_f32_16x16x16_bf16 v[84:87], v[50:51], v[46:47], 0
    v_mfma_f32_16x16x16_bf16 v[88:91], v[52:53], v[46:47], 0
    s_cmp_eq_u32 s10, 0
    s_cselect_b64 s[44:45], 0, s[28:29]
    s_cselect_b64 s[46:47], 0, s[30:31]
    s_cselect_b64 s[48:49], 0, s[32:33]
    s_cselect_b64 s[50:51], 0, s[34:35]
    v_mov_b32 v11, 0xf149f2ca
    v_cndmask_b32 v60, v11, v60, s[44:45]
    v_cndmask_b32 v84, v11, v84, s[28:29]
    v_cndmask_b32 v61, v11, v61, s[46:47]
    v_cndmask_b32 v85, v11, v85, s[30:31]
    v_cndmask_b32 v62, v11, v62, s[48:49]
    v_cndmask_b32 v86, v11, v86, s[32:33]
    v_cndmask_b32 v63, v11, v63, s[50:51]
    v_cndmask_b32 v87, v11, v87, s[34:35]
    v_cndmask_b32 v64, v11, v64, s[36:37]
    v_cndmask_b32 v88, v11, v88, s[36:37]
    v_cndmask_b32 v65, v11, v65, s[38:39]
    v_cndmask_b32 v89, v11, v89, s[38:39]
    v_cndmask_b32 v66, v11, v66, s[40:41]
    v_cndmask_b32 v90, v11, v90, s[40:41]
    v_cndmask_b32 v67, v11, v67, s[42:43]
    v_cndmask_b32 v91, v11, v91, s[42:43]
    v_max3_f32 v12, v60, v61, v62
    v_max3_f32 v92, v84, v85, v86
    v_max3_f32 v13, v63, v64, v65
    v_max3_f32 v93, v87, v88, v89
    v_max3_f32 v12, v12, v66, v67
    v_max3_f32 v92, v92, v90, v91
    v_max_f32 v12, v12, v13
    v_max_f32 v92, v92, v93
    v_mov_b32 v13, v12
    v_mov_b32 v93, v92
    s_nop 0
    v_permlane16_swap_b32 v12, v13
    v_permlane16_swap_b32 v92, v93
    v_max_f32 v12, v12, v13
    v_max_f32 v92, v92, v93
    v_mov_b32 v13, v12
    v_mov_b32 v93, v92
    s_nop 0
    v_permlane32_swap_b32 v12, v13
    v_permlane32_swap_b32 v92, v93
    v_max_f32 v12, v12, v13
    v_max_f32 v92, v92, v93
    v_mul_f32 v12, s27, v12
    v_mul_f32 v92, s27, v92
    v_fma_f32 v60, v60, s26, v12
    v_fma_f32 v84, v84, s26, v92
    v_fma_f32 v61, v61, s26, v12
    v_fma_f32 v85, v85, s26, v92
    v_fma_f32 v62, v62, s26, v12
    v_fma_f32 v86, v86, s26, v92
    v_fma_f32 v63, v63, s26, v12
    v_fma_f32 v87, v87, s26, v92
    v_fma_f32 v64, v64, s26, v12
    v_fma_f32 v88, v88, s26, v92
    v_fma_f32 v65, v65, s26, v12
    v_fma_f32 v89, v89, s26, v92
    v_fma_f32 v66, v66, s26, v12
    v_fma_f32 v90, v90, s26, v92
    v_fma_f32 v67, v67, s26, v12
    v_fma_f32 v91, v91, s26, v92
    v_exp_f32 v60, v60
    v_exp_f32 v84, v84
    v_exp_f32 v61, v61
    v_exp_f32 v85, v85
    v_exp_f32 v62, v62
    v_exp_f32 v86, v86
    v_exp_f32 v63, v63
    v_exp_f32 v87, v87
    v_exp_f32 v64, v64
    v_exp_f32 v88, v88
    v_exp_f32 v65, v65
    v_exp_f32 v89, v89
    v_exp_f32 v66, v66
    v_exp_f32 v90, v90
    v_exp_f32 v67, v67
    v_exp_f32 v91, v91
    v_cvt_pk_bf16_f32 v68, v60, v61
    v_cvt_pk_bf16_f32 v96, v84, v85
    v_cvt_pk_bf16_f32 v69, v62, v63
    v_cvt_pk_bf16_f32 v97, v86, v87
    v_cvt_pk_bf16_f32 v70, v64, v65
    v_cvt_pk_bf16_f32 v98, v88, v89
    v_cvt_pk_bf16_f32 v71, v66, v67
    v_cvt_pk_bf16_f32 v99, v90, v91
    s_nop 0
    v_mfma_f32_16x16x32_bf16 v[72:75], v[54:57], v[68:71], 0
    v_mfma_f32_16x16x32_bf16 v[76:79], v[56:59], v[96:99], 0
    v_add_f32 v12, v60, v61
    v_add_f32 v92, v84, v85
    v_add_f32 v13, v62, v63
    v_add_f32 v93, v86, v87
    v_add_f32 v14, v64, v65
    v_add_f32 v94, v88, v89
    v_add_f32 v15, v66, v67
    v_add_f32 v95, v90, v91
    v_add_f32 v12, v12, v13
    v_add_f32 v92, v92, v93
    v_add_f32 v14, v14, v15
    v_add_f32 v94, v94, v95
    v_add_f32 v12, v12, v14
    v_add_f32 v92, v92, v94
    v_mov_b32 v13, v12
    v_mov_b32 v93, v92
    s_nop 0
    v_permlane16_swap_b32 v12, v13
    v_permlane16_swap_b32 v92, v93
    v_add_f32 v12, v12, v13
    v_add_f32 v92, v92, v93
    v_mov_b32 v13, v12
    v_mov_b32 v93, v92
    s_nop 0
    v_permlane32_swap_b32 v12, v13
    v_permlane32_swap_b32 v92, v93
    v_add_f32 v12, v12, v13
    v_add_f32 v92, v92, v93
    v_rcp_f32 v12, v12
    v_rcp_f32 v92, v92
    v_mul_f32 v72, v72, v12
    v_mul_f32 v76, v76, v92
    v_mul_f32 v73, v73, v12
    v_mul_f32 v77, v77, v92
    v_mul_f32 v74, v74, v12
    v_mul_f32 v78, v78, v92
    v_mul_f32 v75, v75, v12
    v_mul_f32 v79, v79, v92
    v_permlane16_swap_b32 v72, v76
    v_permlane16_swap_b32 v73, v77
    v_permlane16_swap_b32 v74, v78
    v_permlane16_swap_b32 v75, v79
    v_cvt_pk_bf16_f32 v80, v72, v73
    v_cvt_pk_bf16_f32 v81, v74, v75
    v_cvt_pk_bf16_f32 v82, v76, v77
    v_cvt_pk_bf16_f32 v83, v78, v79
    s_and_b32 s11, s10, 7
    s_lshl_b32 s11, s11, 15
    s_add_u32 s11, s11, 13107200
    s_lshl_b32 s14, s8, 10
    s_add_u32 s11, s11, s14
    buffer_store_dwordx4 v[80:83], v0, s[4:7], s11 offen
    s_add_u32 s59, s53, 24
    s_lshl_b32 s59, s59, 7
    s_add_u32 s59, s59, 98304
    s_lshl_b32 s14, s55, 2
    s_add_u32 s59, s59, s14
    s_waitcnt vmcnt(0)
    s_barrier
    s_cmp_lg_u32 s9, 0
    s_cbranch_scc1 pb_56
    s_add_u32 s11, s10, 1
    v_mov_b32 v10, s11
    buffer_store_dword v10, off, s[4:7], s59
pb_56:
    s_sub_u32 s52, s10, 16
nf_57:
    s_cmp_gt_i32 s62, s52
    s_cbranch_scc1 nf_58
    s_mov_b32 s59, 43008
    s_mov_b32 s15, 0
aw_59:
    buffer_load_dword v10, v7, s[4:7], s59 offen sc1
    s_add_u32 s15, s15, 1
    s_cmp_gt_u32 s15, 200000
    s_cbranch_scc1 K_FAIL
    s_waitcnt vmcnt(0)
    v_cmp_ge_u32 vcc, s62, v10
    s_cbranch_vccz awok_60
    s_sleep 1
    s_branch aw_59
awok_60:
    s_and_b32 s11, s62, 7
    s_lshl_b32 s11, s11, 18
    s_lshl_b32 s12, s8, 10
    s_add_u32 s11, s11, s12
    s_add_u32 s11, s11, 33554432
    buffer_load_dwordx4 v[160:163], v0, s[4:7], s11 offen sc1
    s_add_u32 s11, s11, 32768
    buffer_load_dwordx4 v[164:167], v0, s[4:7], s11 offen sc1
    s_add_u32 s11, s11, 32768
    buffer_load_dwordx4 v[168:171], v0, s[4:7], s11 offen sc1
    s_add_u32 s11, s11, 32768
    buffer_load_dwordx4 v[172:175], v0, s[4:7], s11 offen sc1
    s_add_u32 s11, s11, 32768
    buffer_load_dwordx4 v[176:179], v0, s[4:7], s11 offen sc1
    s_add_u32 s11, s11, 32768
    buffer_load_dwordx4 v[180:183], v0, s[4:7], s11 offen sc1
    s_add_u32 s11, s11, 32768
    buffer_load_dwordx4 v[184:187], v0, s[4:7], s11 offen sc1
    s_add_u32 s11, s11, 32768
    buffer_load_dwordx4 v[188:191], v0, s[4:7], s11 offen sc1
    s_lshr_b32 s11, s62, 2
    s_and_b32 s11, s11, 7
    s_lshl_b32 s11, s11, 12
    s_lshl_b32 s12, s9, 10
    s_add_u32 s11, s11, s12
    s_add_u32 s11, s11, 83968
    v_add_u32 v14, s11, v0
    ds_read_b128 v[28:31], v14
    s_mov_b32 s57, 0x3f80
    s_mov_b32 s58, 0x3f800000
    v_mov_b32 v20, 0
    v_mov_b32 v21, 0
    v_mov_b32 v22, 0
    v_mov_b32 v23, 0
    v_mov_b32 v24, 0
    v_mov_b32 v25, 0
    v_mov_b32 v26, 0
    v_mov_b32 v27, 0
    s_waitcnt vmcnt(7)
    v_dot2c_f32_bf16 v20, s57, v160
    v_dot2c_f32_bf16 v21, s58, v160
    v_dot2c_f32_bf16 v22, s57, v161
    v_dot2c_f32_bf16 v23, s58, v161
    v_dot2c_f32_bf16 v24, s57, v162
    v_dot2c_f32_bf16 v25, s58, v162
    v_dot2c_f32_bf16 v26, s57, v163
    v_dot2c_f32_bf16 v27, s58, v163
    s_waitcnt vmcnt(6)
    v_dot2c_f32_bf16 v20, s57, v164
    v_dot2c_f32_bf16 v21, s58, v164
    v_dot2c_f32_bf16 v22, s57, v165
    v_dot2c_f32_bf16 v23, s58, v165
    v_dot2c_f32_bf16 v24, s57, v166
    v_dot2c_f32_bf16 v25, s58, v166
    v_dot2c_f32_bf16 v26, s57, v167
    v_dot2c_f32_bf16 v27, s58, v167
    s_waitcnt vmcnt(5)
    v_dot2c_f32_bf16 v20, s57, v168
    v_dot2c_f32_bf16 v21, s58, v168
    v_dot2c_f32_bf16 v22, s57, v169
    v_dot2c_f32_bf16 v23, s58, v169
    v_dot2c_f32_bf16 v24, s57, v170
    v_dot2c_f32_bf16 v25, s58, v170
    v_dot2c_f32_bf16 v26, s57, v171
    v_dot2c_f32_bf16 v27, s58, v171
    s_waitcnt vmcnt(4)
    v_dot2c_f32_bf16 v20, s57, v172
    v_dot2c_f32_bf16 v21, s58, v172
    v_dot2c_f32_bf16 v22, s57, v173
    v_dot2c_f32_bf16 v23, s58, v173
    v_dot2c_f32_bf16 v24, s57, v174
    v_dot2c_f32_bf16 v25, s58, v174
    v_dot2c_f32_bf16 v26, s57, v175
    v_dot2c_f32_bf16 v27, s58, v175
    s_waitcnt vmcnt(3)
    v_dot2c_f32_bf16 v20, s57, v176
    v_dot2c_f32_bf16 v21, s58, v176
    v_dot2c_f32_bf16 v22, s57, v177
    v_dot2c_f32_bf16 v23, s58, v177
    v_dot2c_f32_bf16 v24, s57, v178
    v_dot2c_f32_bf16 v25, s58, v178
    v_dot2c_f32_bf16 v26, s57, v179
    v_dot2c_f32_bf16 v27, s58, v179
    s_waitcnt vmcnt(2)
    v_dot2c_f32_bf16 v20, s57, v180
    v_dot2c_f32_bf16 v21, s58, v180
    v_dot2c_f32_bf16 v22, s57, v181
    v_dot2c_f32_bf16 v23, s58, v181
    v_dot2c_f32_bf16 v24, s57, v182
    v_dot2c_f32_bf16 v25, s58, v182
    v_dot2c_f32_bf16 v26, s57, v183
    v_dot2c_f32_bf16 v27, s58, v183
    s_waitcnt vmcnt(1)
    v_dot2c_f32_bf16 v20, s57, v184
    v_dot2c_f32_bf16 v21, s58, v184
    v_dot2c_f32_bf16 v22, s57, v185
    v_dot2c_f32_bf16 v23, s58, v185
    v_dot2c_f32_bf16 v24, s57, v186
    v_dot2c_f32_bf16 v25, s58, v186
    v_dot2c_f32_bf16 v26, s57, v187
    v_dot2c_f32_bf16 v27, s58, v187
    s_waitcnt vmcnt(0)
    v_dot2c_f32_bf16 v20, s57, v188
    v_dot2c_f32_bf16 v21, s58, v188
    v_dot2c_f32_bf16 v22, s57, v189
    v_dot2c_f32_bf16 v23, s58, v189
    v_dot2c_f32_bf16 v24, s57, v190
    v_dot2c_f32_bf16 v25, s58, v190
    v_dot2c_f32_bf16 v26, s57, v191
    v_dot2c_f32_bf16 v27, s58, v191
    s_lshl_b32 s11, s53, 3
    s_add_u32 s11, s11, s55
    s_lshl_b32 s11, s11, 7
    s_lshl_b32 s12, s9, 2
    s_add_u32 s11, s11, s12
    s_add_u32 s13, s11, 45056
    s_add_u32 s11, s62, 1
    v_mov_b32 v10, s11
    buffer_store_dword v10, off, s[4:7], s13 sc1
    s_waitcnt lgkmcnt(0)
    v_cvt_pk_bf16_f32 v40, v20, v21
    v_cvt_pk_bf16_f32 v41, v22, v23
    v_cvt_pk_bf16_f32 v42, v24, v25
    v_cvt_pk_bf16_f32 v43, v26, v27
    v_lshlrev_b32 v20, 16, v40
    v_and_b32 v21, 0xffff0000, v40
    v_lshlrev_b32 v22, 16, v41
    v_and_b32 v23, 0xffff0000, v41
    v_lshlrev_b32 v24, 16, v42
    v_and_b32 v25, 0xffff0000, v42
    v_lshlrev_b32 v26, 16, v43
    v_and_b32 v27, 0xffff0000, v43
    v_lshlrev_b32 v32, 16, v28
    v_and_b32 v33, 0xffff0000, v28
    v_lshlrev_b32 v34, 16, v29
    v_and_b32 v35, 0xffff0000, v29
    v_lshlrev_b32 v36, 16, v30
    v_and_b32 v37, 0xffff0000, v30
    v_lshlrev_b32 v38, 16, v31
    v_and_b32 v39, 0xffff0000, v31
    v_add_f32 v20, v20, v32
    v_add_f32 v21, v21, v33
    v_add_f32 v22, v22, v34
    v_add_f32 v23, v23, v35
    v_add_f32 v24, v24, v36
    v_add_f32 v25, v25, v37
    v_add_f32 v26, v26, v38
    v_add_f32 v27, v27, v39
    v_cvt_pk_bf16_f32 v40, v20, v21
    v_cvt_pk_bf16_f32 v41, v22, v23
    v_cvt_pk_bf16_f32 v42, v24, v25
    v_cvt_pk_bf16_f32 v43, v26, v27
    v_lshlrev_b32 v32, 16, v40
    v_and_b32 v33, 0xffff0000, v40
    v_lshlrev_b32 v34, 16, v41
    v_and_b32 v35, 0xffff0000, v41
    v_lshlrev_b32 v36, 16, v42
    v_and_b32 v37, 0xffff0000, v42
    v_lshlrev_b32 v38, 16, v43
    v_and_b32 v39, 0xffff0000, v43
    s_lshl_b32 s11, s62, 15
    buffer_store_dwordx4 v[40:43], v3, s[20:23], s11 offen
    s_add_u32 s62, s62, 4
    s_branch nf_57
nf_58:
    s_add_u32 s59, s53, 24
    s_lshl_b32 s59, s59, 7
    s_add_u32 s59, s59, 98304
    s_mov_b32 s15, 0
aw_61:
    buffer_load_dword v10, v2, s[4:7], s59 offen sc1
    s_add_u32 s15, s15, 1
    s_cmp_gt_u32 s15, 200000
    s_cbranch_scc1 K_FAIL
    s_waitcnt vmcnt(0)
    v_cmp_ge_u32 vcc, s10, v10
    s_cbranch_vccz awok_62
    s_sleep 1
    s_branch aw_61
awok_62:
    s_and_b32 s61, s10, 7
    s_lshl_b32 s61, s61, 15
    s_add_u32 s61, s61, 13107200
    s_lshl_b32 s11, s9, 13
    s_add_u32 s12, s61, s11
    s_add_u32 s11, s11, 32768
    s_mov_b32 m0, s11
    s_nop 0
    buffer_load_dwordx4 v0, s[4:7], s12 offen offset:0 sc1 lds
    buffer_load_dwordx4 v0, s[4:7], s12 offen offset:1024 sc1 lds
    buffer_load_dwordx4 v0, s[4:7], s12 offen offset:2048 sc1 lds
    buffer_load_dwordx4 v0, s[4:7], s12 offen offset:3072 sc1 lds
    s_add_u32 s11, s11, 4096
    s_add_u32 s12, s12, 4096
    s_mov_b32 m0, s11
    s_nop 0
    buffer_load_dwordx4 v0, s[4:7], s12 offen offset:0 sc1 lds
    buffer_load_dwordx4 v0, s[4:7], s12 offen offset:1024 sc1 lds
    buffer_load_dwordx4 v0, s[4:7], s12 offen offset:2048 sc1 lds
    buffer_load_dwordx4 v0, s[4:7], s12 offen offset:3072 sc1 lds
    s_waitcnt vmcnt(0)
    s_barrier
    v_add_u32 v8, 32768, v1
    ds_read_b128 v[128:131], v8 offset:0
    ds_read_b128 v[132:135], v8 offset:256
    ds_read_b128 v[136:139], v8 offset:2048
    ds_read_b128 v[140:143], v8 offset:2304
    ds_read_b128 v[144:147], v8 offset:4096
    ds_read_b128 v[148:151], v8 offset:4352
    s_waitcnt lgkmcnt(4)
    v_mfma_f32_16x16x32_bf16 v[112:115], a[192:195], v[128:131], 0
    v_mfma_f32_16x16x32_bf16 v[116:119], a[192:195], v[132:135], 0
    ds_read_b128 v[128:131], v8 offset:6144
    ds_read_b128 v[132:135], v8 offset:6400
    s_waitcnt lgkmcnt(4)
    v_mfma_f32_16x16x32_bf16 v[112:115], a[196:199], v[136:139], v[112:115]
    v_mfma_f32_16x16x32_bf16 v[116:119], a[196:199], v[140:143], v[116:119]
    ds_read_b128 v[136:139], v8 offset:8192
    ds_read_b128 v[140:143], v8 offset:8448
    s_waitcnt lgkmcnt(4)
    v_mfma_f32_16x16x32_bf16 v[112:115], a[200:203], v[144:147], v[112:115]
    v_mfma_f32_16x16x32_bf16 v[116:119], a[200:203], v[148:151], v[116:119]
    ds_read_b128 v[144:147], v8 offset:10240
    ds_read_b128 v[148:151], v8 offset:10496
    s_waitcnt lgkmcnt(4)
    v_mfma_f32_16x16x32_bf16 v[112:115], a[204:207], v[128:131], v[112:115]
    v_mfma_f32_16x16x32_bf16 v[116:119], a[204:207], v[132:135], v[116:119]
    ds_read_b128 v[128:131], v8 offset:12288
    ds_read_b128 v[132:135], v8 offset:12544
    s_waitcnt lgkmcnt(4)
    v_mfma_f32_16x16x32_bf16 v[112:115], a[208:211], v[136:139], v[112:115]
    v_mfma_f32_16x16x32_bf16 v[116:119], a[208:211], v[140:143], v[116:119]
    ds_read_b128 v[136:139], v8 offset:14336
    ds_read_b128 v[140:143], v8 offset:14592
    s_waitcnt lgkmcnt(4)
    v_mfma_f32_16x16x32_bf16 v[112:115], a[212:215], v[144:147], v[112:115]
    v_mfma_f32_16x16x32_bf16 v[116:119], a[212:215], v[148:151], v[116:119]
    ds_read_b128 v[144:147], v8 offset:16384
    ds_read_b128 v[148:151], v8 offset:16640
    s_waitcnt lgkmcnt(4)
    v_mfma_f32_16x16x32_bf16 v[112:115], a[216:219], v[128:131], v[112:115]
    v_mfma_f32_16x16x32_bf16 v[116:119], a[216:219], v[132:135], v[116:119]
    ds_read_b128 v[128:131], v8 offset:18432
    ds_read_b128 v[132:135], v8 offset:18688
    s_waitcnt lgkmcnt(4)
    v_mfma_f32_16x16x32_bf16 v[112:115], a[220:223], v[136:139], v[112:115]
    v_mfma_f32_16x16x32_bf16 v[116:119], a[220:223], v[140:143], v[116:119]
    ds_read_b128 v[136:139], v8 offset:20480
    ds_read_b128 v[140:143], v8 offset:20736
    s_waitcnt lgkmcnt(4)
    v_mfma_f32_16x16x32_bf16 v[112:115], a[224:227], v[144:147], v[112:115]
    v_mfma_f32_16x16x32_bf16 v[116:119], a[224:227], v[148:151], v[116:119]
    ds_read_b128 v[144:147], v8 offset:22528
    ds_read_b128 v[148:151], v8 offset:22784
    s_waitcnt lgkmcnt(4)
    v_mfma_f32_16x16x32_bf16 v[112:115], a[228:231], v[128:131], v[112:115]
    v_mfma_f32_16x16x32_bf16 v[116:119], a[228:231], v[132:135], v[116:119]
    ds_read_b128 v[128:131], v8 offset:24576
    ds_read_b128 v[132:135], v8 offset:24832
    s_waitcnt lgkmcnt(4)
    v_mfma_f32_16x16x32_bf16 v[112:115], a[232:235], v[136:139], v[112:115]
    v_mfma_f32_16x16x32_bf16 v[116:119], a[232:235], v[140:143], v[116:119]
    ds_read_b128 v[136:139], v8 offset:26624
    ds_read_b128 v[140:143], v8 offset:26880
    s_waitcnt lgkmcnt(4)
    v_mfma_f32_16x16x32_bf16 v[112:115], a[236:239], v[144:147], v[112:115]
    v_mfma_f32_16x16x32_bf16 v[116:119], a[236:239], v[148:151], v[116:119]
    ds_read_b128 v[144:147], v8 offset:28672
    ds_read_b128 v[148:151], v8 offset:28928
    s_waitcnt lgkmcnt(4)
    v_mfma_f32_16x16x32_bf16 v[112:115], a[240:243], v[128:131], v[112:115]
    v_mfma_f32_16x16x32_bf16 v[116:119], a[240:243], v[132:135], v[116:119]
    ds_read_b128 v[128:131], v8 offset:30720
    ds_read_b128 v[132:135], v8 offset:30976
    s_waitcnt lgkmcnt(4)
    v_mfma_f32_16x16x32_bf16 v[112:115], a[244:247], v[136:139], v[112:115]
    v_mfma_f32_16x16x32_bf16 v[116:119], a[244:247], v[140:143], v[116:119]
    s_waitcnt lgkmcnt(2)
    v_mfma_f32_16x16x32_bf16 v[112:115], a[248:251], v[144:147], v[112:115]
    v_mfma_f32_16x16x32_bf16 v[116:119], a[248:251], v[148:151], v[116:119]
    s_waitcnt lgkmcnt(0)
    v_mfma_f32_16x16x32_bf16 v[112:115], a[252:255], v[128:131], v[112:115]
    v_mfma_f32_16x16x32_bf16 v[116:119], a[252:255], v[132:135], v[116:119]
    s_nop 7
    v_permlane16_swap_b32 v112, v116
    v_permlane16_swap_b32 v113, v117
    v_permlane16_swap_b32 v114, v118
    v_permlane16_swap_b32 v115, v119
    v_mov_b32 v20, v112
    v_mov_b32 v24, v116
    v_mov_b32 v21, v113
    v_mov_b32 v25, v117
    v_mov_b32 v22, v114
    v_mov_b32 v26, v118
    v_mov_b32 v23, v115
    v_mov_b32 v27, v119
    v_mov_b32 v28, v100
    v_mov_b32 v29, v101
    v_mov_b32 v30, v102
    v_mov_b32 v31, v103
    v_cvt_pk_bf16_f32 v40, v20, v21
    v_cvt_pk_bf16_f32 v41, v22, v23
    v_cvt_pk_bf16_f32 v42, v24, v25
    v_cvt_pk_bf16_f32 v43, v26, v27
    v_lshlrev_b32 v20, 16, v40
    v_and_b32 v21, 0xffff0000, v40
    v_lshlrev_b32 v22, 16, v41
    v_and_b32 v23, 0xffff0000, v41
    v_lshlrev_b32 v24, 16, v42
    v_and_b32 v25, 0xffff0000, v42
    v_lshlrev_b32 v26, 16, v43
    v_and_b32 v27, 0xffff0000, v43
    v_lshlrev_b32 v32, 16, v28
    v_and_b32 v33, 0xffff0000, v28
    v_lshlrev_b32 v34, 16, v29
    v_and_b32 v35, 0xffff0000, v29
    v_lshlrev_b32 v36, 16, v30
    v_and_b32 v37, 0xffff0000, v30
    v_lshlrev_b32 v38, 16, v31
    v_and_b32 v39, 0xffff0000, v31
    v_add_f32 v20, v20, v32
    v_add_f32 v21, v21, v33
    v_add_f32 v22, v22, v34
    v_add_f32 v23, v23, v35
    v_add_f32 v24, v24, v36
    v_add_f32 v25, v25, v37
    v_add_f32 v26, v26, v38
    v_add_f32 v27, v27, v39
    v_cvt_pk_bf16_f32 v40, v20, v21
    v_cvt_pk_bf16_f32 v41, v22, v23
    v_cvt_pk_bf16_f32 v42, v24, v25
    v_cvt_pk_bf16_f32 v43, v26, v27
    v_lshlrev_b32 v32, 16, v40
    v_and_b32 v33, 0xffff0000, v40
    v_lshlrev_b32 v34, 16, v41
    v_and_b32 v35, 0xffff0000, v41
    v_lshlrev_b32 v36, 16, v42
    v_and_b32 v37, 0xffff0000, v42
    v_lshlrev_b32 v38, 16, v43
    v_and_b32 v39, 0xffff0000, v43
    s_and_b32 s11, s56, 7
    s_lshl_b32 s11, s11, 12
    s_lshl_b32 s12, s9, 10
    s_add_u32 s11, s11, s12
    s_add_u32 s11, s11, 83968
    v_add_u32 v14, s11, v0
    ds_write_b128 v14, v[40:43]
    s_add_u32 s63, s53, 24
    v_add_f32 v44, v32, v33
    v_mul_f32 v45, v32, v32
    v_add_f32 v12, v34, v35
    v_fmac_f32 v45, v33, v33
    v_add_f32 v13, v36, v37
    v_mul_f32 v15, v34, v34
    v_add_f32 v14, v38, v39
    v_fmac_f32 v15, v35, v35
    v_add_f32 v44, v44, v12
    v_fmac_f32 v45, v36, v36
    v_add_f32 v13, v13, v14
    v_fmac_f32 v15, v37, v37
    v_add_f32 v44, v44, v13
    v_fmac_f32 v45, v38, v38
    v_fmac_f32 v15, v39, v39
    v_add_f32 v45, v45, v15
    v_mov_b32 v12, v44
    v_mov_b32 v13, v45
    s_nop 0
    v_permlane32_swap_b32 v44, v12
    v_permlane32_swap_b32 v45, v13
    v_add_f32 v44, v44, v12
    v_add_f32 v45, v45, v13
    v_lshrrev_b32 v14, 1, v0
    v_and_b32 v14, 0xff, v14
    s_lshl_b32 s11, s9, 8
    s_add_u32 s11, s11, 81920
    v_add_u32 v15, s11, v14
    ds_write_b64 v15, v[44:45]
    s_waitcnt lgkmcnt(0)
    s_barrier
    v_add_u32 v14, 81920, v14
    ds_read_b64 v[104:105], v14 offset:0
    ds_read_b64 v[106:107], v14 offset:256
    ds_read_b64 v[108:109], v14 offset:512
    ds_read_b64 v[110:111], v14 offset:768
    s_add_u32 s11, s56, 0
    s_and_b32 s11, s11, 3
    s_lshl_b32 s14, s63, 2
    s_add_u32 s11, s11, s14
    s_lshl_b32 s11, s11, 11
    s_add_u32 s11, s11, 2162688
    s_add_u32 s12, s56, 0
    s_and_b32 s12, s12, 3
    s_lshl_b32 s14, s63, 2
    s_add_u32 s12, s12, s14
    s_lshl_b32 s12, s12, 11
    s_add_u32 s12, s12, 2162688
    s_mov_b32 s13, s11
    s_waitcnt lgkmcnt(0)
    v_add_f32 v104, v104, v106
    v_add_f32 v105, v105, v107
    v_add_f32 v108, v108, v110
    v_add_f32 v109, v109, v111
    v_add_f32 v44, v104, v108
    v_add_f32 v45, v105, v109
    s_cmp_lg_u32 s9, 0
    s_cbranch_scc1 lnp_63
    s_mov_b64 exec, s[24:25]
    buffer_store_dwordx2 v[44:45], v4, s[4:7], s11 offen
    s_mov_b64 exec, -1
lnp_63:
    s_mov_b32 s15, 0
sg_64:
    buffer_load_dwordx4 v[104:107], v0, s[4:7], s13 offen offset:0 sc1
    buffer_load_dwordx4 v[108:111], v0, s[4:7], s13 offen offset:1024 sc1
    s_add_u32 s15, s15, 1
    s_cmp_gt_u32 s15, 200000
    s_cbranch_scc1 K_FAIL
    s_waitcnt vmcnt(0)
    v_add_f32 v104, v104, v108
    v_add_f32 v105, v105, v109
    v_add_f32 v106, v106, v110
    v_add_f32 v107, v107, v111
    v_add_f32 v44, v104, v106
    v_add_f32 v45, v105, v107
    v_cmp_u_f32 vcc, v44, v45
    s_cbranch_vccz sgok_65
    s_branch sg_64
sgok_65:
    s_cmp_lg_u32 s9, 0
    s_cbranch_scc1 lnr_66
    s_add_u32 s11, s56, 3
    s_and_b32 s11, s11, 3
    s_lshl_b32 s14, s63, 2
    s_add_u32 s11, s11, s14
    s_lshl_b32 s11, s11, 11
    s_add_u32 s11, s11, 2162688
    s_mov_b64 exec, s[24:25]
    buffer_store_dwordx2 v[18:19], v4, s[4:7], s11 offen
    s_mov_b64 exec, -1
lnr_66:
    v_mov_b32 v12, v44
    v_mov_b32 v13, v45
    s_nop 0
    v_permlane32_swap_b32 v44, v12
    v_permlane32_swap_b32 v45, v13
    v_add_f32 v44, v44, v12
    v_add_f32 v45, v45, v13
    v_mul_f32 v44, 0x3b000000, v44
    v_mul_f32 v45, 0x3b000000, v45
    v_fma_f32 v45, -v44, v44, v45
    v_max_f32 v45, 0, v45
    v_add_f32 v45, 0x3727c5ac, v45
    v_rsq_f32 v45, v45
    v_sub_f32 v32, v32, v44
    v_sub_f32 v33, v33, v44
    v_sub_f32 v34, v34, v44
    v_sub_f32 v35, v35, v44
    v_sub_f32 v36, v36, v44
    v_sub_f32 v37, v37, v44
    v_sub_f32 v38, v38, v44
    v_sub_f32 v39, v39, v44
    v_mul_f32 v32, v32, v45
    v_mul_f32 v33, v33, v45
    v_mul_f32 v34, v34, v45
    v_mul_f32 v35, v35, v45
    v_mul_f32 v36, v36, v45
    v_mul_f32 v37, v37, v45
    v_mul_f32 v38, v38, v45
    v_mul_f32 v39, v39, v45
    v_cvt_pk_bf16_f32 v40, v32, v33
    v_cvt_pk_bf16_f32 v41, v34, v35
    v_cvt_pk_bf16_f32 v42, v36, v37
    v_cvt_pk_bf16_f32 v43, v38, v39
    s_and_b32 s11, s10, 15
    s_lshl_b32 s11, s11, 15
    s_add_u32 s11, s11, 13631488
    s_lshl_b32 s14, s8, 10
    s_add_u32 s11, s11, s14
    buffer_store_dwordx4 v[40:43], v0, s[4:7], s11 offen sc1
    s_lshl_b32 s59, s53, 3
    s_add_u32 s59, s59, s55
    s_lshl_b32 s59, s59, 7
    s_add_u32 s59, s59, 49152
    s_waitcnt vmcnt(0)
    s_barrier
    s_cmp_lg_u32 s9, 0
    s_cbranch_scc1 pb_67
    s_add_u32 s11, s10, 1
    v_mov_b32 v10, s11
    buffer_store_dword v10, off, s[4:7], s59 sc1
pb_67:
    s_add_u32 s10, s10, 4
    s_add_u32 s56, s56, 1
    s_cmp_lt_u32 s56, 16
    s_cbranch_scc1 AF_SEG
AF_END:
    s_mov_b32 s52, 63
nf_68:
    s_cmp_gt_i32 s62, s52
    s_cbranch_scc1 nf_69
    s_mov_b32 s59, 43008
    s_mov_b32 s15, 0
aw_70:
    buffer_load_dword v10, v7, s[4:7], s59 offen sc1
    s_add_u32 s15, s15, 1
    s_cmp_gt_u32 s15, 200000
    s_cbranch_scc1 K_FAIL
    s_waitcnt vmcnt(0)
    v_cmp_ge_u32 vcc, s62, v10
    s_cbranch_vccz awok_71
    s_sleep 1
    s_branch aw_70
awok_71:
    s_and_b32 s11, s62, 7
    s_lshl_b32 s11, s11, 18
    s_lshl_b32 s12, s8, 10
    s_add_u32 s11, s11, s12
    s_add_u32 s11, s11, 33554432
    buffer_load_dwordx4 v[160:163], v0, s[4:7], s11 offen sc1
    s_add_u32 s11, s11, 32768
    buffer_load_dwordx4 v[164:167], v0, s[4:7], s11 offen sc1
    s_add_u32 s11, s11, 32768
    buffer_load_dwordx4 v[168:171], v0, s[4:7], s11 offen sc1
    s_add_u32 s11, s11, 32768
    buffer_load_dwordx4 v[172:175], v0, s[4:7], s11 offen sc1
    s_add_u32 s11, s11, 32768
    buffer_load_dwordx4 v[176:179], v0, s[4:7], s11 offen sc1
    s_add_u32 s11, s11, 32768
    buffer_load_dwordx4 v[180:183], v0, s[4:7], s11 offen sc1
    s_add_u32 s11, s11, 32768
    buffer_load_dwordx4 v[184:187], v0, s[4:7], s11 offen sc1
    s_add_u32 s11, s11, 32768
    buffer_load_dwordx4 v[188:191], v0, s[4:7], s11 offen sc1
    s_lshr_b32 s11, s62, 2
    s_and_b32 s11, s11, 7
    s_lshl_b32 s11, s11, 12
    s_lshl_b32 s12, s9, 10
    s_add_u32 s11, s11, s12
    s_add_u32 s11, s11, 83968
    v_add_u32 v14, s11, v0
    ds_read_b128 v[28:31], v14
    s_mov_b32 s57, 0x3f80
    s_mov_b32 s58, 0x3f800000
    v_mov_b32 v20, 0
    v_mov_b32 v21, 0
    v_mov_b32 v22, 0
    v_mov_b32 v23, 0
    v_mov_b32 v24, 0
    v_mov_b32 v25, 0
    v_mov_b32 v26, 0
    v_mov_b32 v27, 0
    s_waitcnt vmcnt(7)
    v_dot2c_f32_bf16 v20, s57, v160
    v_dot2c_f32_bf16 v21, s58, v160
    v_dot2c_f32_bf16 v22, s57, v161
    v_dot2c_f32_bf16 v23, s58, v161
    v_dot2c_f32_bf16 v24, s57, v162
    v_dot2c_f32_bf16 v25, s58, v162
    v_dot2c_f32_bf16 v26, s57, v163
    v_dot2c_f32_bf16 v27, s58, v163
    s_waitcnt vmcnt(6)
    v_dot2c_f32_bf16 v20, s57, v164
    v_dot2c_f32_bf16 v21, s58, v164
    v_dot2c_f32_bf16 v22, s57, v165
    v_dot2c_f32_bf16 v23, s58, v165
    v_dot2c_f32_bf16 v24, s57, v166
    v_dot2c_f32_bf16 v25, s58, v166
    v_dot2c_f32_bf16 v26, s57, v167
    v_dot2c_f32_bf16 v27, s58, v167
    s_waitcnt vmcnt(5)
    v_dot2c_f32_bf16 v20, s57, v168
    v_dot2c_f32_bf16 v21, s58, v168
    v_dot2c_f32_bf16 v22, s57, v169
    v_dot2c_f32_bf16 v23, s58, v169
    v_dot2c_f32_bf16 v24, s57, v170
    v_dot2c_f32_bf16 v25, s58, v170
    v_dot2c_f32_bf16 v26, s57, v171
    v_dot2c_f32_bf16 v27, s58, v171
    s_waitcnt vmcnt(4)
    v_dot2c_f32_bf16 v20, s57, v172
    v_dot2c_f32_bf16 v21, s58, v172
    v_dot2c_f32_bf16 v22, s57, v173
    v_dot2c_f32_bf16 v23, s58, v173
    v_dot2c_f32_bf16 v24, s57, v174
    v_dot2c_f32_bf16 v25, s58, v174
    v_dot2c_f32_bf16 v26, s57, v175
    v_dot2c_f32_bf16 v27, s58, v175
    s_waitcnt vmcnt(3)
    v_dot2c_f32_bf16 v20, s57, v176
    v_dot2c_f32_bf16 v21, s58, v176
    v_dot2c_f32_bf16 v22, s57, v177
    v_dot2c_f32_bf16 v23, s58, v177
    v_dot2c_f32_bf16 v24, s57, v178
    v_dot2c_f32_bf16 v25, s58, v178
    v_dot2c_f32_bf16 v26, s57, v179
    v_dot2c_f32_bf16 v27, s58, v179
    s_waitcnt vmcnt(2)
    v_dot2c_f32_bf16 v20, s57, v180
    v_dot2c_f32_bf16 v21, s58, v180
    v_dot2c_f32_bf16 v22, s57, v181
    v_dot2c_f32_bf16 v23, s58, v181
    v_dot2c_f32_bf16 v24, s57, v182
    v_dot2c_f32_bf16 v25, s58, v182
    v_dot2c_f32_bf16 v26, s57, v183
    v_dot2c_f32_bf16 v27, s58, v183
    s_waitcnt vmcnt(1)
    v_dot2c_f32_bf16 v20, s57, v184
    v_dot2c_f32_bf16 v21, s58, v184
    v_dot2c_f32_bf16 v22, s57, v185
    v_dot2c_f32_bf16 v23, s58, v185
    v_dot2c_f32_bf16 v24, s57, v186
    v_dot2c_f32_bf16 v25, s58, v186
    v_dot2c_f32_bf16 v26, s57, v187
    v_dot2c_f32_bf16 v27, s58, v187
    s_waitcnt vmcnt(0)
    v_dot2c_f32_bf16 v20, s57, v188
    v_dot2c_f32_bf16 v21, s58, v188
    v_dot2c_f32_bf16 v22, s57, v189
    v_dot2c_f32_bf16 v23, s58, v189
    v_dot2c_f32_bf16 v24, s57, v190
    v_dot2c_f32_bf16 v25, s58, v190
    v_dot2c_f32_bf16 v26, s57, v191
    v_dot2c_f32_bf16 v27, s58, v191
    s_lshl_b32 s11, s53, 3
    s_add_u32 s11, s11, s55
    s_lshl_b32 s11, s11, 7
    s_lshl_b32 s12, s9, 2
    s_add_u32 s11, s11, s12
    s_add_u32 s13, s11, 45056
    s_add_u32 s11, s62, 1
    v_mov_b32 v10, s11
    buffer_store_dword v10, off, s[4:7], s13 sc1
    s_waitcnt lgkmcnt(0)
    v_cvt_pk_bf16_f32 v40, v20, v21
    v_cvt_pk_bf16_f32 v41, v22, v23
    v_cvt_pk_bf16_f32 v42, v24, v25
    v_cvt_pk_bf16_f32 v43, v26, v27
    v_lshlrev_b32 v20, 16, v40
    v_and_b32 v21, 0xffff0000, v40
    v_lshlrev_b32 v22, 16, v41
    v_and_b32 v23, 0xffff0000, v41
    v_lshlrev_b32 v24, 16, v42
    v_and_b32 v25, 0xffff0000, v42
    v_lshlrev_b32 v26, 16, v43
    v_and_b32 v27, 0xffff0000, v43
    v_lshlrev_b32 v32, 16, v28
    v_and_b32 v33, 0xffff0000, v28
    v_lshlrev_b32 v34, 16, v29
    v_and_b32 v35, 0xffff0000, v29
    v_lshlrev_b32 v36, 16, v30
    v_and_b32 v37, 0xffff0000, v30
    v_lshlrev_b32 v38, 16, v31
    v_and_b32 v39, 0xffff0000, v31
    v_add_f32 v20, v20, v32
    v_add_f32 v21, v21, v33
    v_add_f32 v22, v22, v34
    v_add_f32 v23, v23, v35
    v_add_f32 v24, v24, v36
    v_add_f32 v25, v25, v37
    v_add_f32 v26, v26, v38
    v_add_f32 v27, v27, v39
    v_cvt_pk_bf16_f32 v40, v20, v21
    v_cvt_pk_bf16_f32 v41, v22, v23
    v_cvt_pk_bf16_f32 v42, v24, v25
    v_cvt_pk_bf16_f32 v43, v26, v27
    v_lshlrev_b32 v32, 16, v40
    v_and_b32 v33, 0xffff0000, v40
    v_lshlrev_b32 v34, 16, v41
    v_and_b32 v35, 0xffff0000, v41
    v_lshlrev_b32 v36, 16, v42
    v_and_b32 v37, 0xffff0000, v42
    v_lshlrev_b32 v38, 16, v43
    v_and_b32 v39, 0xffff0000, v43
    s_lshl_b32 s11, s62, 15
    buffer_store_dwordx4 v[40:43], v3, s[20:23], s11 offen
    s_add_u32 s62, s62, 4
    s_branch nf_68
nf_69:
    s_waitcnt vmcnt(0)
    s_branch K_DONE
A_SAFE:
    v_lshrrev_b32 v11, 4, v0
    v_and_b32 v12, 15, v11
    v_lshrrev_b32 v13, 4, v11
    v_lshlrev_b32 v13, 2, v13
    v_add_u32 v14, 0, v13
    v_sub_u32 v15, v12, v14
    v_and_b32 v16, 0xfffffff1, v15
    v_cmp_eq_u32 s[36:37], 0, v16
    v_add_u32 v15, 16, v15
    v_and_b32 v16, 0xfffffff1, v15
    v_cmp_eq_u32 s[28:29], 0, v16
    v_add_u32 v14, 1, v13
    v_sub_u32 v15, v12, v14
    v_and_b32 v16, 0xfffffff1, v15
    v_cmp_eq_u32 s[38:39], 0, v16
    v_add_u32 v15, 16, v15
    v_and_b32 v16, 0xfffffff1, v15
    v_cmp_eq_u32 s[30:31], 0, v16
    v_add_u32 v14, 2, v13
    v_sub_u32 v15, v12, v14
    v_and_b32 v16, 0xfffffff1, v15
    v_cmp_eq_u32 s[40:41], 0, v16
    v_add_u32 v15, 16, v15
    v_and_b32 v16, 0xfffffff1, v15
    v_cmp_eq_u32 s[32:33], 0, v16
    v_add_u32 v14, 3, v13
    v_sub_u32 v15, v12, v14
    v_and_b32 v16, 0xfffffff1, v15
    v_cmp_eq_u32 s[42:43], 0, v16
    v_add_u32 v15, 16, v15
    v_and_b32 v16, 0xfffffff1, v15
    v_cmp_eq_u32 s[34:35], 0, v16
    s_mov_b32 s26, 0x3eb8aa3b
    s_mov_b32 s27, 0xbeb8aa3b
    v_mov_b32 v18, -1
    v_mov_b32 v19, -1
    s_mov_b32 s10, s53
    s_mov_b32 s56, 0
    s_mov_b32 s62, s53
AS_SEG:
    s_mov_b32 s60, 0
    s_cmp_ge_u32 s10, 16
    s_cselect_b32 s11, 1, 0
    s_add_u32 s60, s60, s11
    s_cmp_ge_u32 s10, 32
    s_cselect_b32 s11, 1, 0
    s_add_u32 s60, s60, s11
    s_cmp_ge_u32 s10, 48
    s_cselect_b32 s11, 1, 0
    s_add_u32 s60, s60, s11
    s_cmp_ge_u32 s10, 56
    s_cselect_b32 s11, 1, 0
    s_add_u32 s60, s60, s11
    s_lshl_b32 s60, s60, 2
    s_add_u32 s60, s60, s53
    s_lshl_b32 s60, s60, 3
    s_add_u32 s60, s60, s55
    s_lshl_b32 s60, s60, 7
    s_add_u32 s60, s60, 65536
    s_mov_b32 s59, 40960
    s_mov_b32 s15, 0
abw_72:
    buffer_load_dword v10, v7, s[4:7], s59 offen sc1
    buffer_load_dword v16, off, s[4:7], s60 sc1
    s_add_u32 s13, s59, 2048
    buffer_load_dword v17, v7, s[4:7], s13 offen sc1
    s_add_u32 s15, s15, 1
    s_cmp_gt_u32 s15, 200000
    s_cbranch_scc1 K_FAIL
    s_waitcnt vmcnt(1)
    v_min_u32 v10, v10, v16
    v_cmp_ge_u32 vcc, s10, v10
    s_cbranch_vccz abok_73
    s_waitcnt vmcnt(0)
    s_cmp_lt_u32 s62, s10
    s_cbranch_scc0 abn_74
    v_cmp_ge_u32 vcc, s62, v17
    s_cbranch_vccnz abn_74
    s_and_b32 s11, s62, 7
    s_lshl_b32 s11, s11, 18
    s_lshl_b32 s12, s8, 10
    s_add_u32 s11, s11, s12
    s_add_u32 s11, s11, 33554432
    buffer_load_dwordx4 v[160:163], v0, s[4:7], s11 offen sc1
    s_add_u32 s11, s11, 32768
    buffer_load_dwordx4 v[164:167], v0, s[4:7], s11 offen sc1
    s_add_u32 s11, s11, 32768
    buffer_load_dwordx4 v[168:171], v0, s[4:7], s11 offen sc1
    s_add_u32 s11, s11, 32768
    buffer_load_dwordx4 v[172:175], v0, s[4:7], s11 offen sc1
    s_add_u32 s11, s11, 32768
    buffer_load_dwordx4 v[176:179], v0, s[4:7], s11 offen sc1
    s_add_u32 s11, s11, 32768
    buffer_load_dwordx4 v[180:183], v0, s[4:7], s11 offen sc1
    s_add_u32 s11, s11, 32768
    buffer_load_dwordx4 v[184:187], v0, s[4:7], s11 offen sc1
    s_add_u32 s11, s11, 32768
    buffer_load_dwordx4 v[188:191], v0, s[4:7], s11 offen sc1
    s_lshr_b32 s11, s62, 2
    s_and_b32 s11, s11, 7
    s_lshl_b32 s11, s11, 12
    s_lshl_b32 s12, s9, 10
    s_add_u32 s11, s11, s12
    s_add_u32 s11, s11, 83968
    v_add_u32 v14, s11, v0
    ds_read_b128 v[28:31], v14
    s_mov_b32 s57, 0x3f80
    s_mov_b32 s58, 0x3f800000
    v_mov_b32 v20, 0
    v_mov_b32 v21, 0
    v_mov_b32 v22, 0
    v_mov_b32 v23, 0
    v_mov_b32 v24, 0
    v_mov_b32 v25, 0
    v_mov_b32 v26, 0
    v_mov_b32 v27, 0
    s_waitcnt vmcnt(7)
    v_dot2c_f32_bf16 v20, s57, v160
    v_dot2c_f32_bf16 v21, s58, v160
    v_dot2c_f32_bf16 v22, s57, v161
    v_dot2c_f32_bf16 v23, s58, v161
    v_dot2c_f32_bf16 v24, s57, v162
    v_dot2c_f32_bf16 v25, s58, v162
    v_dot2c_f32_bf16 v26, s57, v163
    v_dot2c_f32_bf16 v27, s58, v163
    s_waitcnt vmcnt(6)
    v_dot2c_f32_bf16 v20, s57, v164
    v_dot2c_f32_bf16 v21, s58, v164
    v_dot2c_f32_bf16 v22, s57, v165
    v_dot2c_f32_bf16 v23, s58, v165
    v_dot2c_f32_bf16 v24, s57, v166
    v_dot2c_f32_bf16 v25, s58, v166
    v_dot2c_f32_bf16 v26, s57, v167
    v_dot2c_f32_bf16 v27, s58, v167
    s_waitcnt vmcnt(5)
    v_dot2c_f32_bf16 v20, s57, v168
    v_dot2c_f32_bf16 v21, s58, v168
    v_dot2c_f32_bf16 v22, s57, v169
    v_dot2c_f32_bf16 v23, s58, v169
    v_dot2c_f32_bf16 v24, s57, v170
    v_dot2c_f32_bf16 v25, s58, v170
    v_dot2c_f32_bf16 v26, s57, v171
    v_dot2c_f32_bf16 v27, s58, v171
    s_waitcnt vmcnt(4)
    v_dot2c_f32_bf16 v20, s57, v172
    v_dot2c_f32_bf16 v21, s58, v172
    v_dot2c_f32_bf16 v22, s57, v173
    v_dot2c_f32_bf16 v23, s58, v173
    v_dot2c_f32_bf16 v24, s57, v174
    v_dot2c_f32_bf16 v25, s58, v174
    v_dot2c_f32_bf16 v26, s57, v175
    v_dot2c_f32_bf16 v27, s58, v175
    s_waitcnt vmcnt(3)
    v_dot2c_f32_bf16 v20, s57, v176
    v_dot2c_f32_bf16 v21, s58, v176
    v_dot2c_f32_bf16 v22, s57, v177
    v_dot2c_f32_bf16 v23, s58, v177
    v_dot2c_f32_bf16 v24, s57, v178
    v_dot2c_f32_bf16 v25, s58, v178
    v_dot2c_f32_bf16 v26, s57, v179
    v_dot2c_f32_bf16 v27, s58, v179
    s_waitcnt vmcnt(2)
    v_dot2c_f32_bf16 v20, s57, v180
    v_dot2c_f32_bf16 v21, s58, v180
    v_dot2c_f32_bf16 v22, s57, v181
    v_dot2c_f32_bf16 v23, s58, v181
    v_dot2c_f32_bf16 v24, s57, v182
    v_dot2c_f32_bf16 v25, s58, v182
    v_dot2c_f32_bf16 v26, s57, v183
    v_dot2c_f32_bf16 v27, s58, v183
    s_waitcnt vmcnt(1)
    v_dot2c_f32_bf16 v20, s57, v184
    v_dot2c_f32_bf16 v21, s58, v184
    v_dot2c_f32_bf16 v22, s57, v185
    v_dot2c_f32_bf16 v23, s58, v185
    v_dot2c_f32_bf16 v24, s57, v186
    v_dot2c_f32_bf16 v25, s58, v186
    v_dot2c_f32_bf16 v26, s57, v187
    v_dot2c_f32_bf16 v27, s58, v187
    s_waitcnt vmcnt(0)
    v_dot2c_f32_bf16 v20, s57, v188
    v_dot2c_f32_bf16 v21, s58, v188
    v_dot2c_f32_bf16 v22, s57, v189
    v_dot2c_f32_bf16 v23, s58, v189
    v_dot2c_f32_bf16 v24, s57, v190
    v_dot2c_f32_bf16 v25, s58, v190
    v_dot2c_f32_bf16 v26, s57, v191
    v_dot2c_f32_bf16 v27, s58, v191
    s_lshl_b32 s11, s53, 3
    s_add_u32 s11, s11, s55
    s_lshl_b32 s11, s11, 7
    s_lshl_b32 s12, s9, 2
    s_add_u32 s11, s11, s12
    s_add_u32 s13, s11, 45056
    s_add_u32 s11, s62, 1
    v_mov_b32 v10, s11
    buffer_store_dword v10, off, s[4:7], s13 sc1
    s_waitcnt lgkmcnt(0)
    v_cvt_pk_bf16_f32 v40, v20, v21
    v_cvt_pk_bf16_f32 v41, v22, v23
    v_cvt_pk_bf16_f32 v42, v24, v25
    v_cvt_pk_bf16_f32 v43, v26, v27
    v_lshlrev_b32 v20, 16, v40
    v_and_b32 v21, 0xffff0000, v40
    v_lshlrev_b32 v22, 16, v41
    v_and_b32 v23, 0xffff0000, v41
    v_lshlrev_b32 v24, 16, v42
    v_and_b32 v25, 0xffff0000, v42
    v_lshlrev_b32 v26, 16, v43
    v_and_b32 v27, 0xffff0000, v43
    v_lshlrev_b32 v32, 16, v28
    v_and_b32 v33, 0xffff0000, v28
    v_lshlrev_b32 v34, 16, v29
    v_and_b32 v35, 0xffff0000, v29
    v_lshlrev_b32 v36, 16, v30
    v_and_b32 v37, 0xffff0000, v30
    v_lshlrev_b32 v38, 16, v31
    v_and_b32 v39, 0xffff0000, v31
    v_add_f32 v20, v20, v32
    v_add_f32 v21, v21, v33
    v_add_f32 v22, v22, v34
    v_add_f32 v23, v23, v35
    v_add_f32 v24, v24, v36
    v_add_f32 v25, v25, v37
    v_add_f32 v26, v26, v38
    v_add_f32 v27, v27, v39
    v_cvt_pk_bf16_f32 v40, v20, v21
    v_cvt_pk_bf16_f32 v41, v22, v23
    v_cvt_pk_bf16_f32 v42, v24, v25
    v_cvt_pk_bf16_f32 v43, v26, v27
    v_lshlrev_b32 v32, 16, v40
    v_and_b32 v33, 0xffff0000, v40
    v_lshlrev_b32 v34, 16, v41
    v_and_b32 v35, 0xffff0000, v41
    v_lshlrev_b32 v36, 16, v42
    v_and_b32 v37, 0xffff0000, v42
    v_lshlrev_b32 v38, 16, v43
    v_and_b32 v39, 0xffff0000, v43
    s_lshl_b32 s11, s62, 15
    buffer_store_dwordx4 v[40:43], v3, s[20:23], s11 offen
    s_add_u32 s62, s62, 4
    s_mov_b32 s15, 0
    s_branch abw_72
abn_74:
    s_sleep 1
    s_branch abw_72
abok_73:
    s_and_b32 s11, s10, 7
    s_lshl_b32 s11, s11, 18
    s_lshl_b32 s12, s8, 10
    s_add_u32 s11, s11, s12
    s_add_u32 s11, s11, 31457280
    buffer_load_dwordx4 v[160:163], v0, s[4:7], s11 offen sc1
    s_add_u32 s11, s11, 32768
    buffer_load_dwordx4 v[164:167], v0, s[4:7], s11 offen sc1
    s_add_u32 s11, s11, 32768
    buffer_load_dwordx4 v[168:171], v0, s[4:7], s11 offen sc1
    s_add_u32 s11, s11, 32768
    buffer_load_dwordx4 v[172:175], v0, s[4:7], s11 offen sc1
    s_add_u32 s11, s11, 32768
    buffer_load_dwordx4 v[176:179], v0, s[4:7], s11 offen sc1
    s_add_u32 s11, s11, 32768
    buffer_load_dwordx4 v[180:183], v0, s[4:7], s11 offen sc1
    s_add_u32 s11, s11, 32768
    buffer_load_dwordx4 v[184:187], v0, s[4:7], s11 offen sc1
    s_add_u32 s11, s11, 32768
    buffer_load_dwordx4 v[188:191], v0, s[4:7], s11 offen sc1
    s_lshl_b32 s11, s10, 15
    s_add_u32 s11, s11, 4194304
    s_lshl_b32 s14, s8, 10
    s_add_u32 s11, s11, s14
    buffer_load_dwordx4 v[28:31], v0, s[4:7], s11 offen sc1
    s_mov_b32 s57, 0x3f80
    s_mov_b32 s58, 0x3f800000
    v_mov_b32 v20, 0
    v_mov_b32 v21, 0
    v_mov_b32 v22, 0
    v_mov_b32 v23, 0
    v_mov_b32 v24, 0
    v_mov_b32 v25, 0
    v_mov_b32 v26, 0
    v_mov_b32 v27, 0
    s_waitcnt vmcnt(8)
    v_dot2c_f32_bf16 v20, s57, v160
    v_dot2c_f32_bf16 v21, s58, v160
    v_dot2c_f32_bf16 v22, s57, v161
    v_dot2c_f32_bf16 v23, s58, v161
    v_dot2c_f32_bf16 v24, s57, v162
    v_dot2c_f32_bf16 v25, s58, v162
    v_dot2c_f32_bf16 v26, s57, v163
    v_dot2c_f32_bf16 v27, s58, v163
    s_waitcnt vmcnt(7)
    v_dot2c_f32_bf16 v20, s57, v164
    v_dot2c_f32_bf16 v21, s58, v164
    v_dot2c_f32_bf16 v22, s57, v165
    v_dot2c_f32_bf16 v23, s58, v165
    v_dot2c_f32_bf16 v24, s57, v166
    v_dot2c_f32_bf16 v25, s58, v166
    v_dot2c_f32_bf16 v26, s57, v167
    v_dot2c_f32_bf16 v27, s58, v167
    s_waitcnt vmcnt(6)
    v_dot2c_f32_bf16 v20, s57, v168
    v_dot2c_f32_bf16 v21, s58, v168
    v_dot2c_f32_bf16 v22, s57, v169
    v_dot2c_f32_bf16 v23, s58, v169
    v_dot2c_f32_bf16 v24, s57, v170
    v_dot2c_f32_bf16 v25, s58, v170
    v_dot2c_f32_bf16 v26, s57, v171
    v_dot2c_f32_bf16 v27, s58, v171
    s_waitcnt vmcnt(5)
    v_dot2c_f32_bf16 v20, s57, v172
    v_dot2c_f32_bf16 v21, s58, v172
    v_dot2c_f32_bf16 v22, s57, v173
    v_dot2c_f32_bf16 v23, s58, v173
    v_dot2c_f32_bf16 v24, s57, v174
    v_dot2c_f32_bf16 v25, s58, v174
    v_dot2c_f32_bf16 v26, s57, v175
    v_dot2c_f32_bf16 v27, s58, v175
    s_waitcnt vmcnt(4)
    v_dot2c_f32_bf16 v20, s57, v176
    v_dot2c_f32_bf16 v21, s58, v176
    v_dot2c_f32_bf16 v22, s57, v177
    v_dot2c_f32_bf16 v23, s58, v177
    v_dot2c_f32_bf16 v24, s57, v178
    v_dot2c_f32_bf16 v25, s58, v178
    v_dot2c_f32_bf16 v26, s57, v179
    v_dot2c_f32_bf16 v27, s58, v179
    s_waitcnt vmcnt(3)
    v_dot2c_f32_bf16 v20, s57, v180
    v_dot2c_f32_bf16 v21, s58, v180
    v_dot2c_f32_bf16 v22, s57, v181
    v_dot2c_f32_bf16 v23, s58, v181
    v_dot2c_f32_bf16 v24, s57, v182
    v_dot2c_f32_bf16 v25, s58, v182
    v_dot2c_f32_bf16 v26, s57, v183
    v_dot2c_f32_bf16 v27, s58, v183
    s_waitcnt vmcnt(2)
    v_dot2c_f32_bf16 v20, s57, v184
    v_dot2c_f32_bf16 v21, s58, v184
    v_dot2c_f32_bf16 v22, s57, v185
    v_dot2c_f32_bf16 v23, s58, v185
    v_dot2c_f32_bf16 v24, s57, v186
    v_dot2c_f32_bf16 v25, s58, v186
    v_dot2c_f32_bf16 v26, s57, v187
    v_dot2c_f32_bf16 v27, s58, v187
    s_waitcnt vmcnt(1)
    v_dot2c_f32_bf16 v20, s57, v188
    v_dot2c_f32_bf16 v21, s58, v188
    v_dot2c_f32_bf16 v22, s57, v189
    v_dot2c_f32_bf16 v23, s58, v189
    v_dot2c_f32_bf16 v24, s57, v190
    v_dot2c_f32_bf16 v25, s58, v190
    v_dot2c_f32_bf16 v26, s57, v191
    v_dot2c_f32_bf16 v27, s58, v191
    s_waitcnt vmcnt(0)
    v_cvt_pk_bf16_f32 v40, v20, v21
    v_cvt_pk_bf16_f32 v41, v22, v23
    v_cvt_pk_bf16_f32 v42, v24, v25
    v_cvt_pk_bf16_f32 v43, v26, v27
    v_lshlrev_b32 v20, 16, v40
    v_and_b32 v21, 0xffff0000, v40
    v_lshlrev_b32 v22, 16, v41
    v_and_b32 v23, 0xffff0000, v41
    v_lshlrev_b32 v24, 16, v42
    v_and_b32 v25, 0xffff0000, v42
    v_lshlrev_b32 v26, 16, v43
    v_and_b32 v27, 0xffff0000, v43
    v_lshlrev_b32 v32, 16, v28
    v_and_b32 v33, 0xffff0000, v28
    v_lshlrev_b32 v34, 16, v29
    v_and_b32 v35, 0xffff0000, v29
    v_lshlrev_b32 v36, 16, v30
    v_and_b32 v37, 0xffff0000, v30
    v_lshlrev_b32 v38, 16, v31
    v_and_b32 v39, 0xffff0000, v31
    v_add_f32 v20, v20, v32
    v_add_f32 v21, v21, v33
    v_add_f32 v22, v22, v34
    v_add_f32 v23, v23, v35
    v_add_f32 v24, v24, v36
    v_add_f32 v25, v25, v37
    v_add_f32 v26, v26, v38
    v_add_f32 v27, v27, v39
    v_cvt_pk_bf16_f32 v40, v20, v21
    v_cvt_pk_bf16_f32 v41, v22, v23
    v_cvt_pk_bf16_f32 v42, v24, v25
    v_cvt_pk_bf16_f32 v43, v26, v27
    v_lshlrev_b32 v32, 16, v40
    v_and_b32 v33, 0xffff0000, v40
    v_lshlrev_b32 v34, 16, v41
    v_and_b32 v35, 0xffff0000, v41
    v_lshlrev_b32 v36, 16, v42
    v_and_b32 v37, 0xffff0000, v42
    v_lshlrev_b32 v38, 16, v43
    v_and_b32 v39, 0xffff0000, v43
    v_mov_b32 v100, v40
    v_mov_b32 v101, v41
    v_mov_b32 v102, v42
    v_mov_b32 v103, v43
    s_add_u32 s63, s53, 20
    v_add_f32 v44, v32, v33
    v_mul_f32 v45, v32, v32
    v_add_f32 v12, v34, v35
    v_fmac_f32 v45, v33, v33
    v_add_f32 v13, v36, v37
    v_mul_f32 v15, v34, v34
    v_add_f32 v14, v38, v39
    v_fmac_f32 v15, v35, v35
    v_add_f32 v44, v44, v12
    v_fmac_f32 v45, v36, v36
    v_add_f32 v13, v13, v14
    v_fmac_f32 v15, v37, v37
    v_add_f32 v44, v44, v13
    v_fmac_f32 v45, v38, v38
    v_fmac_f32 v15, v39, v39
    v_add_f32 v45, v45, v15
    v_mov_b32 v12, v44
    v_mov_b32 v13, v45
    s_nop 0
    v_permlane32_swap_b32 v44, v12
    v_permlane32_swap_b32 v45, v13
    v_add_f32 v44, v44, v12
    v_add_f32 v45, v45, v13
    v_lshrrev_b32 v14, 1, v0
    v_and_b32 v14, 0xff, v14
    s_lshl_b32 s11, s9, 8
    s_add_u32 s11, s11, 81920
    v_add_u32 v15, s11, v14
    ds_write_b64 v15, v[44:45]
    s_waitcnt lgkmcnt(0)
    s_barrier
    v_add_u32 v14, 81920, v14
    ds_read_b64 v[104:105], v14 offset:0
    ds_read_b64 v[106:107], v14 offset:256
    ds_read_b64 v[108:109], v14 offset:512
    ds_read_b64 v[110:111], v14 offset:768
    s_add_u32 s11, s56, 0
    s_and_b32 s11, s11, 3
    s_lshl_b32 s14, s63, 2
    s_add_u32 s11, s11, s14
    s_lshl_b32 s11, s11, 11
    s_add_u32 s11, s11, 2162688
    s_add_u32 s12, s56, 0
    s_and_b32 s12, s12, 3
    s_lshl_b32 s14, s63, 2
    s_add_u32 s12, s12, s14
    s_lshl_b32 s12, s12, 11
    s_add_u32 s12, s12, 2162688
    s_mov_b32 s13, s11
    s_waitcnt lgkmcnt(0)
    v_add_f32 v104, v104, v106
    v_add_f32 v105, v105, v107
    v_add_f32 v108, v108, v110
    v_add_f32 v109, v109, v111
    v_add_f32 v44, v104, v108
    v_add_f32 v45, v105, v109
    s_cmp_lg_u32 s9, 0
    s_cbranch_scc1 lnp_75
    s_mov_b64 exec, s[24:25]
    buffer_store_dwordx2 v[44:45], v4, s[4:7], s11 offen sc1
    s_mov_b64 exec, -1
lnp_75:
    s_mov_b32 s15, 0
sg_76:
    buffer_load_dwordx4 v[104:107], v0, s[4:7], s13 offen offset:0 sc1
    buffer_load_dwordx4 v[108:111], v0, s[4:7], s13 offen offset:1024 sc1
    s_add_u32 s15, s15, 1
    s_cmp_gt_u32 s15, 200000
    s_cbranch_scc1 K_FAIL
    s_waitcnt vmcnt(0)
    v_add_f32 v104, v104, v108
    v_add_f32 v105, v105, v109
    v_add_f32 v106, v106, v110
    v_add_f32 v107, v107, v111
    v_add_f32 v44, v104, v106
    v_add_f32 v45, v105, v107
    v_cmp_u_f32 vcc, v44, v45
    s_cbranch_vccz sgok_77
    s_branch sg_76
sgok_77:
    s_cmp_lg_u32 s9, 0
    s_cbranch_scc1 lnr_78
    s_add_u32 s11, s56, 3
    s_and_b32 s11, s11, 3
    s_lshl_b32 s14, s63, 2
    s_add_u32 s11, s11, s14
    s_lshl_b32 s11, s11, 11
    s_add_u32 s11, s11, 2162688
    s_mov_b64 exec, s[24:25]
    buffer_store_dwordx2 v[18:19], v4, s[4:7], s11 offen sc1
    s_mov_b64 exec, -1
lnr_78:
    v_mov_b32 v12, v44
    v_mov_b32 v13, v45
    s_nop 0
    v_permlane32_swap_b32 v44, v12
    v_permlane32_swap_b32 v45, v13
    v_add_f32 v44, v44, v12
    v_add_f32 v45, v45, v13
    v_mul_f32 v44, 0x3b000000, v44
    v_mul_f32 v45, 0x3b000000, v45
    v_fma_f32 v45, -v44, v44, v45
    v_max_f32 v45, 0, v45
    v_add_f32 v45, 0x3727c5ac, v45
    v_rsq_f32 v45, v45
    v_sub_f32 v32, v32, v44
    v_sub_f32 v33, v33, v44
    v_sub_f32 v34, v34, v44
    v_sub_f32 v35, v35, v44
    v_sub_f32 v36, v36, v44
    v_sub_f32 v37, v37, v44
    v_sub_f32 v38, v38, v44
    v_sub_f32 v39, v39, v44
    v_mul_f32 v32, v32, v45
    v_mul_f32 v33, v33, v45
    v_mul_f32 v34, v34, v45
    v_mul_f32 v35, v35, v45
    v_mul_f32 v36, v36, v45
    v_mul_f32 v37, v37, v45
    v_mul_f32 v38, v38, v45
    v_mul_f32 v39, v39, v45
    v_cvt_pk_bf16_f32 v40, v32, v33
    v_cvt_pk_bf16_f32 v41, v34, v35
    v_cvt_pk_bf16_f32 v42, v36, v37
    v_cvt_pk_bf16_f32 v43, v38, v39
    s_and_b32 s11, s10, 15
    s_lshl_b32 s11, s11, 15
    s_add_u32 s11, s11, 12582912
    s_lshl_b32 s14, s8, 10
    s_add_u32 s11, s11, s14
    buffer_store_dwordx4 v[40:43], v0, s[4:7], s11 offen sc1
    s_add_u32 s59, s53, 20
    s_lshl_b32 s59, s59, 7
    s_add_u32 s59, s59, 98304
    s_lshl_b32 s14, s55, 2
    s_add_u32 s59, s59, s14
    s_waitcnt vmcnt(0)
    s_barrier
    s_cmp_lg_u32 s9, 0
    s_cbranch_scc1 pb_79
    s_add_u32 s11, s10, 1
    v_mov_b32 v10, s11
    buffer_store_dword v10, off, s[4:7], s59 sc1
pb_79:
    s_add_u32 s59, s53, 20
    s_lshl_b32 s59, s59, 7
    s_add_u32 s59, s59, 98304
    s_sub_u32 s52, s10, 1
    s_and_b32 s60, s52, 3
    s_add_u32 s60, s60, 20
    s_lshl_b32 s60, s60, 7
    s_add_u32 s60, s60, 98304
    s_cmp_eq_u32 s10, 0
    s_cselect_b32 s60, s59, s60
    s_cselect_b32 s58, 0, 1
    s_mov_b32 s15, 0
aw_83:
    buffer_load_dword v10, v2, s[4:7], s59 offen sc1
    buffer_load_dword v16, v2, s[4:7], s60 offen sc1
    s_add_u32 s15, s15, 1
    s_cmp_gt_u32 s15, 200000
    s_cbranch_scc1 K_FAIL
    s_waitcnt vmcnt(0)
    v_add_u32 v16, s58, v16
    v_min_u32 v10, v10, v16
    v_cmp_ge_u32 vcc, s10, v10
    s_cbranch_vccz awok_84
    s_branch aw_83
awok_84:
    s_and_b32 s61, s10, 15
    s_lshl_b32 s61, s61, 15
    s_add_u32 s61, s61, 12582912
    s_lshl_b32 s11, s9, 13
    s_add_u32 s12, s61, s11
    s_add_u32 s11, s11, 0
    s_mov_b32 m0, s11
    s_nop 0
    buffer_load_dwordx4 v0, s[4:7], s12 offen offset:0 sc1 lds
    buffer_load_dwordx4 v0, s[4:7], s12 offen offset:1024 sc1 lds
    buffer_load_dwordx4 v0, s[4:7], s12 offen offset:2048 sc1 lds
    buffer_load_dwordx4 v0, s[4:7], s12 offen offset:3072 sc1 lds
    s_add_u32 s11, s11, 4096
    s_add_u32 s12, s12, 4096
    s_mov_b32 m0, s11
    s_nop 0
    buffer_load_dwordx4 v0, s[4:7], s12 offen offset:0 sc1 lds
    buffer_load_dwordx4 v0, s[4:7], s12 offen offset:1024 sc1 lds
    buffer_load_dwordx4 v0, s[4:7], s12 offen offset:2048 sc1 lds
    buffer_load_dwordx4 v0, s[4:7], s12 offen offset:3072 sc1 lds
    s_cmp_eq_u32 s10, 0
    s_cbranch_scc1 h3_80
    s_and_b32 s61, s52, 15
    s_lshl_b32 s61, s61, 15
    s_add_u32 s61, s61, 12582912
    s_lshl_b32 s11, s9, 13
    s_add_u32 s12, s61, s11
    s_add_u32 s12, s12, 256
    s_lshl_b32 s11, s9, 12
    s_add_u32 s11, s11, 65536
    s_mov_b32 m0, s11
    s_nop 0
    buffer_load_dwordx4 v1, s[4:7], s12 offen sc1 lds
    s_add_u32 s11, s11, 1024
    s_add_u32 s12, s12, 2048
    s_mov_b32 m0, s11
    s_nop 0
    buffer_load_dwordx4 v1, s[4:7], s12 offen sc1 lds
    s_add_u32 s11, s11, 1024
    s_add_u32 s12, s12, 2048
    s_mov_b32 m0, s11
    s_nop 0
    buffer_load_dwordx4 v1, s[4:7], s12 offen sc1 lds
    s_add_u32 s11, s11, 1024
    s_add_u32 s12, s12, 2048
    s_mov_b32 m0, s11
    s_nop 0
    buffer_load_dwordx4 v1, s[4:7], s12 offen sc1 lds
h3_80:
    s_waitcnt vmcnt(0)
    s_barrier
    s_cmp_eq_u32 s10, 0
    s_cbranch_scc1 h3_81
    v_add_u32 v8, 65536, v0
    ds_read_b128 v[128:131], v8 offset:0
    ds_read_b128 v[132:135], v8 offset:1024
    ds_read_b128 v[136:139], v8 offset:2048
    ds_read_b128 v[140:143], v8 offset:3072
    s_waitcnt lgkmcnt(3)
    v_mfma_f32_16x16x32_bf16 v[32:35], a[64:67], v[128:131], 0
    ds_read_b128 v[144:147], v8 offset:4096
    v_mfma_f32_16x16x32_bf16 v[40:43], v[128:131], a[128:131], 0
    s_waitcnt lgkmcnt(3)
    v_mfma_f32_16x16x32_bf16 v[32:35], a[68:71], v[132:135], v[32:35]
    ds_read_b128 v[148:151], v8 offset:5120
    v_mfma_f32_16x16x32_bf16 v[40:43], v[132:135], a[132:135], v[40:43]
    s_waitcnt lgkmcnt(3)
    v_mfma_f32_16x16x32_bf16 v[32:35], a[72:75], v[136:139], v[32:35]
    ds_read_b128 v[128:131], v8 offset:6144
    v_mfma_f32_16x16x32_bf16 v[40:43], v[136:139], a[136:139], v[40:43]
    s_waitcnt lgkmcnt(3)
    v_mfma_f32_16x16x32_bf16 v[32:35], a[76:79], v[140:143], v[32:35]
    ds_read_b128 v[132:135], v8 offset:7168
    v_mfma_f32_16x16x32_bf16 v[40:43], v[140:143], a[140:143], v[40:43]
    s_waitcnt lgkmcnt(3)
    v_mfma_f32_16x16x32_bf16 v[32:35], a[80:83], v[144:147], v[32:35]
    ds_read_b128 v[136:139], v8 offset:8192
    v_mfma_f32_16x16x32_bf16 v[40:43], v[144:147], a[144:147], v[40:43]
    s_waitcnt lgkmcnt(3)
    v_mfma_f32_16x16x32_bf16 v[32:35], a[84:87], v[148:151], v[32:35]
    ds_read_b128 v[140:143], v8 offset:9216
    v_mfma_f32_16x16x32_bf16 v[40:43], v[148:151], a[148:151], v[40:43]
    s_waitcnt lgkmcnt(3)
    v_mfma_f32_16x16x32_bf16 v[32:35], a[88:91], v[128:131], v[32:35]
    ds_read_b128 v[144:147], v8 offset:10240
    v_mfma_f32_16x16x32_bf16 v[40:43], v[128:131], a[152:155], v[40:43]
    s_waitcnt lgkmcnt(3)
    v_mfma_f32_16x16x32_bf16 v[32:35], a[92:95], v[132:135], v[32:35]
    ds_read_b128 v[148:151], v8 offset:11264
    v_mfma_f32_16x16x32_bf16 v[40:43], v[132:135], a[156:159], v[40:43]
    s_waitcnt lgkmcnt(3)
    v_mfma_f32_16x16x32_bf16 v[32:35], a[96:99], v[136:139], v[32:35]
    ds_read_b128 v[128:131], v8 offset:12288
    v_mfma_f32_16x16x32_bf16 v[40:43], v[136:139], a[160:163], v[40:43]
    s_waitcnt lgkmcnt(3)
    v_mfma_f32_16x16x32_bf16 v[32:35], a[100:103], v[140:143], v[32:35]
    ds_read_b128 v[132:135], v8 offset:13312
    v_mfma_f32_16x16x32_bf16 v[40:43], v[140:143], a[164:167], v[40:43]
    s_waitcnt lgkmcnt(3)
    v_mfma_f32_16x16x32_bf16 v[32:35], a[104:107], v[144:147], v[32:35]
    ds_read_b128 v[136:139], v8 offset:14336
    v_mfma_f32_16x16x32_bf16 v[40:43], v[144:147], a[168:171], v[40:43]
    s_waitcnt lgkmcnt(3)
    v_mfma_f32_16x16x32_bf16 v[32:35], a[108:111], v[148:151], v[32:35]
    ds_read_b128 v[140:143], v8 offset:15360
    v_mfma_f32_16x16x32_bf16 v[40:43], v[148:151], a[172:175], v[40:43]
    s_waitcnt lgkmcnt(3)
    v_mfma_f32_16x16x32_bf16 v[32:35], a[112:115], v[128:131], v[32:35]
    v_mfma_f32_16x16x32_bf16 v[40:43], v[128:131], a[176:179], v[40:43]
    s_waitcnt lgkmcnt(2)
    v_mfma_f32_16x16x32_bf16 v[32:35], a[116:119], v[132:135], v[32:35]
    v_mfma_f32_16x16x32_bf16 v[40:43], v[132:135], a[180:183], v[40:43]
    s_waitcnt lgkmcnt(1)
    v_mfma_f32_16x16x32_bf16 v[32:35], a[120:123], v[136:139], v[32:35]
    v_mfma_f32_16x16x32_bf16 v[40:43], v[136:139], a[184:187], v[40:43]
    s_waitcnt lgkmcnt(0)
    v_mfma_f32_16x16x32_bf16 v[32:35], a[124:127], v[140:143], v[32:35]
    v_mfma_f32_16x16x32_bf16 v[40:43], v[140:143], a[188:191], v[40:43]
    s_nop 6
    v_cvt_pk_bf16_f32 v48, v32, v33
    v_cvt_pk_bf16_f32 v49, v34, v35
    v_cvt_pk_bf16_f32 v54, v40, v41
    v_cvt_pk_bf16_f32 v55, v42, v43
    s_branch h3_82
h3_81:
    v_mov_b32 v48, 0
    v_mov_b32 v49, 0
    v_mov_b32 v54, 0
    v_mov_b32 v55, 0
h3_82:
    v_add_u32 v8, 0, v1
    ds_read_b128 v[128:131], v8 offset:0
    ds_read_b128 v[132:135], v8 offset:256
    ds_read_b128 v[136:139], v8 offset:2048
    ds_read_b128 v[140:143], v8 offset:2304
    ds_read_b128 v[144:147], v8 offset:4096
    ds_read_b128 v[148:151], v8 offset:4352
    s_waitcnt lgkmcnt(4)
    v_mfma_f32_16x16x32_bf16 v[20:23], a[0:3], v[128:131], 0
    v_mfma_f32_16x16x32_bf16 v[28:31], a[64:67], v[128:131], 0
    v_mfma_f32_16x16x32_bf16 v[36:39], v[128:131], a[128:131], 0
    v_mfma_f32_16x16x32_bf16 v[24:27], a[0:3], v[132:135], 0
    v_mfma_f32_16x16x32_bf16 v[32:35], a[64:67], v[132:135], 0
    v_mfma_f32_16x16x32_bf16 v[40:43], v[132:135], a[128:131], 0
    ds_read_b128 v[128:131], v8 offset:6144
    ds_read_b128 v[132:135], v8 offset:6400
    s_waitcnt lgkmcnt(4)
    v_mfma_f32_16x16x32_bf16 v[20:23], a[4:7], v[136:139], v[20:23]
    v_mfma_f32_16x16x32_bf16 v[28:31], a[68:71], v[136:139], v[28:31]
    v_mfma_f32_16x16x32_bf16 v[36:39], v[136:139], a[132:135], v[36:39]
    v_mfma_f32_16x16x32_bf16 v[24:27], a[4:7], v[140:143], v[24:27]
    v_mfma_f32_16x16x32_bf16 v[32:35], a[68:71], v[140:143], v[32:35]
    v_mfma_f32_16x16x32_bf16 v[40:43], v[140:143], a[132:135], v[40:43]
    ds_read_b128 v[136:139], v8 offset:8192
    ds_read_b128 v[140:143], v8 offset:8448
    s_waitcnt lgkmcnt(4)
    v_mfma_f32_16x16x32_bf16 v[20:23], a[8:11], v[144:147], v[20:23]
    v_mfma_f32_16x16x32_bf16 v[28:31], a[72:75], v[144:147], v[28:31]
    v_mfma_f32_16x16x32_bf16 v[36:39], v[144:147], a[136:139], v[36:39]
    v_mfma_f32_16x16x32_bf16 v[24:27], a[8:11], v[148:151], v[24:27]
    v_mfma_f32_16x16x32_bf16 v[32:35], a[72:75], v[148:151], v[32:35]
    v_mfma_f32_16x16x32_bf16 v[40:43], v[148:151], a[136:139], v[40:43]
    ds_read_b128 v[144:147], v8 offset:10240
    ds_read_b128 v[148:151], v8 offset:10496
    s_waitcnt lgkmcnt(4)
    v_mfma_f32_16x16x32_bf16 v[20:23], a[12:15], v[128:131], v[20:23]
    v_mfma_f32_16x16x32_bf16 v[28:31], a[76:79], v[128:131], v[28:31]
    v_mfma_f32_16x16x32_bf16 v[36:39], v[128:131], a[140:143], v[36:39]
    v_mfma_f32_16x16x32_bf16 v[24:27], a[12:15], v[132:135], v[24:27]
    v_mfma_f32_16x16x32_bf16 v[32:35], a[76:79], v[132:135], v[32:35]
    v_mfma_f32_16x16x32_bf16 v[40:43], v[132:135], a[140:143], v[40:43]
    ds_read_b128 v[128:131], v8 offset:12288
    ds_read_b128 v[132:135], v8 offset:12544
    s_waitcnt lgkmcnt(4)
    v_mfma_f32_16x16x32_bf16 v[20:23], a[16:19], v[136:139], v[20:23]
    v_mfma_f32_16x16x32_bf16 v[28:31], a[80:83], v[136:139], v[28:31]
    v_mfma_f32_16x16x32_bf16 v[36:39], v[136:139], a[144:147], v[36:39]
    v_mfma_f32_16x16x32_bf16 v[24:27], a[16:19], v[140:143], v[24:27]
    v_mfma_f32_16x16x32_bf16 v[32:35], a[80:83], v[140:143], v[32:35]
    v_mfma_f32_16x16x32_bf16 v[40:43], v[140:143], a[144:147], v[40:43]
    ds_read_b128 v[136:139], v8 offset:14336
    ds_read_b128 v[140:143], v8 offset:14592
    s_waitcnt lgkmcnt(4)
    v_mfma_f32_16x16x32_bf16 v[20:23], a[20:23], v[144:147], v[20:23]
    v_mfma_f32_16x16x32_bf16 v[28:31], a[84:87], v[144:147], v[28:31]
    v_mfma_f32_16x16x32_bf16 v[36:39], v[144:147], a[148:151], v[36:39]
    v_mfma_f32_16x16x32_bf16 v[24:27], a[20:23], v[148:151], v[24:27]
    v_mfma_f32_16x16x32_bf16 v[32:35], a[84:87], v[148:151], v[32:35]
    v_mfma_f32_16x16x32_bf16 v[40:43], v[148:151], a[148:151], v[40:43]
    ds_read_b128 v[144:147], v8 offset:16384
    ds_read_b128 v[148:151], v8 offset:16640
    s_waitcnt lgkmcnt(4)
    v_mfma_f32_16x16x32_bf16 v[20:23], a[24:27], v[128:131], v[20:23]
    v_mfma_f32_16x16x32_bf16 v[28:31], a[88:91], v[128:131], v[28:31]
    v_mfma_f32_16x16x32_bf16 v[36:39], v[128:131], a[152:155], v[36:39]
    v_mfma_f32_16x16x32_bf16 v[24:27], a[24:27], v[132:135], v[24:27]
    v_mfma_f32_16x16x32_bf16 v[32:35], a[88:91], v[132:135], v[32:35]
    v_mfma_f32_16x16x32_bf16 v[40:43], v[132:135], a[152:155], v[40:43]
    ds_read_b128 v[128:131], v8 offset:18432
    ds_read_b128 v[132:135], v8 offset:18688
    s_waitcnt lgkmcnt(4)
    v_mfma_f32_16x16x32_bf16 v[20:23], a[28:31], v[136:139], v[20:23]
    v_mfma_f32_16x16x32_bf16 v[28:31], a[92:95], v[136:139], v[28:31]
    v_mfma_f32_16x16x32_bf16 v[36:39], v[136:139], a[156:159], v[36:39]
    v_mfma_f32_16x16x32_bf16 v[24:27], a[28:31], v[140:143], v[24:27]
    v_mfma_f32_16x16x32_bf16 v[32:35], a[92:95], v[140:143], v[32:35]
    v_mfma_f32_16x16x32_bf16 v[40:43], v[140:143], a[156:159], v[40:43]
    ds_read_b128 v[136:139], v8 offset:20480
    ds_read_b128 v[140:143], v8 offset:20736
    s_waitcnt lgkmcnt(4)
    v_mfma_f32_16x16x32_bf16 v[20:23], a[32:35], v[144:147], v[20:23]
    v_mfma_f32_16x16x32_bf16 v[28:31], a[96:99], v[144:147], v[28:31]
    v_mfma_f32_16x16x32_bf16 v[36:39], v[144:147], a[160:163], v[36:39]
    v_mfma_f32_16x16x32_bf16 v[24:27], a[32:35], v[148:151], v[24:27]
    v_mfma_f32_16x16x32_bf16 v[32:35], a[96:99], v[148:151], v[32:35]
    v_mfma_f32_16x16x32_bf16 v[40:43], v[148:151], a[160:163], v[40:43]
    ds_read_b128 v[144:147], v8 offset:22528
    ds_read_b128 v[148:151], v8 offset:22784
    s_waitcnt lgkmcnt(4)
    v_mfma_f32_16x16x32_bf16 v[20:23], a[36:39], v[128:131], v[20:23]
    v_mfma_f32_16x16x32_bf16 v[28:31], a[100:103], v[128:131], v[28:31]
    v_mfma_f32_16x16x32_bf16 v[36:39], v[128:131], a[164:167], v[36:39]
    v_mfma_f32_16x16x32_bf16 v[24:27], a[36:39], v[132:135], v[24:27]
    v_mfma_f32_16x16x32_bf16 v[32:35], a[100:103], v[132:135], v[32:35]
    v_mfma_f32_16x16x32_bf16 v[40:43], v[132:135], a[164:167], v[40:43]
    ds_read_b128 v[128:131], v8 offset:24576
    ds_read_b128 v[132:135], v8 offset:24832
    s_waitcnt lgkmcnt(4)
    v_mfma_f32_16x16x32_bf16 v[20:23], a[40:43], v[136:139], v[20:23]
    v_mfma_f32_16x16x32_bf16 v[28:31], a[104:107], v[136:139], v[28:31]
    v_mfma_f32_16x16x32_bf16 v[36:39], v[136:139], a[168:171], v[36:39]
    v_mfma_f32_16x16x32_bf16 v[24:27], a[40:43], v[140:143], v[24:27]
    v_mfma_f32_16x16x32_bf16 v[32:35], a[104:107], v[140:143], v[32:35]
    v_mfma_f32_16x16x32_bf16 v[40:43], v[140:143], a[168:171], v[40:43]
    ds_read_b128 v[136:139], v8 offset:26624
    ds_read_b128 v[140:143], v8 offset:26880
    s_waitcnt lgkmcnt(4)
    v_mfma_f32_16x16x32_bf16 v[20:23], a[44:47], v[144:147], v[20:23]
    v_mfma_f32_16x16x32_bf16 v[28:31], a[108:111], v[144:147], v[28:31]
    v_mfma_f32_16x16x32_bf16 v[36:39], v[144:147], a[172:175], v[36:39]
    v_mfma_f32_16x16x32_bf16 v[24:27], a[44:47], v[148:151], v[24:27]
    v_mfma_f32_16x16x32_bf16 v[32:35], a[108:111], v[148:151], v[32:35]
    v_mfma_f32_16x16x32_bf16 v[40:43], v[148:151], a[172:175], v[40:43]
    ds_read_b128 v[144:147], v8 offset:28672
    ds_read_b128 v[148:151], v8 offset:28928
    s_waitcnt lgkmcnt(4)
    v_mfma_f32_16x16x32_bf16 v[20:23], a[48:51], v[128:131], v[20:23]
    v_mfma_f32_16x16x32_bf16 v[28:31], a[112:115], v[128:131], v[28:31]
    v_mfma_f32_16x16x32_bf16 v[36:39], v[128:131], a[176:179], v[36:39]
    v_mfma_f32_16x16x32_bf16 v[24:27], a[48:51], v[132:135], v[24:27]
    v_mfma_f32_16x16x32_bf16 v[32:35], a[112:115], v[132:135], v[32:35]
    v_mfma_f32_16x16x32_bf16 v[40:43], v[132:135], a[176:179], v[40:43]
    ds_read_b128 v[128:131], v8 offset:30720
    ds_read_b128 v[132:135], v8 offset:30976
    s_waitcnt lgkmcnt(4)
    v_mfma_f32_16x16x32_bf16 v[20:23], a[52:55], v[136:139], v[20:23]
    v_mfma_f32_16x16x32_bf16 v[28:31], a[116:119], v[136:139], v[28:31]
    v_mfma_f32_16x16x32_bf16 v[36:39], v[136:139], a[180:183], v[36:39]
    v_mfma_f32_16x16x32_bf16 v[24:27], a[52:55], v[140:143], v[24:27]
    v_mfma_f32_16x16x32_bf16 v[32:35], a[116:119], v[140:143], v[32:35]
    v_mfma_f32_16x16x32_bf16 v[40:43], v[140:143], a[180:183], v[40:43]
    s_waitcnt lgkmcnt(2)
    v_mfma_f32_16x16x32_bf16 v[20:23], a[56:59], v[144:147], v[20:23]
    v_mfma_f32_16x16x32_bf16 v[28:31], a[120:123], v[144:147], v[28:31]
    v_mfma_f32_16x16x32_bf16 v[36:39], v[144:147], a[184:187], v[36:39]
    v_mfma_f32_16x16x32_bf16 v[24:27], a[56:59], v[148:151], v[24:27]
    v_mfma_f32_16x16x32_bf16 v[32:35], a[120:123], v[148:151], v[32:35]
    v_mfma_f32_16x16x32_bf16 v[40:43], v[148:151], a[184:187], v[40:43]
    s_waitcnt lgkmcnt(0)
    v_mfma_f32_16x16x32_bf16 v[20:23], a[60:63], v[128:131], v[20:23]
    v_mfma_f32_16x16x32_bf16 v[28:31], a[124:127], v[128:131], v[28:31]
    v_mfma_f32_16x16x32_bf16 v[36:39], v[128:131], a[188:191], v[36:39]
    v_mfma_f32_16x16x32_bf16 v[24:27], a[60:63], v[132:135], v[24:27]
    v_mfma_f32_16x16x32_bf16 v[32:35], a[124:127], v[132:135], v[32:35]
    v_mfma_f32_16x16x32_bf16 v[40:43], v[132:135], a[188:191], v[40:43]
    s_nop 2
    v_cvt_pk_bf16_f32 v44, v20, v21
    v_cvt_pk_bf16_f32 v45, v22, v23
    v_cvt_pk_bf16_f32 v50, v28, v29
    v_cvt_pk_bf16_f32 v51, v30, v31
    v_cvt_pk_bf16_f32 v56, v36, v37
    v_cvt_pk_bf16_f32 v57, v38, v39
    v_cvt_pk_bf16_f32 v46, v24, v25
    v_cvt_pk_bf16_f32 v47, v26, v27
    v_cvt_pk_bf16_f32 v52, v32, v33
    v_cvt_pk_bf16_f32 v53, v34, v35
    v_cvt_pk_bf16_f32 v58, v40, v41
    v_cvt_pk_bf16_f32 v59, v42, v43
    v_mfma_f32_16x16x16_bf16 v[60:63], v[48:49], v[44:45], 0
    v_mfma_f32_16x16x16_bf16 v[64:67], v[50:51], v[44:45], 0
    v_mfma_f32_16x16x16_bf16 v[84:87], v[50:51], v[46:47], 0
    v_mfma_f32_16x16x16_bf16 v[88:91], v[52:53], v[46:47], 0
    s_cmp_eq_u32 s10, 0
    s_cselect_b64 s[44:45], 0, s[28:29]
    s_cselect_b64 s[46:47], 0, s[30:31]
    s_cselect_b64 s[48:49], 0, s[32:33]
    s_cselect_b64 s[50:51], 0, s[34:35]
    v_mov_b32 v11, 0xf149f2ca
    v_cndmask_b32 v60, v11, v60, s[44:45]
    v_cndmask_b32 v84, v11, v84, s[28:29]
    v_cndmask_b32 v61, v11, v61, s[46:47]
    v_cndmask_b32 v85, v11, v85, s[30:31]
    v_cndmask_b32 v62, v11, v62, s[48:49]
    v_cndmask_b32 v86, v11, v86, s[32:33]
    v_cndmask_b32 v63, v11, v63, s[50:51]
    v_cndmask_b32 v87, v11, v87, s[34:35]
    v_cndmask_b32 v64, v11, v64, s[36:37]
    v_cndmask_b32 v88, v11, v88, s[36:37]
    v_cndmask_b32 v65, v11, v65, s[38:39]
    v_cndmask_b32 v89, v11, v89, s[38:39]
    v_cndmask_b32 v66, v11, v66, s[40:41]
    v_cndmask_b32 v90, v11, v90, s[40:41]
    v_cndmask_b32 v67, v11, v67, s[42:43]
    v_cndmask_b32 v91, v11, v91, s[42:43]
    v_max3_f32 v12, v60, v61, v62
    v_max3_f32 v92, v84, v85, v86
    v_max3_f32 v13, v63, v64, v65
    v_max3_f32 v93, v87, v88, v89
    v_max3_f32 v12, v12, v66, v67
    v_max3_f32 v92, v92, v90, v91
    v_max_f32 v12, v12, v13
    v_max_f32 v92, v92, v93
    v_mov_b32 v13, v12
    v_mov_b32 v93, v92
    s_nop 0
    v_permlane16_swap_b32 v12, v13
    v_permlane16_swap_b32 v92, v93
    v_max_f32 v12, v12, v13
    v_max_f32 v92, v92, v93
    v_mov_b32 v13, v12
    v_mov_b32 v93, v92
    s_nop 0
    v_permlane32_swap_b32 v12, v13
    v_permlane32_swap_b32 v92, v93
    v_max_f32 v12, v12, v13
    v_max_f32 v92, v92, v93
    v_mul_f32 v12, s27, v12
    v_mul_f32 v92, s27, v92
    v_fma_f32 v60, v60, s26, v12
    v_fma_f32 v84, v84, s26, v92
    v_fma_f32 v61, v61, s26, v12
    v_fma_f32 v85, v85, s26, v92
    v_fma_f32 v62, v62, s26, v12
    v_fma_f32 v86, v86, s26, v92
    v_fma_f32 v63, v63, s26, v12
    v_fma_f32 v87, v87, s26, v92
    v_fma_f32 v64, v64, s26, v12
    v_fma_f32 v88, v88, s26, v92
    v_fma_f32 v65, v65, s26, v12
    v_fma_f32 v89, v89, s26, v92
    v_fma_f32 v66, v66, s26, v12
    v_fma_f32 v90, v90, s26, v92
    v_fma_f32 v67, v67, s26, v12
    v_fma_f32 v91, v91, s26, v92
    v_exp_f32 v60, v60
    v_exp_f32 v84, v84
    v_exp_f32 v61, v61
    v_exp_f32 v85, v85
    v_exp_f32 v62, v62
    v_exp_f32 v86, v86
    v_exp_f32 v63, v63
    v_exp_f32 v87, v87
    v_exp_f32 v64, v64
    v_exp_f32 v88, v88
    v_exp_f32 v65, v65
    v_exp_f32 v89, v89
    v_exp_f32 v66, v66
    v_exp_f32 v90, v90
    v_exp_f32 v67, v67
    v_exp_f32 v91, v91
    v_cvt_pk_bf16_f32 v68, v60, v61
    v_cvt_pk_bf16_f32 v96, v84, v85
    v_cvt_pk_bf16_f32 v69, v62, v63
    v_cvt_pk_bf16_f32 v97, v86, v87
    v_cvt_pk_bf16_f32 v70, v64, v65
    v_cvt_pk_bf16_f32 v98, v88, v89
    v_cvt_pk_bf16_f32 v71, v66, v67
    v_cvt_pk_bf16_f32 v99, v90, v91
    s_nop 0
    v_mfma_f32_16x16x32_bf16 v[72:75], v[54:57], v[68:71], 0
    v_mfma_f32_16x16x32_bf16 v[76:79], v[56:59], v[96:99], 0
    v_add_f32 v12, v60, v61
    v_add_f32 v92, v84, v85
    v_add_f32 v13, v62, v63
    v_add_f32 v93, v86, v87
    v_add_f32 v14, v64, v65
    v_add_f32 v94, v88, v89
    v_add_f32 v15, v66, v67
    v_add_f32 v95, v90, v91
    v_add_f32 v12, v12, v13
    v_add_f32 v92, v92, v93
    v_add_f32 v14, v14, v15
    v_add_f32 v94, v94, v95
    v_add_f32 v12, v12, v14
    v_add_f32 v92, v92, v94
    v_mov_b32 v13, v12
    v_mov_b32 v93, v92
    s_nop 0
    v_permlane16_swap_b32 v12, v13
    v_permlane16_swap_b32 v92, v93
    v_add_f32 v12, v12, v13
    v_add_f32 v92, v92, v93
    v_mov_b32 v13, v12
    v_mov_b32 v93, v92
    s_nop 0
    v_permlane32_swap_b32 v12, v13
    v_permlane32_swap_b32 v92, v93
    v_add_f32 v12, v12, v13
    v_add_f32 v92, v92, v93
    v_rcp_f32 v12, v12
    v_rcp_f32 v92, v92
    v_mul_f32 v72, v72, v12
    v_mul_f32 v76, v76, v92
    v_mul_f32 v73, v73, v12
    v_mul_f32 v77, v77, v92
    v_mul_f32 v74, v74, v12
    v_mul_f32 v78, v78, v92
    v_mul_f32 v75, v75, v12
    v_mul_f32 v79, v79, v92
    v_permlane16_swap_b32 v72, v76
    v_permlane16_swap_b32 v73, v77
    v_permlane16_swap_b32 v74, v78
    v_permlane16_swap_b32 v75, v79
    v_cvt_pk_bf16_f32 v80, v72, v73
    v_cvt_pk_bf16_f32 v81, v74, v75
    v_cvt_pk_bf16_f32 v82, v76, v77
    v_cvt_pk_bf16_f32 v83, v78, v79
    s_and_b32 s11, s10, 7
    s_lshl_b32 s11, s11, 15
    s_add_u32 s11, s11, 13107200
    s_lshl_b32 s14, s8, 10
    s_add_u32 s11, s11, s14
    buffer_store_dwordx4 v[80:83], v0, s[4:7], s11 offen sc1
    s_add_u32 s59, s53, 24
    s_lshl_b32 s59, s59, 7
    s_add_u32 s59, s59, 98304
    s_lshl_b32 s14, s55, 2
    s_add_u32 s59, s59, s14
    s_waitcnt vmcnt(0)
    s_barrier
    s_cmp_lg_u32 s9, 0
    s_cbranch_scc1 pb_85
    s_add_u32 s11, s10, 1
    v_mov_b32 v10, s11
    buffer_store_dword v10, off, s[4:7], s59 sc1
pb_85:
    s_sub_u32 s52, s10, 16
nf_86:
    s_cmp_gt_i32 s62, s52
    s_cbranch_scc1 nf_87
    s_mov_b32 s59, 43008
    s_mov_b32 s15, 0
aw_88:
    buffer_load_dword v10, v7, s[4:7], s59 offen sc1
    s_add_u32 s15, s15, 1
    s_cmp_gt_u32 s15, 200000
    s_cbranch_scc1 K_FAIL
    s_waitcnt vmcnt(0)
    v_cmp_ge_u32 vcc, s62, v10
    s_cbranch_vccz awok_89
    s_sleep 1
    s_branch aw_88
awok_89:
    s_and_b32 s11, s62, 7
    s_lshl_b32 s11, s11, 18
    s_lshl_b32 s12, s8, 10
    s_add_u32 s11, s11, s12
    s_add_u32 s11, s11, 33554432
    buffer_load_dwordx4 v[160:163], v0, s[4:7], s11 offen sc1
    s_add_u32 s11, s11, 32768
    buffer_load_dwordx4 v[164:167], v0, s[4:7], s11 offen sc1
    s_add_u32 s11, s11, 32768
    buffer_load_dwordx4 v[168:171], v0, s[4:7], s11 offen sc1
    s_add_u32 s11, s11, 32768
    buffer_load_dwordx4 v[172:175], v0, s[4:7], s11 offen sc1
    s_add_u32 s11, s11, 32768
    buffer_load_dwordx4 v[176:179], v0, s[4:7], s11 offen sc1
    s_add_u32 s11, s11, 32768
    buffer_load_dwordx4 v[180:183], v0, s[4:7], s11 offen sc1
    s_add_u32 s11, s11, 32768
    buffer_load_dwordx4 v[184:187], v0, s[4:7], s11 offen sc1
    s_add_u32 s11, s11, 32768
    buffer_load_dwordx4 v[188:191], v0, s[4:7], s11 offen sc1
    s_lshr_b32 s11, s62, 2
    s_and_b32 s11, s11, 7
    s_lshl_b32 s11, s11, 12
    s_lshl_b32 s12, s9, 10
    s_add_u32 s11, s11, s12
    s_add_u32 s11, s11, 83968
    v_add_u32 v14, s11, v0
    ds_read_b128 v[28:31], v14
    s_mov_b32 s57, 0x3f80
    s_mov_b32 s58, 0x3f800000
    v_mov_b32 v20, 0
    v_mov_b32 v21, 0
    v_mov_b32 v22, 0
    v_mov_b32 v23, 0
    v_mov_b32 v24, 0
    v_mov_b32 v25, 0
    v_mov_b32 v26, 0
    v_mov_b32 v27, 0
    s_waitcnt vmcnt(7)
    v_dot2c_f32_bf16 v20, s57, v160
    v_dot2c_f32_bf16 v21, s58, v160
    v_dot2c_f32_bf16 v22, s57, v161
    v_dot2c_f32_bf16 v23, s58, v161
    v_dot2c_f32_bf16 v24, s57, v162
    v_dot2c_f32_bf16 v25, s58, v162
    v_dot2c_f32_bf16 v26, s57, v163
    v_dot2c_f32_bf16 v27, s58, v163
    s_waitcnt vmcnt(6)
    v_dot2c_f32_bf16 v20, s57, v164
    v_dot2c_f32_bf16 v21, s58, v164
    v_dot2c_f32_bf16 v22, s57, v165
    v_dot2c_f32_bf16 v23, s58, v165
    v_dot2c_f32_bf16 v24, s57, v166
    v_dot2c_f32_bf16 v25, s58, v166
    v_dot2c_f32_bf16 v26, s57, v167
    v_dot2c_f32_bf16 v27, s58, v167
    s_waitcnt vmcnt(5)
    v_dot2c_f32_bf16 v20, s57, v168
    v_dot2c_f32_bf16 v21, s58, v168
    v_dot2c_f32_bf16 v22, s57, v169
    v_dot2c_f32_bf16 v23, s58, v169
    v_dot2c_f32_bf16 v24, s57, v170
    v_dot2c_f32_bf16 v25, s58, v170
    v_dot2c_f32_bf16 v26, s57, v171
    v_dot2c_f32_bf16 v27, s58, v171
    s_waitcnt vmcnt(4)
    v_dot2c_f32_bf16 v20, s57, v172
    v_dot2c_f32_bf16 v21, s58, v172
    v_dot2c_f32_bf16 v22, s57, v173
    v_dot2c_f32_bf16 v23, s58, v173
    v_dot2c_f32_bf16 v24, s57, v174
    v_dot2c_f32_bf16 v25, s58, v174
    v_dot2c_f32_bf16 v26, s57, v175
    v_dot2c_f32_bf16 v27, s58, v175
    s_waitcnt vmcnt(3)
    v_dot2c_f32_bf16 v20, s57, v176
    v_dot2c_f32_bf16 v21, s58, v176
    v_dot2c_f32_bf16 v22, s57, v177
    v_dot2c_f32_bf16 v23, s58, v177
    v_dot2c_f32_bf16 v24, s57, v178
    v_dot2c_f32_bf16 v25, s58, v178
    v_dot2c_f32_bf16 v26, s57, v179
    v_dot2c_f32_bf16 v27, s58, v179
    s_waitcnt vmcnt(2)
    v_dot2c_f32_bf16 v20, s57, v180
    v_dot2c_f32_bf16 v21, s58, v180
    v_dot2c_f32_bf16 v22, s57, v181
    v_dot2c_f32_bf16 v23, s58, v181
    v_dot2c_f32_bf16 v24, s57, v182
    v_dot2c_f32_bf16 v25, s58, v182
    v_dot2c_f32_bf16 v26, s57, v183
    v_dot2c_f32_bf16 v27, s58, v183
    s_waitcnt vmcnt(1)
    v_dot2c_f32_bf16 v20, s57, v184
    v_dot2c_f32_bf16 v21, s58, v184
    v_dot2c_f32_bf16 v22, s57, v185
    v_dot2c_f32_bf16 v23, s58, v185
    v_dot2c_f32_bf16 v24, s57, v186
    v_dot2c_f32_bf16 v25, s58, v186
    v_dot2c_f32_bf16 v26, s57, v187
    v_dot2c_f32_bf16 v27, s58, v187
    s_waitcnt vmcnt(0)
    v_dot2c_f32_bf16 v20, s57, v188
    v_dot2c_f32_bf16 v21, s58, v188
    v_dot2c_f32_bf16 v22, s57, v189
    v_dot2c_f32_bf16 v23, s58, v189
    v_dot2c_f32_bf16 v24, s57, v190
    v_dot2c_f32_bf16 v25, s58, v190
    v_dot2c_f32_bf16 v26, s57, v191
    v_dot2c_f32_bf16 v27, s58, v191
    s_lshl_b32 s11, s53, 3
    s_add_u32 s11, s11, s55
    s_lshl_b32 s11, s11, 7
    s_lshl_b32 s12, s9, 2
    s_add_u32 s11, s11, s12
    s_add_u32 s13, s11, 45056
    s_add_u32 s11, s62, 1
    v_mov_b32 v10, s11
    buffer_store_dword v10, off, s[4:7], s13 sc1
    s_waitcnt lgkmcnt(0)
    v_cvt_pk_bf16_f32 v40, v20, v21
    v_cvt_pk_bf16_f32 v41, v22, v23
    v_cvt_pk_bf16_f32 v42, v24, v25
    v_cvt_pk_bf16_f32 v43, v26, v27
    v_lshlrev_b32 v20, 16, v40
    v_and_b32 v21, 0xffff0000, v40
    v_lshlrev_b32 v22, 16, v41
    v_and_b32 v23, 0xffff0000, v41
    v_lshlrev_b32 v24, 16, v42
    v_and_b32 v25, 0xffff0000, v42
    v_lshlrev_b32 v26, 16, v43
    v_and_b32 v27, 0xffff0000, v43
    v_lshlrev_b32 v32, 16, v28
    v_and_b32 v33, 0xffff0000, v28
    v_lshlrev_b32 v34, 16, v29
    v_and_b32 v35, 0xffff0000, v29
    v_lshlrev_b32 v36, 16, v30
    v_and_b32 v37, 0xffff0000, v30
    v_lshlrev_b32 v38, 16, v31
    v_and_b32 v39, 0xffff0000, v31
    v_add_f32 v20, v20, v32
    v_add_f32 v21, v21, v33
    v_add_f32 v22, v22, v34
    v_add_f32 v23, v23, v35
    v_add_f32 v24, v24, v36
    v_add_f32 v25, v25, v37
    v_add_f32 v26, v26, v38
    v_add_f32 v27, v27, v39
    v_cvt_pk_bf16_f32 v40, v20, v21
    v_cvt_pk_bf16_f32 v41, v22, v23
    v_cvt_pk_bf16_f32 v42, v24, v25
    v_cvt_pk_bf16_f32 v43, v26, v27
    v_lshlrev_b32 v32, 16, v40
    v_and_b32 v33, 0xffff0000, v40
    v_lshlrev_b32 v34, 16, v41
    v_and_b32 v35, 0xffff0000, v41
    v_lshlrev_b32 v36, 16, v42
    v_and_b32 v37, 0xffff0000, v42
    v_lshlrev_b32 v38, 16, v43
    v_and_b32 v39, 0xffff0000, v43
    s_lshl_b32 s11, s62, 15
    buffer_store_dwordx4 v[40:43], v3, s[20:23], s11 offen
    s_add_u32 s62, s62, 4
    s_branch nf_86
nf_87:
    s_add_u32 s59, s53, 24
    s_lshl_b32 s59, s59, 7
    s_add_u32 s59, s59, 98304
    s_mov_b32 s15, 0
aw_90:
    buffer_load_dword v10, v2, s[4:7], s59 offen sc1
    s_add_u32 s15, s15, 1
    s_cmp_gt_u32 s15, 200000
    s_cbranch_scc1 K_FAIL
    s_waitcnt vmcnt(0)
    v_cmp_ge_u32 vcc, s10, v10
    s_cbranch_vccz awok_91
    s_sleep 1
    s_branch aw_90
awok_91:
    s_and_b32 s61, s10, 7
    s_lshl_b32 s61, s61, 15
    s_add_u32 s61, s61, 13107200
    s_lshl_b32 s11, s9, 13
    s_add_u32 s12, s61, s11
    s_add_u32 s11, s11, 32768
    s_mov_b32 m0, s11
    s_nop 0
    buffer_load_dwordx4 v0, s[4:7], s12 offen offset:0 sc1 lds
    buffer_load_dwordx4 v0, s[4:7], s12 offen offset:1024 sc1 lds
    buffer_load_dwordx4 v0, s[4:7], s12 offen offset:2048 sc1 lds
    buffer_load_dwordx4 v0, s[4:7], s12 offen offset:3072 sc1 lds
    s_add_u32 s11, s11, 4096
    s_add_u32 s12, s12, 4096
    s_mov_b32 m0, s11
    s_nop 0
    buffer_load_dwordx4 v0, s[4:7], s12 offen offset:0 sc1 lds
    buffer_load_dwordx4 v0, s[4:7], s12 offen offset:1024 sc1 lds
    buffer_load_dwordx4 v0, s[4:7], s12 offen offset:2048 sc1 lds
    buffer_load_dwordx4 v0, s[4:7], s12 offen offset:3072 sc1 lds
    s_waitcnt vmcnt(0)
    s_barrier
    v_add_u32 v8, 32768, v1
    ds_read_b128 v[128:131], v8 offset:0
    ds_read_b128 v[132:135], v8 offset:256
    ds_read_b128 v[136:139], v8 offset:2048
    ds_read_b128 v[140:143], v8 offset:2304
    ds_read_b128 v[144:147], v8 offset:4096
    ds_read_b128 v[148:151], v8 offset:4352
    s_waitcnt lgkmcnt(4)
    v_mfma_f32_16x16x32_bf16 v[112:115], a[192:195], v[128:131], 0
    v_mfma_f32_16x16x32_bf16 v[116:119], a[192:195], v[132:135], 0
    ds_read_b128 v[128:131], v8 offset:6144
    ds_read_b128 v[132:135], v8 offset:6400
    s_waitcnt lgkmcnt(4)
    v_mfma_f32_16x16x32_bf16 v[112:115], a[196:199], v[136:139], v[112:115]
    v_mfma_f32_16x16x32_bf16 v[116:119], a[196:199], v[140:143], v[116:119]
    ds_read_b128 v[136:139], v8 offset:8192
    ds_read_b128 v[140:143], v8 offset:8448
    s_waitcnt lgkmcnt(4)
    v_mfma_f32_16x16x32_bf16 v[112:115], a[200:203], v[144:147], v[112:115]
    v_mfma_f32_16x16x32_bf16 v[116:119], a[200:203], v[148:151], v[116:119]
    ds_read_b128 v[144:147], v8 offset:10240
    ds_read_b128 v[148:151], v8 offset:10496
    s_waitcnt lgkmcnt(4)
    v_mfma_f32_16x16x32_bf16 v[112:115], a[204:207], v[128:131], v[112:115]
    v_mfma_f32_16x16x32_bf16 v[116:119], a[204:207], v[132:135], v[116:119]
    ds_read_b128 v[128:131], v8 offset:12288
    ds_read_b128 v[132:135], v8 offset:12544
    s_waitcnt lgkmcnt(4)
    v_mfma_f32_16x16x32_bf16 v[112:115], a[208:211], v[136:139], v[112:115]
    v_mfma_f32_16x16x32_bf16 v[116:119], a[208:211], v[140:143], v[116:119]
    ds_read_b128 v[136:139], v8 offset:14336
    ds_read_b128 v[140:143], v8 offset:14592
    s_waitcnt lgkmcnt(4)
    v_mfma_f32_16x16x32_bf16 v[112:115], a[212:215], v[144:147], v[112:115]
    v_mfma_f32_16x16x32_bf16 v[116:119], a[212:215], v[148:151], v[116:119]
    ds_read_b128 v[144:147], v8 offset:16384
    ds_read_b128 v[148:151], v8 offset:16640
    s_waitcnt lgkmcnt(4)
    v_mfma_f32_16x16x32_bf16 v[112:115], a[216:219], v[128:131], v[112:115]
    v_mfma_f32_16x16x32_bf16 v[116:119], a[216:219], v[132:135], v[116:119]
    ds_read_b128 v[128:131], v8 offset:18432
    ds_read_b128 v[132:135], v8 offset:18688
    s_waitcnt lgkmcnt(4)
    v_mfma_f32_16x16x32_bf16 v[112:115], a[220:223], v[136:139], v[112:115]
    v_mfma_f32_16x16x32_bf16 v[116:119], a[220:223], v[140:143], v[116:119]
    ds_read_b128 v[136:139], v8 offset:20480
    ds_read_b128 v[140:143], v8 offset:20736
    s_waitcnt lgkmcnt(4)
    v_mfma_f32_16x16x32_bf16 v[112:115], a[224:227], v[144:147], v[112:115]
    v_mfma_f32_16x16x32_bf16 v[116:119], a[224:227], v[148:151], v[116:119]
    ds_read_b128 v[144:147], v8 offset:22528
    ds_read_b128 v[148:151], v8 offset:22784
    s_waitcnt lgkmcnt(4)
    v_mfma_f32_16x16x32_bf16 v[112:115], a[228:231], v[128:131], v[112:115]
    v_mfma_f32_16x16x32_bf16 v[116:119], a[228:231], v[132:135], v[116:119]
    ds_read_b128 v[128:131], v8 offset:24576
    ds_read_b128 v[132:135], v8 offset:24832
    s_waitcnt lgkmcnt(4)
    v_mfma_f32_16x16x32_bf16 v[112:115], a[232:235], v[136:139], v[112:115]
    v_mfma_f32_16x16x32_bf16 v[116:119], a[232:235], v[140:143], v[116:119]
    ds_read_b128 v[136:139], v8 offset:26624
    ds_read_b128 v[140:143], v8 offset:26880
    s_waitcnt lgkmcnt(4)
    v_mfma_f32_16x16x32_bf16 v[112:115], a[236:239], v[144:147], v[112:115]
    v_mfma_f32_16x16x32_bf16 v[116:119], a[236:239], v[148:151], v[116:119]
    ds_read_b128 v[144:147], v8 offset:28672
    ds_read_b128 v[148:151], v8 offset:28928
    s_waitcnt lgkmcnt(4)
    v_mfma_f32_16x16x32_bf16 v[112:115], a[240:243], v[128:131], v[112:115]
    v_mfma_f32_16x16x32_bf16 v[116:119], a[240:243], v[132:135], v[116:119]
    ds_read_b128 v[128:131], v8 offset:30720
    ds_read_b128 v[132:135], v8 offset:30976
    s_waitcnt lgkmcnt(4)
    v_mfma_f32_16x16x32_bf16 v[112:115], a[244:247], v[136:139], v[112:115]
    v_mfma_f32_16x16x32_bf16 v[116:119], a[244:247], v[140:143], v[116:119]
    s_waitcnt lgkmcnt(2)
    v_mfma_f32_16x16x32_bf16 v[112:115], a[248:251], v[144:147], v[112:115]
    v_mfma_f32_16x16x32_bf16 v[116:119], a[248:251], v[148:151], v[116:119]
    s_waitcnt lgkmcnt(0)
    v_mfma_f32_16x16x32_bf16 v[112:115], a[252:255], v[128:131], v[112:115]
    v_mfma_f32_16x16x32_bf16 v[116:119], a[252:255], v[132:135], v[116:119]
    s_nop 7
    v_permlane16_swap_b32 v112, v116
    v_permlane16_swap_b32 v113, v117
    v_permlane16_swap_b32 v114, v118
    v_permlane16_swap_b32 v115, v119
    v_mov_b32 v20, v112
    v_mov_b32 v24, v116
    v_mov_b32 v21, v113
    v_mov_b32 v25, v117
    v_mov_b32 v22, v114
    v_mov_b32 v26, v118
    v_mov_b32 v23, v115
    v_mov_b32 v27, v119
    v_mov_b32 v28, v100
    v_mov_b32 v29, v101
    v_mov_b32 v30, v102
    v_mov_b32 v31, v103
    v_cvt_pk_bf16_f32 v40, v20, v21
    v_cvt_pk_bf16_f32 v41, v22, v23
    v_cvt_pk_bf16_f32 v42, v24, v25
    v_cvt_pk_bf16_f32 v43, v26, v27
    v_lshlrev_b32 v20, 16, v40
    v_and_b32 v21, 0xffff0000, v40
    v_lshlrev_b32 v22, 16, v41
    v_and_b32 v23, 0xffff0000, v41
    v_lshlrev_b32 v24, 16, v42
    v_and_b32 v25, 0xffff0000, v42
    v_lshlrev_b32 v26, 16, v43
    v_and_b32 v27, 0xffff0000, v43
    v_lshlrev_b32 v32, 16, v28
    v_and_b32 v33, 0xffff0000, v28
    v_lshlrev_b32 v34, 16, v29
    v_and_b32 v35, 0xffff0000, v29
    v_lshlrev_b32 v36, 16, v30
    v_and_b32 v37, 0xffff0000, v30
    v_lshlrev_b32 v38, 16, v31
    v_and_b32 v39, 0xffff0000, v31
    v_add_f32 v20, v20, v32
    v_add_f32 v21, v21, v33
    v_add_f32 v22, v22, v34
    v_add_f32 v23, v23, v35
    v_add_f32 v24, v24, v36
    v_add_f32 v25, v25, v37
    v_add_f32 v26, v26, v38
    v_add_f32 v27, v27, v39
    v_cvt_pk_bf16_f32 v40, v20, v21
    v_cvt_pk_bf16_f32 v41, v22, v23
    v_cvt_pk_bf16_f32 v42, v24, v25
    v_cvt_pk_bf16_f32 v43, v26, v27
    v_lshlrev_b32 v32, 16, v40
    v_and_b32 v33, 0xffff0000, v40
    v_lshlrev_b32 v34, 16, v41
    v_and_b32 v35, 0xffff0000, v41
    v_lshlrev_b32 v36, 16, v42
    v_and_b32 v37, 0xffff0000, v42
    v_lshlrev_b32 v38, 16, v43
    v_and_b32 v39, 0xffff0000, v43
    s_and_b32 s11, s56, 7
    s_lshl_b32 s11, s11, 12
    s_lshl_b32 s12, s9, 10
    s_add_u32 s11, s11, s12
    s_add_u32 s11, s11, 83968
    v_add_u32 v14, s11, v0
    ds_write_b128 v14, v[40:43]
    s_add_u32 s63, s53, 24
    v_add_f32 v44, v32, v33
    v_mul_f32 v45, v32, v32
    v_add_f32 v12, v34, v35
    v_fmac_f32 v45, v33, v33
    v_add_f32 v13, v36, v37
    v_mul_f32 v15, v34, v34
    v_add_f32 v14, v38, v39
    v_fmac_f32 v15, v35, v35
    v_add_f32 v44, v44, v12
    v_fmac_f32 v45, v36, v36
    v_add_f32 v13, v13, v14
    v_fmac_f32 v15, v37, v37
    v_add_f32 v44, v44, v13
    v_fmac_f32 v45, v38, v38
    v_fmac_f32 v15, v39, v39
    v_add_f32 v45, v45, v15
    v_mov_b32 v12, v44
    v_mov_b32 v13, v45
    s_nop 0
    v_permlane32_swap_b32 v44, v12
    v_permlane32_swap_b32 v45, v13
    v_add_f32 v44, v44, v12
    v_add_f32 v45, v45, v13
    v_lshrrev_b32 v14, 1, v0
    v_and_b32 v14, 0xff, v14
    s_lshl_b32 s11, s9, 8
    s_add_u32 s11, s11, 81920
    v_add_u32 v15, s11, v14
    ds_write_b64 v15, v[44:45]
    s_waitcnt lgkmcnt(0)
    s_barrier
    v_add_u32 v14, 81920, v14
    ds_read_b64 v[104:105], v14 offset:0
    ds_read_b64 v[106:107], v14 offset:256
    ds_read_b64 v[108:109], v14 offset:512
    ds_read_b64 v[110:111], v14 offset:768
    s_add_u32 s11, s56, 0
    s_and_b32 s11, s11, 3
    s_lshl_b32 s14, s63, 2
    s_add_u32 s11, s11, s14
    s_lshl_b32 s11, s11, 11
    s_add_u32 s11, s11, 2162688
    s_add_u32 s12, s56, 0
    s_and_b32 s12, s12, 3
    s_lshl_b32 s14, s63, 2
    s_add_u32 s12, s12, s14
    s_lshl_b32 s12, s12, 11
    s_add_u32 s12, s12, 2162688
    s_mov_b32 s13, s11
    s_waitcnt lgkmcnt(0)
    v_add_f32 v104, v104, v106
    v_add_f32 v105, v105, v107
    v_add_f32 v108, v108, v110
    v_add_f32 v109, v109, v111
    v_add_f32 v44, v104, v108
    v_add_f32 v45, v105, v109
    s_cmp_lg_u32 s9, 0
    s_cbranch_scc1 lnp_92
    s_mov_b64 exec, s[24:25]
    buffer_store_dwordx2 v[44:45], v4, s[4:7], s11 offen sc1
    s_mov_b64 exec, -1
lnp_92:
    s_mov_b32 s15, 0
sg_93:
    buffer_load_dwordx4 v[104:107], v0, s[4:7], s13 offen offset:0 sc1
    buffer_load_dwordx4 v[108:111], v0, s[4:7], s13 offen offset:1024 sc1
    s_add_u32 s15, s15, 1
    s_cmp_gt_u32 s15, 200000
    s_cbranch_scc1 K_FAIL
    s_waitcnt vmcnt(0)
    v_add_f32 v104, v104, v108
    v_add_f32 v105, v105, v109
    v_add_f32 v106, v106, v110
    v_add_f32 v107, v107, v111
    v_add_f32 v44, v104, v106
    v_add_f32 v45, v105, v107
    v_cmp_u_f32 vcc, v44, v45
    s_cbranch_vccz sgok_94
    s_branch sg_93
sgok_94:
    s_cmp_lg_u32 s9, 0
    s_cbranch_scc1 lnr_95
    s_add_u32 s11, s56, 3
    s_and_b32 s11, s11, 3
    s_lshl_b32 s14, s63, 2
    s_add_u32 s11, s11, s14
    s_lshl_b32 s11, s11, 11
    s_add_u32 s11, s11, 2162688
    s_mov_b64 exec, s[24:25]
    buffer_store_dwordx2 v[18:19], v4, s[4:7], s11 offen sc1
    s_mov_b64 exec, -1
lnr_95:
    v_mov_b32 v12, v44
    v_mov_b32 v13, v45
    s_nop 0
    v_permlane32_swap_b32 v44, v12
    v_permlane32_swap_b32 v45, v13
    v_add_f32 v44, v44, v12
    v_add_f32 v45, v45, v13
    v_mul_f32 v44, 0x3b000000, v44
    v_mul_f32 v45, 0x3b000000, v45
    v_fma_f32 v45, -v44, v44, v45
    v_max_f32 v45, 0, v45
    v_add_f32 v45, 0x3727c5ac, v45
    v_rsq_f32 v45, v45
    v_sub_f32 v32, v32, v44
    v_sub_f32 v33, v33, v44
    v_sub_f32 v34, v34, v44
    v_sub_f32 v35, v35, v44
    v_sub_f32 v36, v36, v44
    v_sub_f32 v37, v37, v44
    v_sub_f32 v38, v38, v44
    v_sub_f32 v39, v39, v44
    v_mul_f32 v32, v32, v45
    v_mul_f32 v33, v33, v45
    v_mul_f32 v34, v34, v45
    v_mul_f32 v35, v35, v45
    v_mul_f32 v36, v36, v45
    v_mul_f32 v37, v37, v45
    v_mul_f32 v38, v38, v45
    v_mul_f32 v39, v39, v45
    v_cvt_pk_bf16_f32 v40, v32, v33
    v_cvt_pk_bf16_f32 v41, v34, v35
    v_cvt_pk_bf16_f32 v42, v36, v37
    v_cvt_pk_bf16_f32 v43, v38, v39
    s_and_b32 s11, s10, 15
    s_lshl_b32 s11, s11, 15
    s_add_u32 s11, s11, 13631488
    s_lshl_b32 s14, s8, 10
    s_add_u32 s11, s11, s14
    buffer_store_dwordx4 v[40:43], v0, s[4:7], s11 offen sc1
    s_lshl_b32 s59, s53, 3
    s_add_u32 s59, s59, s55
    s_lshl_b32 s59, s59, 7
    s_add_u32 s59, s59, 49152
    s_waitcnt vmcnt(0)
    s_barrier
    s_cmp_lg_u32 s9, 0
    s_cbranch_scc1 pb_96
    s_add_u32 s11, s10, 1
    v_mov_b32 v10, s11
    buffer_store_dword v10, off, s[4:7], s59 sc1
pb_96:
    s_add_u32 s10, s10, 4
    s_add_u32 s56, s56, 1
    s_cmp_lt_u32 s56, 16
    s_cbranch_scc1 AS_SEG
AS_END:
    s_mov_b32 s52, 63
nf_97:
    s_cmp_gt_i32 s62, s52
    s_cbranch_scc1 nf_98
    s_mov_b32 s59, 43008
    s_mov_b32 s15, 0
aw_99:
    buffer_load_dword v10, v7, s[4:7], s59 offen sc1
    s_add_u32 s15, s15, 1
    s_cmp_gt_u32 s15, 200000
    s_cbranch_scc1 K_FAIL
    s_waitcnt vmcnt(0)
    v_cmp_ge_u32 vcc, s62, v10
    s_cbranch_vccz awok_100
    s_sleep 1
    s_branch aw_99
awok_100:
    s_and_b32 s11, s62, 7
    s_lshl_b32 s11, s11, 18
    s_lshl_b32 s12, s8, 10
    s_add_u32 s11, s11, s12
    s_add_u32 s11, s11, 33554432
    buffer_load_dwordx4 v[160:163], v0, s[4:7], s11 offen sc1
    s_add_u32 s11, s11, 32768
    buffer_load_dwordx4 v[164:167], v0, s[4:7], s11 offen sc1
    s_add_u32 s11, s11, 32768
    buffer_load_dwordx4 v[168:171], v0, s[4:7], s11 offen sc1
    s_add_u32 s11, s11, 32768
    buffer_load_dwordx4 v[172:175], v0, s[4:7], s11 offen sc1
    s_add_u32 s11, s11, 32768
    buffer_load_dwordx4 v[176:179], v0, s[4:7], s11 offen sc1
    s_add_u32 s11, s11, 32768
    buffer_load_dwordx4 v[180:183], v0, s[4:7], s11 offen sc1
    s_add_u32 s11, s11, 32768
    buffer_load_dwordx4 v[184:187], v0, s[4:7], s11 offen sc1
    s_add_u32 s11, s11, 32768
    buffer_load_dwordx4 v[188:191], v0, s[4:7], s11 offen sc1
    s_lshr_b32 s11, s62, 2
    s_and_b32 s11, s11, 7
    s_lshl_b32 s11, s11, 12
    s_lshl_b32 s12, s9, 10
    s_add_u32 s11, s11, s12
    s_add_u32 s11, s11, 83968
    v_add_u32 v14, s11, v0
    ds_read_b128 v[28:31], v14
    s_mov_b32 s57, 0x3f80
    s_mov_b32 s58, 0x3f800000
    v_mov_b32 v20, 0
    v_mov_b32 v21, 0
    v_mov_b32 v22, 0
    v_mov_b32 v23, 0
    v_mov_b32 v24, 0
    v_mov_b32 v25, 0
    v_mov_b32 v26, 0
    v_mov_b32 v27, 0
    s_waitcnt vmcnt(7)
    v_dot2c_f32_bf16 v20, s57, v160
    v_dot2c_f32_bf16 v21, s58, v160
    v_dot2c_f32_bf16 v22, s57, v161
    v_dot2c_f32_bf16 v23, s58, v161
    v_dot2c_f32_bf16 v24, s57, v162
    v_dot2c_f32_bf16 v25, s58, v162
    v_dot2c_f32_bf16 v26, s57, v163
    v_dot2c_f32_bf16 v27, s58, v163
    s_waitcnt vmcnt(6)
    v_dot2c_f32_bf16 v20, s57, v164
    v_dot2c_f32_bf16 v21, s58, v164
    v_dot2c_f32_bf16 v22, s57, v165
    v_dot2c_f32_bf16 v23, s58, v165
    v_dot2c_f32_bf16 v24, s57, v166
    v_dot2c_f32_bf16 v25, s58, v166
    v_dot2c_f32_bf16 v26, s57, v167
    v_dot2c_f32_bf16 v27, s58, v167
    s_waitcnt vmcnt(5)
    v_dot2c_f32_bf16 v20, s57, v168
    v_dot2c_f32_bf16 v21, s58, v168
    v_dot2c_f32_bf16 v22, s57, v169
    v_dot2c_f32_bf16 v23, s58, v169
    v_dot2c_f32_bf16 v24, s57, v170
    v_dot2c_f32_bf16 v25, s58, v170
    v_dot2c_f32_bf16 v26, s57, v171
    v_dot2c_f32_bf16 v27, s58, v171
    s_waitcnt vmcnt(4)
    v_dot2c_f32_bf16 v20, s57, v172
    v_dot2c_f32_bf16 v21, s58, v172
    v_dot2c_f32_bf16 v22, s57, v173
    v_dot2c_f32_bf16 v23, s58, v173
    v_dot2c_f32_bf16 v24, s57, v174
    v_dot2c_f32_bf16 v25, s58, v174
    v_dot2c_f32_bf16 v26, s57, v175
    v_dot2c_f32_bf16 v27, s58, v175
    s_waitcnt vmcnt(3)
    v_dot2c_f32_bf16 v20, s57, v176
    v_dot2c_f32_bf16 v21, s58, v176
    v_dot2c_f32_bf16 v22, s57, v177
    v_dot2c_f32_bf16 v23, s58, v177
    v_dot2c_f32_bf16 v24, s57, v178
    v_dot2c_f32_bf16 v25, s58, v178
    v_dot2c_f32_bf16 v26, s57, v179
    v_dot2c_f32_bf16 v27, s58, v179
    s_waitcnt vmcnt(2)
    v_dot2c_f32_bf16 v20, s57, v180
    v_dot2c_f32_bf16 v21, s58, v180
    v_dot2c_f32_bf16 v22, s57, v181
    v_dot2c_f32_bf16 v23, s58, v181
    v_dot2c_f32_bf16 v24, s57, v182
    v_dot2c_f32_bf16 v25, s58, v182
    v_dot2c_f32_bf16 v26, s57, v183
    v_dot2c_f32_bf16 v27, s58, v183
    s_waitcnt vmcnt(1)
    v_dot2c_f32_bf16 v20, s57, v184
    v_dot2c_f32_bf16 v21, s58, v184
    v_dot2c_f32_bf16 v22, s57, v185
    v_dot2c_f32_bf16 v23, s58, v185
    v_dot2c_f32_bf16 v24, s57, v186
    v_dot2c_f32_bf16 v25, s58, v186
    v_dot2c_f32_bf16 v26, s57, v187
    v_dot2c_f32_bf16 v27, s58, v187
    s_waitcnt vmcnt(0)
    v_dot2c_f32_bf16 v20, s57, v188
    v_dot2c_f32_bf16 v21, s58, v188
    v_dot2c_f32_bf16 v22, s57, v189
    v_dot2c_f32_bf16 v23, s58, v189
    v_dot2c_f32_bf16 v24, s57, v190
    v_dot2c_f32_bf16 v25, s58, v190
    v_dot2c_f32_bf16 v26, s57, v191
    v_dot2c_f32_bf16 v27, s58, v191
    s_lshl_b32 s11, s53, 3
    s_add_u32 s11, s11, s55
    s_lshl_b32 s11, s11, 7
    s_lshl_b32 s12, s9, 2
    s_add_u32 s11, s11, s12
    s_add_u32 s13, s11, 45056
    s_add_u32 s11, s62, 1
    v_mov_b32 v10, s11
    buffer_store_dword v10, off, s[4:7], s13 sc1
    s_waitcnt lgkmcnt(0)
    v_cvt_pk_bf16_f32 v40, v20, v21
    v_cvt_pk_bf16_f32 v41, v22, v23
    v_cvt_pk_bf16_f32 v42, v24, v25
    v_cvt_pk_bf16_f32 v43, v26, v27
    v_lshlrev_b32 v20, 16, v40
    v_and_b32 v21, 0xffff0000, v40
    v_lshlrev_b32 v22, 16, v41
    v_and_b32 v23, 0xffff0000, v41
    v_lshlrev_b32 v24, 16, v42
    v_and_b32 v25, 0xffff0000, v42
    v_lshlrev_b32 v26, 16, v43
    v_and_b32 v27, 0xffff0000, v43
    v_lshlrev_b32 v32, 16, v28
    v_and_b32 v33, 0xffff0000, v28
    v_lshlrev_b32 v34, 16, v29
    v_and_b32 v35, 0xffff0000, v29
    v_lshlrev_b32 v36, 16, v30
    v_and_b32 v37, 0xffff0000, v30
    v_lshlrev_b32 v38, 16, v31
    v_and_b32 v39, 0xffff0000, v31
    v_add_f32 v20, v20, v32
    v_add_f32 v21, v21, v33
    v_add_f32 v22, v22, v34
    v_add_f32 v23, v23, v35
    v_add_f32 v24, v24, v36
    v_add_f32 v25, v25, v37
    v_add_f32 v26, v26, v38
    v_add_f32 v27, v27, v39
    v_cvt_pk_bf16_f32 v40, v20, v21
    v_cvt_pk_bf16_f32 v41, v22, v23
    v_cvt_pk_bf16_f32 v42, v24, v25
    v_cvt_pk_bf16_f32 v43, v26, v27
    v_lshlrev_b32 v32, 16, v40
    v_and_b32 v33, 0xffff0000, v40
    v_lshlrev_b32 v34, 16, v41
    v_and_b32 v35, 0xffff0000, v41
    v_lshlrev_b32 v36, 16, v42
    v_and_b32 v37, 0xffff0000, v42
    v_lshlrev_b32 v38, 16, v43
    v_and_b32 v39, 0xffff0000, v43
    s_lshl_b32 s11, s62, 15
    buffer_store_dwordx4 v[40:43], v3, s[20:23], s11 offen
    s_add_u32 s62, s62, 4
    s_branch nf_97
nf_98:
    s_waitcnt vmcnt(0)
    s_branch K_DONE
ROLE_R2:
    s_mov_b32 s36, 1
    s_mov_b32 s8, s91
    s_load_dwordx2 s[4:5], s[0:1], 96
    v_lshrrev_b32 v17, 6, v0
    v_and_b32 v18, 63, v0
    v_readfirstlane_b32 s9, v17
    s_mov_b32 s6, 268435456
    s_mov_b32 s7, 0x20000
    s_mul_i32 s29, s36, 557056
    s_add_u32 s29, s29, 1048576
    v_and_b32 v24, 15, v18
    v_lshrrev_b32 v25, 4, v18
    v_lshlrev_b32 v0, 4, v18
    v_lshrrev_b32 v28, 2, v24
    v_lshlrev_b32 v28, 1, v28
    v_and_b32 v29, 1, v24
    v_add_u32 v28, v28, v29
    v_bfe_u32 v29, v24, 1, 1
    s_lshl_b32 s24, s9, 11
    v_add_u32 v7, s24, v0
    v_lshlrev_b32 v26, 8, v25
    v_lshlrev_b32 v27, 5, v28
    v_add_u32 v26, v26, v27
    v_lshlrev_b32 v27, 4, v29
    v_add3_u32 v1, v26, v27, s24
    s_lshl_b32 s25, s9, 14
    s_add_u32 s25, s25, 32768
    v_add_u32 v2, s25, v0
    v_add_u32 v3, 0x10000, v2
    s_lshl_b32 s25, s9, 3
    v_add_u32 v26, s25, v25
    v_lshlrev_b32 v26, 13, v26
    v_lshrrev_b32 v27, 2, v24
    v_lshlrev_b32 v27, 11, v27
    v_add_u32 v26, v26, v27
    v_and_b32 v27, 3, v24
    v_lshlrev_b32 v27, 4, v27
    s_lshl_b32 s25, s8, 6
    v_add3_u32 v4, v26, v27, s25
    v_lshlrev_b32 v26, 2, v25
    v_and_b32 v27, 3, v18
    v_add_u32 v26, v26, v27
    v_lshlrev_b32 v26, 6, v26
    v_bfe_u32 v27, v18, 2, 2
    v_lshlrev_b32 v27, 4, v27
    s_lshl_b32 s25, s8, 13
    s_add_u32 s25, s25, s24
    v_add3_u32 v5, v26, v27, s25
    v_and_b32 v26, 7, v24
    v_lshlrev_b32 v26, 5, v26
    v_lshrrev_b32 v27, 1, v25
    v_lshlrev_b32 v27, 2, v27
    s_lshl_b32 s25, s8, 8
    s_lshl_b32 s26, s9, 3
    s_add_u32 s25, s25, s26
    v_add3_u32 v6, v26, v27, s25
    v_and_b32 v26, 0x18, v18
    v_cmp_eq_u32 s[20:21], 0, v26
    v_lshlrev_b32 v26, 9, v25
    v_lshlrev_b32 v27, 4, v24
    v_add_u32 v8, v26, v27
    s_lshl_b32 s25, s9, 5
    v_add_u32 v26, s25, v24
    v_lshlrev_b32 v27, 1, v26
    v_mul_u32_u24 v9, 576, v25
    v_add_u32 v9, v9, v27
    v_and_b32 v27, 1, v25
    v_lshlrev_b32 v27, 4, v27
    v_add_u32 v26, v26, v27
    v_lshlrev_b32 v26, 4, v26
    v_lshrrev_b32 v27, 1, v25
    v_lshlrev_b32 v27, 3, v27
    v_add_u32 v16, v26, v27
    v_and_b32 v26, 7, v24
    v_mul_u32_u24 v26, 288, v26
    v_lshlrev_b32 v27, 4, v25
    v_add_u32 v10, v26, v27
    v_mul_u32_u24 v26, 288, v28
    v_add_u32 v15, v26, v27
    v_and_b32 v26, 7, v24
    v_mul_u32_u24 v26, 320, v26
    v_lshlrev_b32 v27, 3, v25
    s_lshl_b32 s25, s9, 6
    v_add3_u32 v11, v26, v27, s25
    v_mul_u32_u24 v26, 320, v28
    v_lshlrev_b32 v27, 5, v25
    v_add_u32 v26, v26, v27
    v_lshlrev_b32 v27, 4, v29
    v_add_u32 v12, v26, v27
    v_mov_b32 v26, 0x4444
    v_mov_b32 v27, 0xeeee
    v_cmp_eq_u32 vcc, 0, v29
    s_nop 1
    v_cndmask_b32 v13, v27, v26, vcc
    v_and_b32 v26, 7, v24
    v_mov_b32 v20, 0
    v_mov_b32 v27, 0x3f80
    v_cmp_eq_u32 vcc, 0, v26
    s_nop 1
    v_cndmask_b32 v20, v20, v27, vcc
    v_mov_b32 v27, 0x3f800000
    v_cmp_eq_u32 vcc, 1, v26
    s_nop 1
    v_cndmask_b32 v20, v20, v27, vcc
    v_mov_b32 v21, 0
    v_mov_b32 v27, 0x3f80
    v_cmp_eq_u32 vcc, 2, v26
    s_nop 1
    v_cndmask_b32 v21, v21, v27, vcc
    v_mov_b32 v27, 0x3f800000
    v_cmp_eq_u32 vcc, 3, v26
    s_nop 1
    v_cndmask_b32 v21, v21, v27, vcc
    v_mov_b32 v22, 0
    v_mov_b32 v27, 0x3f80
    v_cmp_eq_u32 vcc, 4, v26
    s_nop 1
    v_cndmask_b32 v22, v22, v27, vcc
    v_mov_b32 v27, 0x3f800000
    v_cmp_eq_u32 vcc, 5, v26
    s_nop 1
    v_cndmask_b32 v22, v22, v27, vcc
    v_mov_b32 v23, 0
    v_mov_b32 v27, 0x3f80
    v_cmp_eq_u32 vcc, 6, v26
    s_nop 1
    v_cndmask_b32 v23, v23, v27, vcc
    v_mov_b32 v27, 0x3f800000
    v_cmp_eq_u32 vcc, 7, v26
    s_nop 1
    v_cndmask_b32 v23, v23, v27, vcc
    s_mov_b32 s22, 0x3e0293ee
    s_mov_b32 s23, 0xbe0293ee
    s_waitcnt lgkmcnt(0)
    v_lshrrev_b32 v25, 4, v18
    v_and_b32 v24, 15, v18
    v_and_b32 v26, 1, v25
    s_lshl_b32 s24, s9, 1
    v_or_b32 v26, s24, v26
    v_lshlrev_b32 v26, 1, v26
    v_xor_b32 v26, v26, v24
    v_lshlrev_b32 v26, 4, v26
    s_lshl_b32 s24, s9, 2
    v_add_u32 v27, s24, v25
    v_lshlrev_b32 v27, 13, v27
    s_lshl_b32 s24, s8, 8
    v_add3_u32 v32, v26, v27, s24
    v_lshrrev_b32 v26, 2, v24
    v_and_b32 v27, 1, v26
    v_lshrrev_b32 v26, 1, v26
    v_and_b32 v30, 1, v25
    v_lshlrev_b32 v28, 3, v26
    v_add_u32 v28, v28, v27
    v_lshlrev_b32 v29, 2, v30
    v_add_u32 v28, v28, v29
    v_lshrrev_b32 v29, 1, v25
    v_lshlrev_b32 v29, 4, v29
    v_add_u32 v28, v28, v29
    v_lshlrev_b32 v30, 1, v30
    v_or_b32 v30, v30, v27
    v_lshlrev_b32 v26, 2, v26
    v_or_b32 v30, v30, v26
    v_and_b32 v27, 3, v18
    v_lshlrev_b32 v27, 3, v27
    v_mov_b32 v24, v28
    v_mov_b32 v25, v30
    s_lshl_b32 s24, s9, 1
    v_xor_b32 v30, s24, v25
    v_lshlrev_b32 v30, 5, v30
    v_lshlrev_b32 v28, 8, v24
    v_add3_u32 v28, v28, v30, v27
    v_xor_b32 v29, 32, v28
    v_add_u32 v28, 32768, v28
    v_add_u32 v29, 32768, v29
    v_add_u32 v30, 0x10000, v28
    v_add_u32 v31, 0x10000, v29
    s_and_b32 s24, s9, 1
    s_or_b32 s25, s24, 0
    s_lshl_b32 s25, s25, 1
    v_xor_b32 v33, s25, v18
    v_lshlrev_b32 v33, 4, v33
    s_or_b32 s25, s24, 2
    s_lshl_b32 s25, s25, 1
    v_xor_b32 v34, s25, v18
    v_lshlrev_b32 v34, 4, v34
    s_or_b32 s25, s24, 4
    s_lshl_b32 s25, s25, 1
    v_xor_b32 v35, s25, v18
    v_lshlrev_b32 v35, 4, v35
    s_or_b32 s25, s24, 6
    s_lshl_b32 s25, s25, 1
    v_xor_b32 v36, s25, v18
    v_lshlrev_b32 v36, 4, v36
    v_lshlrev_b32 v37, 10, v24
    s_lshl_b32 s26, s9, 8
    s_add_u32 s26, s26, 32768
    v_add3_u32 v37, v37, v27, s26
    v_lshlrev_b32 v25, 5, v25
    s_load_dwordx2 s[32:33], s[0:1], 56
    s_mov_b32 s34, 4194304
    s_mov_b32 s35, 0x20000
    s_waitcnt lgkmcnt(0)
    s_lshl_b32 s24, s9, 10
    s_add_u32 s24, s24, 32768
    s_mov_b32 s25, 0
    s_mov_b32 s28, 0
wdma_101:
    s_mov_b32 m0, s24
    s_add_u32 s24, s24, 4096
    buffer_load_dwordx4 v32, s[32:35], s25 offen  lds
    s_add_u32 s25, s25, 131072
    s_add_u32 s28, s28, 1
    s_cmp_lt_u32 s28, 16
    s_cbranch_scc1 wdma_101
    s_lshl_b32 s24, s9, 10
    s_add_u32 s24, s24, 98304
    s_mov_b32 s25, 2097152
    s_mov_b32 s28, 0
wdma_102:
    s_mov_b32 m0, s24
    s_add_u32 s24, s24, 4096
    buffer_load_dwordx4 v32, s[32:35], s25 offen  lds
    s_add_u32 s25, s25, 131072
    s_add_u32 s28, s28, 1
    s_cmp_lt_u32 s28, 16
    s_cbranch_scc1 wdma_102
    s_waitcnt vmcnt(16)
    s_barrier
    ds_read_b64_tr_b16 v[128:129], v28 offset:0
    ds_read_b64_tr_b16 v[130:131], v28 offset:512
    ds_read_b64_tr_b16 v[132:133], v28 offset:8192
    ds_read_b64_tr_b16 v[134:135], v28 offset:8704
    ds_read_b64_tr_b16 v[136:137], v28 offset:16384
    ds_read_b64_tr_b16 v[138:139], v28 offset:16896
    ds_read_b64_tr_b16 v[140:141], v28 offset:24576
    ds_read_b64_tr_b16 v[142:143], v28 offset:25088
    s_waitcnt lgkmcnt(4)
    ds_read_b64_tr_b16 v[144:145], v28 offset:32768
    ds_read_b64_tr_b16 v[146:147], v28 offset:33280
    ds_read_b64_tr_b16 v[148:149], v28 offset:40960
    ds_read_b64_tr_b16 v[150:151], v28 offset:41472
    ds_read_b64_tr_b16 v[152:153], v28 offset:49152
    ds_read_b64_tr_b16 v[154:155], v28 offset:49664
    ds_read_b64_tr_b16 v[156:157], v28 offset:57344
    ds_read_b64_tr_b16 v[158:159], v28 offset:57856
    s_waitcnt lgkmcnt(4)
    ds_read_b64_tr_b16 v[192:193], v29 offset:0
    ds_read_b64_tr_b16 v[194:195], v29 offset:512
    ds_read_b64_tr_b16 v[196:197], v29 offset:8192
    ds_read_b64_tr_b16 v[198:199], v29 offset:8704
    ds_read_b64_tr_b16 v[200:201], v29 offset:16384
    ds_read_b64_tr_b16 v[202:203], v29 offset:16896
    ds_read_b64_tr_b16 v[204:205], v29 offset:24576
    ds_read_b64_tr_b16 v[206:207], v29 offset:25088
    s_waitcnt lgkmcnt(4)
    ds_read_b64_tr_b16 v[208:209], v29 offset:32768
    ds_read_b64_tr_b16 v[210:211], v29 offset:33280
    ds_read_b64_tr_b16 v[212:213], v29 offset:40960
    ds_read_b64_tr_b16 v[214:215], v29 offset:41472
    ds_read_b64_tr_b16 v[216:217], v29 offset:49152
    ds_read_b64_tr_b16 v[218:219], v29 offset:49664
    ds_read_b64_tr_b16 v[220:221], v29 offset:57344
    ds_read_b64_tr_b16 v[222:223], v29 offset:57856
    s_waitcnt lgkmcnt(4)
    s_waitcnt lgkmcnt(0)
    s_barrier
    s_load_dwordx2 s[76:77], s[0:1], 48
    s_mov_b32 s78, 4194304
    s_mov_b32 s79, 0x20000
    s_waitcnt lgkmcnt(0)
    s_lshl_b32 s24, s9, 10
    s_add_u32 s24, s24, 32768
    s_mov_b32 s25, 0
    s_mov_b32 s28, 0
wdma_103:
    s_mov_b32 m0, s24
    s_add_u32 s24, s24, 4096
    buffer_load_dwordx4 v32, s[76:79], s25 offen  lds
    s_add_u32 s25, s25, 131072
    s_add_u32 s28, s28, 1
    s_cmp_lt_u32 s28, 16
    s_cbranch_scc1 wdma_103
    s_waitcnt vmcnt(16)
    s_barrier
    ds_read_b64_tr_b16 v[160:161], v30 offset:0
    ds_read_b64_tr_b16 v[162:163], v30 offset:512
    ds_read_b64_tr_b16 v[164:165], v30 offset:8192
    ds_read_b64_tr_b16 v[166:167], v30 offset:8704
    ds_read_b64_tr_b16 v[168:169], v30 offset:16384
    ds_read_b64_tr_b16 v[170:171], v30 offset:16896
    ds_read_b64_tr_b16 v[172:173], v30 offset:24576
    ds_read_b64_tr_b16 v[174:175], v30 offset:25088
    s_waitcnt lgkmcnt(4)
    ds_read_b64_tr_b16 v[176:177], v30 offset:32768
    ds_read_b64_tr_b16 v[178:179], v30 offset:33280
    ds_read_b64_tr_b16 v[180:181], v30 offset:40960
    ds_read_b64_tr_b16 v[182:183], v30 offset:41472
    ds_read_b64_tr_b16 v[184:185], v30 offset:49152
    ds_read_b64_tr_b16 v[186:187], v30 offset:49664
    ds_read_b64_tr_b16 v[188:189], v30 offset:57344
    ds_read_b64_tr_b16 v[190:191], v30 offset:57856
    s_waitcnt lgkmcnt(4)
    ds_read_b64_tr_b16 v[224:225], v31 offset:0
    ds_read_b64_tr_b16 v[226:227], v31 offset:512
    ds_read_b64_tr_b16 v[228:229], v31 offset:8192
    ds_read_b64_tr_b16 v[230:231], v31 offset:8704
    ds_read_b64_tr_b16 v[232:233], v31 offset:16384
    ds_read_b64_tr_b16 v[234:235], v31 offset:16896
    ds_read_b64_tr_b16 v[236:237], v31 offset:24576
    ds_read_b64_tr_b16 v[238:239], v31 offset:25088
    s_waitcnt lgkmcnt(4)
    ds_read_b64_tr_b16 v[240:241], v31 offset:32768
    ds_read_b64_tr_b16 v[242:243], v31 offset:33280
    ds_read_b64_tr_b16 v[244:245], v31 offset:40960
    ds_read_b64_tr_b16 v[246:247], v31 offset:41472
    ds_read_b64_tr_b16 v[248:249], v31 offset:49152
    ds_read_b64_tr_b16 v[250:251], v31 offset:49664
    ds_read_b64_tr_b16 v[252:253], v31 offset:57344
    ds_read_b64_tr_b16 v[254:255], v31 offset:57856
    s_waitcnt lgkmcnt(4)
    s_waitcnt lgkmcnt(0)
    s_barrier
    s_lshl_b32 s24, s9, 10
    s_add_u32 s24, s24, 98304
    s_mov_b32 s25, 2097152
    s_mov_b32 s28, 0
wdma_104:
    s_mov_b32 m0, s24
    s_add_u32 s24, s24, 4096
    buffer_load_dwordx4 v32, s[76:79], s25 offen  lds
    s_add_u32 s25, s25, 131072
    s_add_u32 s28, s28, 1
    s_cmp_lt_u32 s28, 16
    s_cbranch_scc1 wdma_104
    s_waitcnt vmcnt(16)
    s_barrier
    ds_read_b64_tr_b16 a[128:129], v28 offset:0
    ds_read_b64_tr_b16 a[130:131], v28 offset:512
    ds_read_b64_tr_b16 a[132:133], v28 offset:8192
    ds_read_b64_tr_b16 a[134:135], v28 offset:8704
    ds_read_b64_tr_b16 a[136:137], v28 offset:16384
    ds_read_b64_tr_b16 a[138:139], v28 offset:16896
    ds_read_b64_tr_b16 a[140:141], v28 offset:24576
    ds_read_b64_tr_b16 a[142:143], v28 offset:25088
    s_waitcnt lgkmcnt(4)
    ds_read_b64_tr_b16 a[144:145], v28 offset:32768
    ds_read_b64_tr_b16 a[146:147], v28 offset:33280
    ds_read_b64_tr_b16 a[148:149], v28 offset:40960
    ds_read_b64_tr_b16 a[150:151], v28 offset:41472
    ds_read_b64_tr_b16 a[152:153], v28 offset:49152
    ds_read_b64_tr_b16 a[154:155], v28 offset:49664
    ds_read_b64_tr_b16 a[156:157], v28 offset:57344
    ds_read_b64_tr_b16 a[158:159], v28 offset:57856
    s_waitcnt lgkmcnt(4)
    ds_read_b64_tr_b16 a[192:193], v29 offset:0
    ds_read_b64_tr_b16 a[194:195], v29 offset:512
    ds_read_b64_tr_b16 a[196:197], v29 offset:8192
    ds_read_b64_tr_b16 a[198:199], v29 offset:8704
    ds_read_b64_tr_b16 a[200:201], v29 offset:16384
    ds_read_b64_tr_b16 a[202:203], v29 offset:16896
    ds_read_b64_tr_b16 a[204:205], v29 offset:24576
    ds_read_b64_tr_b16 a[206:207], v29 offset:25088
    s_waitcnt lgkmcnt(4)
    ds_read_b64_tr_b16 a[208:209], v29 offset:32768
    ds_read_b64_tr_b16 a[210:211], v29 offset:33280
    ds_read_b64_tr_b16 a[212:213], v29 offset:40960
    ds_read_b64_tr_b16 a[214:215], v29 offset:41472
    ds_read_b64_tr_b16 a[216:217], v29 offset:49152
    ds_read_b64_tr_b16 a[218:219], v29 offset:49664
    ds_read_b64_tr_b16 a[220:221], v29 offset:57344
    ds_read_b64_tr_b16 a[222:223], v29 offset:57856
    s_waitcnt lgkmcnt(4)
    s_waitcnt lgkmcnt(0)
    s_barrier
    s_load_dwordx2 s[32:33], s[0:1], 40
    s_mov_b32 s34, 4194304
    s_mov_b32 s35, 0x20000
    s_waitcnt lgkmcnt(0)
    s_lshl_b32 s24, s9, 10
    s_add_u32 s24, s24, 32768
    s_mov_b32 s25, 0
    s_mov_b32 s28, 0
wdma_105:
    s_mov_b32 m0, s24
    s_add_u32 s24, s24, 4096
    buffer_load_dwordx4 v32, s[32:35], s25 offen  lds
    s_add_u32 s25, s25, 131072
    s_add_u32 s28, s28, 1
    s_cmp_lt_u32 s28, 16
    s_cbranch_scc1 wdma_105
    s_waitcnt vmcnt(16)
    s_barrier
    ds_read_b64_tr_b16 a[160:161], v30 offset:0
    ds_read_b64_tr_b16 a[162:163], v30 offset:512
    ds_read_b64_tr_b16 a[164:165], v30 offset:8192
    ds_read_b64_tr_b16 a[166:167], v30 offset:8704
    ds_read_b64_tr_b16 a[168:169], v30 offset:16384
    ds_read_b64_tr_b16 a[170:171], v30 offset:16896
    ds_read_b64_tr_b16 a[172:173], v30 offset:24576
    ds_read_b64_tr_b16 a[174:175], v30 offset:25088
    s_waitcnt lgkmcnt(4)
    ds_read_b64_tr_b16 a[176:177], v30 offset:32768
    ds_read_b64_tr_b16 a[178:179], v30 offset:33280
    ds_read_b64_tr_b16 a[180:181], v30 offset:40960
    ds_read_b64_tr_b16 a[182:183], v30 offset:41472
    ds_read_b64_tr_b16 a[184:185], v30 offset:49152
    ds_read_b64_tr_b16 a[186:187], v30 offset:49664
    ds_read_b64_tr_b16 a[188:189], v30 offset:57344
    ds_read_b64_tr_b16 a[190:191], v30 offset:57856
    s_waitcnt lgkmcnt(4)
    ds_read_b64_tr_b16 a[224:225], v31 offset:0
    ds_read_b64_tr_b16 a[226:227], v31 offset:512
    ds_read_b64_tr_b16 a[228:229], v31 offset:8192
    ds_read_b64_tr_b16 a[230:231], v31 offset:8704
    ds_read_b64_tr_b16 a[232:233], v31 offset:16384
    ds_read_b64_tr_b16 a[234:235], v31 offset:16896
    ds_read_b64_tr_b16 a[236:237], v31 offset:24576
    ds_read_b64_tr_b16 a[238:239], v31 offset:25088
    s_waitcnt lgkmcnt(4)
    ds_read_b64_tr_b16 a[240:241], v31 offset:32768
    ds_read_b64_tr_b16 a[242:243], v31 offset:33280
    ds_read_b64_tr_b16 a[244:245], v31 offset:40960
    ds_read_b64_tr_b16 a[246:247], v31 offset:41472
    ds_read_b64_tr_b16 a[248:249], v31 offset:49152
    ds_read_b64_tr_b16 a[250:251], v31 offset:49664
    ds_read_b64_tr_b16 a[252:253], v31 offset:57344
    ds_read_b64_tr_b16 a[254:255], v31 offset:57856
    s_waitcnt lgkmcnt(4)
    s_waitcnt lgkmcnt(0)
    s_barrier
    s_lshl_b32 s24, s9, 10
    s_add_u32 s24, s24, 98304
    s_mov_b32 s25, 2097152
    s_mov_b32 s28, 0
wdma_106:
    s_mov_b32 m0, s24
    s_add_u32 s24, s24, 4096
    buffer_load_dwordx4 v32, s[32:35], s25 offen  lds
    s_add_u32 s25, s25, 131072
    s_add_u32 s28, s28, 1
    s_cmp_lt_u32 s28, 16
    s_cbranch_scc1 wdma_106
    s_waitcnt vmcnt(16)
    s_barrier
    ds_read_b64_tr_b16 a[0:1], v28 offset:0
    ds_read_b64_tr_b16 a[2:3], v28 offset:512
    ds_read_b64_tr_b16 a[4:5], v28 offset:8192
    ds_read_b64_tr_b16 a[6:7], v28 offset:8704
    ds_read_b64_tr_b16 a[8:9], v28 offset:16384
    ds_read_b64_tr_b16 a[10:11], v28 offset:16896
    ds_read_b64_tr_b16 a[12:13], v28 offset:24576
    ds_read_b64_tr_b16 a[14:15], v28 offset:25088
    s_waitcnt lgkmcnt(4)
    ds_read_b64_tr_b16 a[16:17], v28 offset:32768
    ds_read_b64_tr_b16 a[18:19], v28 offset:33280
    ds_read_b64_tr_b16 a[20:21], v28 offset:40960
    ds_read_b64_tr_b16 a[22:23], v28 offset:41472
    ds_read_b64_tr_b16 a[24:25], v28 offset:49152
    ds_read_b64_tr_b16 a[26:27], v28 offset:49664
    ds_read_b64_tr_b16 a[28:29], v28 offset:57344
    ds_read_b64_tr_b16 a[30:31], v28 offset:57856
    s_waitcnt lgkmcnt(4)
    ds_read_b64_tr_b16 a[64:65], v29 offset:0
    ds_read_b64_tr_b16 a[66:67], v29 offset:512
    ds_read_b64_tr_b16 a[68:69], v29 offset:8192
    ds_read_b64_tr_b16 a[70:71], v29 offset:8704
    ds_read_b64_tr_b16 a[72:73], v29 offset:16384
    ds_read_b64_tr_b16 a[74:75], v29 offset:16896
    ds_read_b64_tr_b16 a[76:77], v29 offset:24576
    ds_read_b64_tr_b16 a[78:79], v29 offset:25088
    s_waitcnt lgkmcnt(4)
    ds_read_b64_tr_b16 a[80:81], v29 offset:32768
    ds_read_b64_tr_b16 a[82:83], v29 offset:33280
    ds_read_b64_tr_b16 a[84:85], v29 offset:40960
    ds_read_b64_tr_b16 a[86:87], v29 offset:41472
    ds_read_b64_tr_b16 a[88:89], v29 offset:49152
    ds_read_b64_tr_b16 a[90:91], v29 offset:49664
    ds_read_b64_tr_b16 a[92:93], v29 offset:57344
    ds_read_b64_tr_b16 a[94:95], v29 offset:57856
    s_waitcnt lgkmcnt(4)
    s_waitcnt lgkmcnt(0)
    s_barrier
    s_load_dwordx2 s[76:77], s[0:1], 64
    s_mov_b32 s78, 4194304
    s_mov_b32 s79, 0x20000
    s_waitcnt lgkmcnt(0)
    s_lshl_b32 s24, s9, 10
    s_add_u32 s24, s24, 32768
    s_lshl_b32 s25, s8, 17
    s_lshl_b32 s26, s9, 10
    s_add_u32 s25, s25, s26
    s_add_u32 s25, s25, 0
    s_mov_b32 s28, 0
wdma_107:
    s_mov_b32 m0, s24
    s_add_u32 s24, s24, 4096
    buffer_load_dwordx4 v33, s[76:79], s25 offen  lds
    s_add_u32 s25, s25, 4096
    s_mov_b32 m0, s24
    s_add_u32 s24, s24, 4096
    buffer_load_dwordx4 v34, s[76:79], s25 offen  lds
    s_add_u32 s25, s25, 4096
    s_mov_b32 m0, s24
    s_add_u32 s24, s24, 4096
    buffer_load_dwordx4 v35, s[76:79], s25 offen  lds
    s_add_u32 s25, s25, 4096
    s_mov_b32 m0, s24
    s_add_u32 s24, s24, 4096
    buffer_load_dwordx4 v36, s[76:79], s25 offen  lds
    s_add_u32 s25, s25, 4096
    s_add_u32 s28, s28, 1
    s_cmp_lt_u32 s28, 4
    s_cbranch_scc1 wdma_107
    s_waitcnt vmcnt(16)
    s_barrier
    ds_read_b64_tr_b16 a[32:33], v30 offset:0
    ds_read_b64_tr_b16 a[34:35], v30 offset:512
    ds_read_b64_tr_b16 a[36:37], v30 offset:8192
    ds_read_b64_tr_b16 a[38:39], v30 offset:8704
    ds_read_b64_tr_b16 a[40:41], v30 offset:16384
    ds_read_b64_tr_b16 a[42:43], v30 offset:16896
    ds_read_b64_tr_b16 a[44:45], v30 offset:24576
    ds_read_b64_tr_b16 a[46:47], v30 offset:25088
    s_waitcnt lgkmcnt(4)
    ds_read_b64_tr_b16 a[48:49], v30 offset:32768
    ds_read_b64_tr_b16 a[50:51], v30 offset:33280
    ds_read_b64_tr_b16 a[52:53], v30 offset:40960
    ds_read_b64_tr_b16 a[54:55], v30 offset:41472
    ds_read_b64_tr_b16 a[56:57], v30 offset:49152
    ds_read_b64_tr_b16 a[58:59], v30 offset:49664
    ds_read_b64_tr_b16 a[60:61], v30 offset:57344
    ds_read_b64_tr_b16 a[62:63], v30 offset:57856
    s_waitcnt lgkmcnt(4)
    ds_read_b64_tr_b16 a[96:97], v31 offset:0
    ds_read_b64_tr_b16 a[98:99], v31 offset:512
    ds_read_b64_tr_b16 a[100:101], v31 offset:8192
    ds_read_b64_tr_b16 a[102:103], v31 offset:8704
    ds_read_b64_tr_b16 a[104:105], v31 offset:16384
    ds_read_b64_tr_b16 a[106:107], v31 offset:16896
    ds_read_b64_tr_b16 a[108:109], v31 offset:24576
    ds_read_b64_tr_b16 a[110:111], v31 offset:25088
    s_waitcnt lgkmcnt(4)
    ds_read_b64_tr_b16 a[112:113], v31 offset:32768
    ds_read_b64_tr_b16 a[114:115], v31 offset:33280
    ds_read_b64_tr_b16 a[116:117], v31 offset:40960
    ds_read_b64_tr_b16 a[118:119], v31 offset:41472
    ds_read_b64_tr_b16 a[120:121], v31 offset:49152
    ds_read_b64_tr_b16 a[122:123], v31 offset:49664
    ds_read_b64_tr_b16 a[124:125], v31 offset:57344
    ds_read_b64_tr_b16 a[126:127], v31 offset:57856
    s_waitcnt lgkmcnt(4)
    s_waitcnt lgkmcnt(0)
    s_barrier
    s_lshl_b32 s24, s9, 10
    s_add_u32 s24, s24, 98304
    s_lshl_b32 s25, s8, 17
    s_lshl_b32 s26, s9, 10
    s_add_u32 s25, s25, s26
    s_add_u32 s25, s25, 65536
    s_mov_b32 s28, 0
wdma_108:
    s_mov_b32 m0, s24
    s_add_u32 s24, s24, 4096
    buffer_load_dwordx4 v33, s[76:79], s25 offen  lds
    s_add_u32 s25, s25, 4096
    s_mov_b32 m0, s24
    s_add_u32 s24, s24, 4096
    buffer_load_dwordx4 v34, s[76:79], s25 offen  lds
    s_add_u32 s25, s25, 4096
    s_mov_b32 m0, s24
    s_add_u32 s24, s24, 4096
    buffer_load_dwordx4 v35, s[76:79], s25 offen  lds
    s_add_u32 s25, s25, 4096
    s_mov_b32 m0, s24
    s_add_u32 s24, s24, 4096
    buffer_load_dwordx4 v36, s[76:79], s25 offen  lds
    s_add_u32 s25, s25, 4096
    s_add_u32 s28, s28, 1
    s_cmp_lt_u32 s28, 4
    s_cbranch_scc1 wdma_108
    s_waitcnt vmcnt(16)
    s_barrier
    v_xor_b32 v29, 0, v25
    v_add_u32 v29, v29, v37
    ds_read_b64_tr_b16 v[40:41], v29 offset:0
    ds_read_b64_tr_b16 v[42:43], v29 offset:2048
    ds_read_b64_tr_b16 v[44:45], v29 offset:32768
    ds_read_b64_tr_b16 v[46:47], v29 offset:34816
    s_waitcnt lgkmcnt(4)
    v_xor_b32 v29, 32, v25
    v_add_u32 v29, v29, v37
    ds_read_b64_tr_b16 v[48:49], v29 offset:0
    ds_read_b64_tr_b16 v[50:51], v29 offset:2048
    ds_read_b64_tr_b16 v[52:53], v29 offset:32768
    ds_read_b64_tr_b16 v[54:55], v29 offset:34816
    s_waitcnt lgkmcnt(4)
    v_xor_b32 v29, 64, v25
    v_add_u32 v29, v29, v37
    ds_read_b64_tr_b16 v[56:57], v29 offset:0
    ds_read_b64_tr_b16 v[58:59], v29 offset:2048
    ds_read_b64_tr_b16 v[60:61], v29 offset:32768
    ds_read_b64_tr_b16 v[62:63], v29 offset:34816
    s_waitcnt lgkmcnt(4)
    v_xor_b32 v29, 96, v25
    v_add_u32 v29, v29, v37
    ds_read_b64_tr_b16 v[64:65], v29 offset:0
    ds_read_b64_tr_b16 v[66:67], v29 offset:2048
    ds_read_b64_tr_b16 v[68:69], v29 offset:32768
    ds_read_b64_tr_b16 v[70:71], v29 offset:34816
    s_waitcnt lgkmcnt(4)
    v_xor_b32 v29, 128, v25
    v_add_u32 v29, v29, v37
    ds_read_b64_tr_b16 v[72:73], v29 offset:0
    ds_read_b64_tr_b16 v[74:75], v29 offset:2048
    ds_read_b64_tr_b16 v[76:77], v29 offset:32768
    ds_read_b64_tr_b16 v[78:79], v29 offset:34816
    s_waitcnt lgkmcnt(4)
    v_xor_b32 v29, 160, v25
    v_add_u32 v29, v29, v37
    ds_read_b64_tr_b16 v[80:81], v29 offset:0
    ds_read_b64_tr_b16 v[82:83], v29 offset:2048
    ds_read_b64_tr_b16 v[84:85], v29 offset:32768
    ds_read_b64_tr_b16 v[86:87], v29 offset:34816
    s_waitcnt lgkmcnt(4)
    v_xor_b32 v29, 192, v25
    v_add_u32 v29, v29, v37
    ds_read_b64_tr_b16 v[88:89], v29 offset:0
    ds_read_b64_tr_b16 v[90:91], v29 offset:2048
    ds_read_b64_tr_b16 v[92:93], v29 offset:32768
    ds_read_b64_tr_b16 v[94:95], v29 offset:34816
    s_waitcnt lgkmcnt(4)
    v_xor_b32 v29, 224, v25
    v_add_u32 v29, v29, v37
    ds_read_b64_tr_b16 v[96:97], v29 offset:0
    ds_read_b64_tr_b16 v[98:99], v29 offset:2048
    ds_read_b64_tr_b16 v[100:101], v29 offset:32768
    ds_read_b64_tr_b16 v[102:103], v29 offset:34816
    s_waitcnt lgkmcnt(4)
    s_waitcnt lgkmcnt(0)
    s_barrier
    ds_write_b128 v2, v[40:43] offset:0
    ds_write_b128 v2, v[44:47] offset:1024
    s_waitcnt lgkmcnt(4)
    ds_write_b128 v2, v[48:51] offset:2048
    ds_write_b128 v2, v[52:55] offset:3072
    s_waitcnt lgkmcnt(4)
    ds_write_b128 v2, v[56:59] offset:4096
    ds_write_b128 v2, v[60:63] offset:5120
    s_waitcnt lgkmcnt(4)
    ds_write_b128 v2, v[64:67] offset:6144
    ds_write_b128 v2, v[68:71] offset:7168
    s_waitcnt lgkmcnt(4)
    ds_write_b128 v2, v[72:75] offset:8192
    ds_write_b128 v2, v[76:79] offset:9216
    s_waitcnt lgkmcnt(4)
    ds_write_b128 v2, v[80:83] offset:10240
    ds_write_b128 v2, v[84:87] offset:11264
    s_waitcnt lgkmcnt(4)
    ds_write_b128 v2, v[88:91] offset:12288
    ds_write_b128 v2, v[92:95] offset:13312
    s_waitcnt lgkmcnt(4)
    ds_write_b128 v2, v[96:99] offset:14336
    ds_write_b128 v2, v[100:103] offset:15360
    s_waitcnt lgkmcnt(4)
    s_waitcnt lgkmcnt(0)
    s_waitcnt vmcnt(0)
    s_barrier
    v_xor_b32 v29, 0, v25
    v_add_u32 v29, v29, v37
    v_add_u32 v29, 0x10000, v29
    ds_read_b64_tr_b16 v[40:41], v29 offset:0
    ds_read_b64_tr_b16 v[42:43], v29 offset:2048
    ds_read_b64_tr_b16 v[44:45], v29 offset:32768
    ds_read_b64_tr_b16 v[46:47], v29 offset:34816
    s_waitcnt lgkmcnt(4)
    v_xor_b32 v29, 32, v25
    v_add_u32 v29, v29, v37
    v_add_u32 v29, 0x10000, v29
    ds_read_b64_tr_b16 v[48:49], v29 offset:0
    ds_read_b64_tr_b16 v[50:51], v29 offset:2048
    ds_read_b64_tr_b16 v[52:53], v29 offset:32768
    ds_read_b64_tr_b16 v[54:55], v29 offset:34816
    s_waitcnt lgkmcnt(4)
    v_xor_b32 v29, 64, v25
    v_add_u32 v29, v29, v37
    v_add_u32 v29, 0x10000, v29
    ds_read_b64_tr_b16 v[56:57], v29 offset:0
    ds_read_b64_tr_b16 v[58:59], v29 offset:2048
    ds_read_b64_tr_b16 v[60:61], v29 offset:32768
    ds_read_b64_tr_b16 v[62:63], v29 offset:34816
    s_waitcnt lgkmcnt(4)
    v_xor_b32 v29, 96, v25
    v_add_u32 v29, v29, v37
    v_add_u32 v29, 0x10000, v29
    ds_read_b64_tr_b16 v[64:65], v29 offset:0
    ds_read_b64_tr_b16 v[66:67], v29 offset:2048
    ds_read_b64_tr_b16 v[68:69], v29 offset:32768
    ds_read_b64_tr_b16 v[70:71], v29 offset:34816
    s_waitcnt lgkmcnt(4)
    v_xor_b32 v29, 128, v25
    v_add_u32 v29, v29, v37
    v_add_u32 v29, 0x10000, v29
    ds_read_b64_tr_b16 v[72:73], v29 offset:0
    ds_read_b64_tr_b16 v[74:75], v29 offset:2048
    ds_read_b64_tr_b16 v[76:77], v29 offset:32768
    ds_read_b64_tr_b16 v[78:79], v29 offset:34816
    s_waitcnt lgkmcnt(4)
    v_xor_b32 v29, 160, v25
    v_add_u32 v29, v29, v37
    v_add_u32 v29, 0x10000, v29
    ds_read_b64_tr_b16 v[80:81], v29 offset:0
    ds_read_b64_tr_b16 v[82:83], v29 offset:2048
    ds_read_b64_tr_b16 v[84:85], v29 offset:32768
    ds_read_b64_tr_b16 v[86:87], v29 offset:34816
    s_waitcnt lgkmcnt(4)
    v_xor_b32 v29, 192, v25
    v_add_u32 v29, v29, v37
    v_add_u32 v29, 0x10000, v29
    ds_read_b64_tr_b16 v[88:89], v29 offset:0
    ds_read_b64_tr_b16 v[90:91], v29 offset:2048
    ds_read_b64_tr_b16 v[92:93], v29 offset:32768
    ds_read_b64_tr_b16 v[94:95], v29 offset:34816
    s_waitcnt lgkmcnt(4)
    v_xor_b32 v29, 224, v25
    v_add_u32 v29, v29, v37
    v_add_u32 v29, 0x10000, v29
    ds_read_b64_tr_b16 v[96:97], v29 offset:0
    ds_read_b64_tr_b16 v[98:99], v29 offset:2048
    ds_read_b64_tr_b16 v[100:101], v29 offset:32768
    ds_read_b64_tr_b16 v[102:103], v29 offset:34816
    s_waitcnt lgkmcnt(4)
    s_waitcnt lgkmcnt(0)
    s_barrier
    ds_write_b128 v3, v[40:43] offset:0
    ds_write_b128 v3, v[44:47] offset:1024
    s_waitcnt lgkmcnt(4)
    ds_write_b128 v3, v[48:51] offset:2048
    ds_write_b128 v3, v[52:55] offset:3072
    s_waitcnt lgkmcnt(4)
    ds_write_b128 v3, v[56:59] offset:4096
    ds_write_b128 v3, v[60:63] offset:5120
    s_waitcnt lgkmcnt(4)
    ds_write_b128 v3, v[64:67] offset:6144
    ds_write_b128 v3, v[68:71] offset:7168
    s_waitcnt lgkmcnt(4)
    ds_write_b128 v3, v[72:75] offset:8192
    ds_write_b128 v3, v[76:79] offset:9216
    s_waitcnt lgkmcnt(4)
    ds_write_b128 v3, v[80:83] offset:10240
    ds_write_b128 v3, v[84:87] offset:11264
    s_waitcnt lgkmcnt(4)
    ds_write_b128 v3, v[88:91] offset:12288
    ds_write_b128 v3, v[92:95] offset:13312
    s_waitcnt lgkmcnt(4)
    ds_write_b128 v3, v[96:99] offset:14336
    ds_write_b128 v3, v[100:103] offset:15360
    s_waitcnt lgkmcnt(4)
    s_waitcnt lgkmcnt(0)
    s_barrier
    s_branch ROLE_R3
ROLE_R:
    s_mov_b32 s8, s91
    s_load_dwordx2 s[4:5], s[0:1], 96
    v_lshrrev_b32 v17, 6, v0
    v_and_b32 v18, 63, v0
    v_readfirstlane_b32 s9, v17
    s_mov_b32 s6, 268435456
    s_mov_b32 s7, 0x20000
    s_mul_i32 s29, s36, 557056
    s_add_u32 s29, s29, 1048576
    v_and_b32 v24, 15, v18
    v_lshrrev_b32 v25, 4, v18
    v_lshlrev_b32 v0, 4, v18
    v_lshrrev_b32 v28, 2, v24
    v_lshlrev_b32 v28, 1, v28
    v_and_b32 v29, 1, v24
    v_add_u32 v28, v28, v29
    v_bfe_u32 v29, v24, 1, 1
    s_lshl_b32 s24, s9, 11
    v_add_u32 v7, s24, v0
    v_lshlrev_b32 v26, 8, v25
    v_lshlrev_b32 v27, 5, v28
    v_add_u32 v26, v26, v27
    v_lshlrev_b32 v27, 4, v29
    v_add3_u32 v1, v26, v27, s24
    s_lshl_b32 s25, s9, 14
    s_add_u32 s25, s25, 32768
    v_add_u32 v2, s25, v0
    v_add_u32 v3, 0x10000, v2
    s_lshl_b32 s25, s9, 3
    v_add_u32 v26, s25, v25
    v_lshlrev_b32 v26, 13, v26
    v_lshrrev_b32 v27, 2, v24
    v_lshlrev_b32 v27, 11, v27
    v_add_u32 v26, v26, v27
    v_and_b32 v27, 3, v24
    v_lshlrev_b32 v27, 4, v27
    s_lshl_b32 s25, s8, 6
    v_add3_u32 v4, v26, v27, s25
    v_lshlrev_b32 v26, 2, v25
    v_and_b32 v27, 3, v18
    v_add_u32 v26, v26, v27
    v_lshlrev_b32 v26, 6, v26
    v_bfe_u32 v27, v18, 2, 2
    v_lshlrev_b32 v27, 4, v27
    s_lshl_b32 s25, s8, 13
    s_add_u32 s25, s25, s24
    v_add3_u32 v5, v26, v27, s25
    v_and_b32 v26, 7, v24
    v_lshlrev_b32 v26, 5, v26
    v_lshrrev_b32 v27, 1, v25
    v_lshlrev_b32 v27, 2, v27
    s_lshl_b32 s25, s8, 8
    s_lshl_b32 s26, s9, 3
    s_add_u32 s25, s25, s26
    v_add3_u32 v6, v26, v27, s25
    v_and_b32 v26, 0x18, v18
    v_cmp_eq_u32 s[20:21], 0, v26
    v_lshlrev_b32 v26, 9, v25
    v_lshlrev_b32 v27, 4, v24
    v_add_u32 v8, v26, v27
    s_lshl_b32 s25, s9, 5
    v_add_u32 v26, s25, v24
    v_lshlrev_b32 v27, 1, v26
    v_mul_u32_u24 v9, 576, v25
    v_add_u32 v9, v9, v27
    v_and_b32 v27, 1, v25
    v_lshlrev_b32 v27, 4, v27
    v_add_u32 v26, v26, v27
    v_lshlrev_b32 v26, 4, v26
    v_lshrrev_b32 v27, 1, v25
    v_lshlrev_b32 v27, 3, v27
    v_add_u32 v16, v26, v27
    v_and_b32 v26, 7, v24
    v_mul_u32_u24 v26, 288, v26
    v_lshlrev_b32 v27, 4, v25
    v_add_u32 v10, v26, v27
    v_mul_u32_u24 v26, 288, v28
    v_add_u32 v15, v26, v27
    v_and_b32 v26, 7, v24
    v_mul_u32_u24 v26, 320, v26
    v_lshlrev_b32 v27, 3, v25
    s_lshl_b32 s25, s9, 6
    v_add3_u32 v11, v26, v27, s25
    v_mul_u32_u24 v26, 320, v28
    v_lshlrev_b32 v27, 5, v25
    v_add_u32 v26, v26, v27
    v_lshlrev_b32 v27, 4, v29
    v_add_u32 v12, v26, v27
    v_mov_b32 v26, 0x4444
    v_mov_b32 v27, 0xeeee
    v_cmp_eq_u32 vcc, 0, v29
    s_nop 1
    v_cndmask_b32 v13, v27, v26, vcc
    v_and_b32 v26, 7, v24
    v_mov_b32 v20, 0
    v_mov_b32 v27, 0x3f80
    v_cmp_eq_u32 vcc, 0, v26
    s_nop 1
    v_cndmask_b32 v20, v20, v27, vcc
    v_mov_b32 v27, 0x3f800000
    v_cmp_eq_u32 vcc, 1, v26
    s_nop 1
    v_cndmask_b32 v20, v20, v27, vcc
    v_mov_b32 v21, 0
    v_mov_b32 v27, 0x3f80
    v_cmp_eq_u32 vcc, 2, v26
    s_nop 1
    v_cndmask_b32 v21, v21, v27, vcc
    v_mov_b32 v27, 0x3f800000
    v_cmp_eq_u32 vcc, 3, v26
    s_nop 1
    v_cndmask_b32 v21, v21, v27, vcc
    v_mov_b32 v22, 0
    v_mov_b32 v27, 0x3f80
    v_cmp_eq_u32 vcc, 4, v26
    s_nop 1
    v_cndmask_b32 v22, v22, v27, vcc
    v_mov_b32 v27, 0x3f800000
    v_cmp_eq_u32 vcc, 5, v26
    s_nop 1
    v_cndmask_b32 v22, v22, v27, vcc
    v_mov_b32 v23, 0
    v_mov_b32 v27, 0x3f80
    v_cmp_eq_u32 vcc, 6, v26
    s_nop 1
    v_cndmask_b32 v23, v23, v27, vcc
    v_mov_b32 v27, 0x3f800000
    v_cmp_eq_u32 vcc, 7, v26
    s_nop 1
    v_cndmask_b32 v23, v23, v27, vcc
    s_mov_b32 s22, 0x3e0293ee
    s_mov_b32 s23, 0xbe0293ee
    s_waitcnt lgkmcnt(0)
    v_lshrrev_b32 v25, 4, v18
    v_and_b32 v24, 15, v18
    v_and_b32 v26, 1, v25
    s_lshl_b32 s24, s9, 1
    v_or_b32 v26, s24, v26
    v_lshlrev_b32 v26, 1, v26
    v_xor_b32 v26, v26, v24
    v_lshlrev_b32 v26, 4, v26
    s_lshl_b32 s24, s9, 2
    v_add_u32 v27, s24, v25
    v_lshlrev_b32 v27, 13, v27
    s_lshl_b32 s24, s8, 8
    v_add3_u32 v32, v26, v27, s24
    v_lshrrev_b32 v26, 2, v24
    v_and_b32 v27, 1, v26
    v_lshrrev_b32 v26, 1, v26
    v_and_b32 v30, 1, v25
    v_lshlrev_b32 v28, 3, v26
    v_add_u32 v28, v28, v27
    v_lshlrev_b32 v29, 2, v30
    v_add_u32 v28, v28, v29
    v_lshrrev_b32 v29, 1, v25
    v_lshlrev_b32 v29, 4, v29
    v_add_u32 v28, v28, v29
    v_lshlrev_b32 v30, 1, v30
    v_or_b32 v30, v30, v27
    v_lshlrev_b32 v26, 2, v26
    v_or_b32 v30, v30, v26
    v_and_b32 v27, 3, v18
    v_lshlrev_b32 v27, 3, v27
    v_mov_b32 v24, v28
    v_mov_b32 v25, v30
    s_lshl_b32 s24, s9, 1
    v_xor_b32 v30, s24, v25
    v_lshlrev_b32 v30, 5, v30
    v_lshlrev_b32 v28, 8, v24
    v_add3_u32 v28, v28, v30, v27
    v_xor_b32 v29, 32, v28
    v_add_u32 v28, 32768, v28
    v_add_u32 v29, 32768, v29
    v_add_u32 v30, 0x10000, v28
    v_add_u32 v31, 0x10000, v29
    s_and_b32 s24, s9, 1
    s_or_b32 s25, s24, 0
    s_lshl_b32 s25, s25, 1
    v_xor_b32 v33, s25, v18
    v_lshlrev_b32 v33, 4, v33
    s_or_b32 s25, s24, 2
    s_lshl_b32 s25, s25, 1
    v_xor_b32 v34, s25, v18
    v_lshlrev_b32 v34, 4, v34
    s_or_b32 s25, s24, 4
    s_lshl_b32 s25, s25, 1
    v_xor_b32 v35, s25, v18
    v_lshlrev_b32 v35, 4, v35
    s_or_b32 s25, s24, 6
    s_lshl_b32 s25, s25, 1
    v_xor_b32 v36, s25, v18
    v_lshlrev_b32 v36, 4, v36
    v_lshlrev_b32 v37, 10, v24
    s_lshl_b32 s26, s9, 8
    s_add_u32 s26, s26, 32768
    v_add3_u32 v37, v37, v27, s26
    v_lshlrev_b32 v25, 5, v25
    s_load_dwordx2 s[32:33], s[0:1], 56
    s_mov_b32 s34, 4194304
    s_mov_b32 s35, 0x20000
    s_waitcnt lgkmcnt(0)
    s_lshl_b32 s24, s9, 10
    s_add_u32 s24, s24, 32768
    s_mov_b32 s25, 0
    s_mov_b32 s28, 0
wdma_109:
    s_mov_b32 m0, s24
    s_add_u32 s24, s24, 4096
    buffer_load_dwordx4 v32, s[32:35], s25 offen  lds
    s_add_u32 s25, s25, 131072
    s_add_u32 s28, s28, 1
    s_cmp_lt_u32 s28, 16
    s_cbranch_scc1 wdma_109
    s_lshl_b32 s24, s9, 10
    s_add_u32 s24, s24, 98304
    s_mov_b32 s25, 2097152
    s_mov_b32 s28, 0
wdma_110:
    s_mov_b32 m0, s24
    s_add_u32 s24, s24, 4096
    buffer_load_dwordx4 v32, s[32:35], s25 offen  lds
    s_add_u32 s25, s25, 131072
    s_add_u32 s28, s28, 1
    s_cmp_lt_u32 s28, 16
    s_cbranch_scc1 wdma_110
    s_waitcnt vmcnt(16)
    s_barrier
    ds_read_b64_tr_b16 v[128:129], v28 offset:0
    ds_read_b64_tr_b16 v[130:131], v28 offset:512
    ds_read_b64_tr_b16 v[132:133], v28 offset:8192
    ds_read_b64_tr_b16 v[134:135], v28 offset:8704
    ds_read_b64_tr_b16 v[136:137], v28 offset:16384
    ds_read_b64_tr_b16 v[138:139], v28 offset:16896
    ds_read_b64_tr_b16 v[140:141], v28 offset:24576
    ds_read_b64_tr_b16 v[142:143], v28 offset:25088
    s_waitcnt lgkmcnt(4)
    ds_read_b64_tr_b16 v[144:145], v28 offset:32768
    ds_read_b64_tr_b16 v[146:147], v28 offset:33280
    ds_read_b64_tr_b16 v[148:149], v28 offset:40960
    ds_read_b64_tr_b16 v[150:151], v28 offset:41472
    ds_read_b64_tr_b16 v[152:153], v28 offset:49152
    ds_read_b64_tr_b16 v[154:155], v28 offset:49664
    ds_read_b64_tr_b16 v[156:157], v28 offset:57344
    ds_read_b64_tr_b16 v[158:159], v28 offset:57856
    s_waitcnt lgkmcnt(4)
    ds_read_b64_tr_b16 v[192:193], v29 offset:0
    ds_read_b64_tr_b16 v[194:195], v29 offset:512
    ds_read_b64_tr_b16 v[196:197], v29 offset:8192
    ds_read_b64_tr_b16 v[198:199], v29 offset:8704
    ds_read_b64_tr_b16 v[200:201], v29 offset:16384
    ds_read_b64_tr_b16 v[202:203], v29 offset:16896
    ds_read_b64_tr_b16 v[204:205], v29 offset:24576
    ds_read_b64_tr_b16 v[206:207], v29 offset:25088
    s_waitcnt lgkmcnt(4)
    ds_read_b64_tr_b16 v[208:209], v29 offset:32768
    ds_read_b64_tr_b16 v[210:211], v29 offset:33280
    ds_read_b64_tr_b16 v[212:213], v29 offset:40960
    ds_read_b64_tr_b16 v[214:215], v29 offset:41472
    ds_read_b64_tr_b16 v[216:217], v29 offset:49152
    ds_read_b64_tr_b16 v[218:219], v29 offset:49664
    ds_read_b64_tr_b16 v[220:221], v29 offset:57344
    ds_read_b64_tr_b16 v[222:223], v29 offset:57856
    s_waitcnt lgkmcnt(4)
    s_waitcnt lgkmcnt(0)
    s_barrier
    s_load_dwordx2 s[76:77], s[0:1], 48
    s_mov_b32 s78, 4194304
    s_mov_b32 s79, 0x20000
    s_waitcnt lgkmcnt(0)
    s_lshl_b32 s24, s9, 10
    s_add_u32 s24, s24, 32768
    s_mov_b32 s25, 0
    s_mov_b32 s28, 0
wdma_111:
    s_mov_b32 m0, s24
    s_add_u32 s24, s24, 4096
    buffer_load_dwordx4 v32, s[76:79], s25 offen  lds
    s_add_u32 s25, s25, 131072
    s_add_u32 s28, s28, 1
    s_cmp_lt_u32 s28, 16
    s_cbranch_scc1 wdma_111
    s_waitcnt vmcnt(16)
    s_barrier
    ds_read_b64_tr_b16 v[160:161], v30 offset:0
    ds_read_b64_tr_b16 v[162:163], v30 offset:512
    ds_read_b64_tr_b16 v[164:165], v30 offset:8192
    ds_read_b64_tr_b16 v[166:167], v30 offset:8704
    ds_read_b64_tr_b16 v[168:169], v30 offset:16384
    ds_read_b64_tr_b16 v[170:171], v30 offset:16896
    ds_read_b64_tr_b16 v[172:173], v30 offset:24576
    ds_read_b64_tr_b16 v[174:175], v30 offset:25088
    s_waitcnt lgkmcnt(4)
    ds_read_b64_tr_b16 v[176:177], v30 offset:32768
    ds_read_b64_tr_b16 v[178:179], v30 offset:33280
    ds_read_b64_tr_b16 v[180:181], v30 offset:40960
    ds_read_b64_tr_b16 v[182:183], v30 offset:41472
    ds_read_b64_tr_b16 v[184:185], v30 offset:49152
    ds_read_b64_tr_b16 v[186:187], v30 offset:49664
    ds_read_b64_tr_b16 v[188:189], v30 offset:57344
    ds_read_b64_tr_b16 v[190:191], v30 offset:57856
    s_waitcnt lgkmcnt(4)
    ds_read_b64_tr_b16 v[224:225], v31 offset:0
    ds_read_b64_tr_b16 v[226:227], v31 offset:512
    ds_read_b64_tr_b16 v[228:229], v31 offset:8192
    ds_read_b64_tr_b16 v[230:231], v31 offset:8704
    ds_read_b64_tr_b16 v[232:233], v31 offset:16384
    ds_read_b64_tr_b16 v[234:235], v31 offset:16896
    ds_read_b64_tr_b16 v[236:237], v31 offset:24576
    ds_read_b64_tr_b16 v[238:239], v31 offset:25088
    s_waitcnt lgkmcnt(4)
    ds_read_b64_tr_b16 v[240:241], v31 offset:32768
    ds_read_b64_tr_b16 v[242:243], v31 offset:33280
    ds_read_b64_tr_b16 v[244:245], v31 offset:40960
    ds_read_b64_tr_b16 v[246:247], v31 offset:41472
    ds_read_b64_tr_b16 v[248:249], v31 offset:49152
    ds_read_b64_tr_b16 v[250:251], v31 offset:49664
    ds_read_b64_tr_b16 v[252:253], v31 offset:57344
    ds_read_b64_tr_b16 v[254:255], v31 offset:57856
    s_waitcnt lgkmcnt(4)
    s_waitcnt lgkmcnt(0)
    s_barrier
    s_lshl_b32 s24, s9, 10
    s_add_u32 s24, s24, 98304
    s_mov_b32 s25, 2097152
    s_mov_b32 s28, 0
wdma_112:
    s_mov_b32 m0, s24
    s_add_u32 s24, s24, 4096
    buffer_load_dwordx4 v32, s[76:79], s25 offen  lds
    s_add_u32 s25, s25, 131072
    s_add_u32 s28, s28, 1
    s_cmp_lt_u32 s28, 16
    s_cbranch_scc1 wdma_112
    s_waitcnt vmcnt(16)
    s_barrier
    ds_read_b64_tr_b16 a[128:129], v28 offset:0
    ds_read_b64_tr_b16 a[130:131], v28 offset:512
    ds_read_b64_tr_b16 a[132:133], v28 offset:8192
    ds_read_b64_tr_b16 a[134:135], v28 offset:8704
    ds_read_b64_tr_b16 a[136:137], v28 offset:16384
    ds_read_b64_tr_b16 a[138:139], v28 offset:16896
    ds_read_b64_tr_b16 a[140:141], v28 offset:24576
    ds_read_b64_tr_b16 a[142:143], v28 offset:25088
    s_waitcnt lgkmcnt(4)
    ds_read_b64_tr_b16 a[144:145], v28 offset:32768
    ds_read_b64_tr_b16 a[146:147], v28 offset:33280
    ds_read_b64_tr_b16 a[148:149], v28 offset:40960
    ds_read_b64_tr_b16 a[150:151], v28 offset:41472
    ds_read_b64_tr_b16 a[152:153], v28 offset:49152
    ds_read_b64_tr_b16 a[154:155], v28 offset:49664
    ds_read_b64_tr_b16 a[156:157], v28 offset:57344
    ds_read_b64_tr_b16 a[158:159], v28 offset:57856
    s_waitcnt lgkmcnt(4)
    ds_read_b64_tr_b16 a[192:193], v29 offset:0
    ds_read_b64_tr_b16 a[194:195], v29 offset:512
    ds_read_b64_tr_b16 a[196:197], v29 offset:8192
    ds_read_b64_tr_b16 a[198:199], v29 offset:8704
    ds_read_b64_tr_b16 a[200:201], v29 offset:16384
    ds_read_b64_tr_b16 a[202:203], v29 offset:16896
    ds_read_b64_tr_b16 a[204:205], v29 offset:24576
    ds_read_b64_tr_b16 a[206:207], v29 offset:25088
    s_waitcnt lgkmcnt(4)
    ds_read_b64_tr_b16 a[208:209], v29 offset:32768
    ds_read_b64_tr_b16 a[210:211], v29 offset:33280
    ds_read_b64_tr_b16 a[212:213], v29 offset:40960
    ds_read_b64_tr_b16 a[214:215], v29 offset:41472
    ds_read_b64_tr_b16 a[216:217], v29 offset:49152
    ds_read_b64_tr_b16 a[218:219], v29 offset:49664
    ds_read_b64_tr_b16 a[220:221], v29 offset:57344
    ds_read_b64_tr_b16 a[222:223], v29 offset:57856
    s_waitcnt lgkmcnt(4)
    s_waitcnt lgkmcnt(0)
    s_barrier
    s_load_dwordx2 s[32:33], s[0:1], 40
    s_mov_b32 s34, 4194304
    s_mov_b32 s35, 0x20000
    s_waitcnt lgkmcnt(0)
    s_lshl_b32 s24, s9, 10
    s_add_u32 s24, s24, 32768
    s_mov_b32 s25, 0
    s_mov_b32 s28, 0
wdma_113:
    s_mov_b32 m0, s24
    s_add_u32 s24, s24, 4096
    buffer_load_dwordx4 v32, s[32:35], s25 offen  lds
    s_add_u32 s25, s25, 131072
    s_add_u32 s28, s28, 1
    s_cmp_lt_u32 s28, 16
    s_cbranch_scc1 wdma_113
    s_waitcnt vmcnt(16)
    s_barrier
    ds_read_b64_tr_b16 a[160:161], v30 offset:0
    ds_read_b64_tr_b16 a[162:163], v30 offset:512
    ds_read_b64_tr_b16 a[164:165], v30 offset:8192
    ds_read_b64_tr_b16 a[166:167], v30 offset:8704
    ds_read_b64_tr_b16 a[168:169], v30 offset:16384
    ds_read_b64_tr_b16 a[170:171], v30 offset:16896
    ds_read_b64_tr_b16 a[172:173], v30 offset:24576
    ds_read_b64_tr_b16 a[174:175], v30 offset:25088
    s_waitcnt lgkmcnt(4)
    ds_read_b64_tr_b16 a[176:177], v30 offset:32768
    ds_read_b64_tr_b16 a[178:179], v30 offset:33280
    ds_read_b64_tr_b16 a[180:181], v30 offset:40960
    ds_read_b64_tr_b16 a[182:183], v30 offset:41472
    ds_read_b64_tr_b16 a[184:185], v30 offset:49152
    ds_read_b64_tr_b16 a[186:187], v30 offset:49664
    ds_read_b64_tr_b16 a[188:189], v30 offset:57344
    ds_read_b64_tr_b16 a[190:191], v30 offset:57856
    s_waitcnt lgkmcnt(4)
    ds_read_b64_tr_b16 a[224:225], v31 offset:0
    ds_read_b64_tr_b16 a[226:227], v31 offset:512
    ds_read_b64_tr_b16 a[228:229], v31 offset:8192
    ds_read_b64_tr_b16 a[230:231], v31 offset:8704
    ds_read_b64_tr_b16 a[232:233], v31 offset:16384
    ds_read_b64_tr_b16 a[234:235], v31 offset:16896
    ds_read_b64_tr_b16 a[236:237], v31 offset:24576
    ds_read_b64_tr_b16 a[238:239], v31 offset:25088
    s_waitcnt lgkmcnt(4)
    ds_read_b64_tr_b16 a[240:241], v31 offset:32768
    ds_read_b64_tr_b16 a[242:243], v31 offset:33280
    ds_read_b64_tr_b16 a[244:245], v31 offset:40960
    ds_read_b64_tr_b16 a[246:247], v31 offset:41472
    ds_read_b64_tr_b16 a[248:249], v31 offset:49152
    ds_read_b64_tr_b16 a[250:251], v31 offset:49664
    ds_read_b64_tr_b16 a[252:253], v31 offset:57344
    ds_read_b64_tr_b16 a[254:255], v31 offset:57856
    s_waitcnt lgkmcnt(4)
    s_waitcnt lgkmcnt(0)
    s_barrier
    s_lshl_b32 s24, s9, 10
    s_add_u32 s24, s24, 98304
    s_mov_b32 s25, 2097152
    s_mov_b32 s28, 0
wdma_114:
    s_mov_b32 m0, s24
    s_add_u32 s24, s24, 4096
    buffer_load_dwordx4 v32, s[32:35], s25 offen  lds
    s_add_u32 s25, s25, 131072
    s_add_u32 s28, s28, 1
    s_cmp_lt_u32 s28, 16
    s_cbranch_scc1 wdma_114
    s_waitcnt vmcnt(16)
    s_barrier
    ds_read_b64_tr_b16 a[0:1], v28 offset:0
    ds_read_b64_tr_b16 a[2:3], v28 offset:512
    ds_read_b64_tr_b16 a[4:5], v28 offset:8192
    ds_read_b64_tr_b16 a[6:7], v28 offset:8704
    ds_read_b64_tr_b16 a[8:9], v28 offset:16384
    ds_read_b64_tr_b16 a[10:11], v28 offset:16896
    ds_read_b64_tr_b16 a[12:13], v28 offset:24576
    ds_read_b64_tr_b16 a[14:15], v28 offset:25088
    s_waitcnt lgkmcnt(4)
    ds_read_b64_tr_b16 a[16:17], v28 offset:32768
    ds_read_b64_tr_b16 a[18:19], v28 offset:33280
    ds_read_b64_tr_b16 a[20:21], v28 offset:40960
    ds_read_b64_tr_b16 a[22:23], v28 offset:41472
    ds_read_b64_tr_b16 a[24:25], v28 offset:49152
    ds_read_b64_tr_b16 a[26:27], v28 offset:49664
    ds_read_b64_tr_b16 a[28:29], v28 offset:57344
    ds_read_b64_tr_b16 a[30:31], v28 offset:57856
    s_waitcnt lgkmcnt(4)
    ds_read_b64_tr_b16 a[64:65], v29 offset:0
    ds_read_b64_tr_b16 a[66:67], v29 offset:512
    ds_read_b64_tr_b16 a[68:69], v29 offset:8192
    ds_read_b64_tr_b16 a[70:71], v29 offset:8704
    ds_read_b64_tr_b16 a[72:73], v29 offset:16384
    ds_read_b64_tr_b16 a[74:75], v29 offset:16896
    ds_read_b64_tr_b16 a[76:77], v29 offset:24576
    ds_read_b64_tr_b16 a[78:79], v29 offset:25088
    s_waitcnt lgkmcnt(4)
    ds_read_b64_tr_b16 a[80:81], v29 offset:32768
    ds_read_b64_tr_b16 a[82:83], v29 offset:33280
    ds_read_b64_tr_b16 a[84:85], v29 offset:40960
    ds_read_b64_tr_b16 a[86:87], v29 offset:41472
    ds_read_b64_tr_b16 a[88:89], v29 offset:49152
    ds_read_b64_tr_b16 a[90:91], v29 offset:49664
    ds_read_b64_tr_b16 a[92:93], v29 offset:57344
    ds_read_b64_tr_b16 a[94:95], v29 offset:57856
    s_waitcnt lgkmcnt(4)
    s_waitcnt lgkmcnt(0)
    s_barrier
    s_load_dwordx2 s[76:77], s[0:1], 64
    s_mov_b32 s78, 4194304
    s_mov_b32 s79, 0x20000
    s_waitcnt lgkmcnt(0)
    s_lshl_b32 s24, s9, 10
    s_add_u32 s24, s24, 32768
    s_lshl_b32 s25, s8, 17
    s_lshl_b32 s26, s9, 10
    s_add_u32 s25, s25, s26
    s_add_u32 s25, s25, 0
    s_mov_b32 s28, 0
wdma_115:
    s_mov_b32 m0, s24
    s_add_u32 s24, s24, 4096
    buffer_load_dwordx4 v33, s[76:79], s25 offen  lds
    s_add_u32 s25, s25, 4096
    s_mov_b32 m0, s24
    s_add_u32 s24, s24, 4096
    buffer_load_dwordx4 v34, s[76:79], s25 offen  lds
    s_add_u32 s25, s25, 4096
    s_mov_b32 m0, s24
    s_add_u32 s24, s24, 4096
    buffer_load_dwordx4 v35, s[76:79], s25 offen  lds
    s_add_u32 s25, s25, 4096
    s_mov_b32 m0, s24
    s_add_u32 s24, s24, 4096
    buffer_load_dwordx4 v36, s[76:79], s25 offen  lds
    s_add_u32 s25, s25, 4096
    s_add_u32 s28, s28, 1
    s_cmp_lt_u32 s28, 4
    s_cbranch_scc1 wdma_115
    s_waitcnt vmcnt(16)
    s_barrier
    ds_read_b64_tr_b16 a[32:33], v30 offset:0
    ds_read_b64_tr_b16 a[34:35], v30 offset:512
    ds_read_b64_tr_b16 a[36:37], v30 offset:8192
    ds_read_b64_tr_b16 a[38:39], v30 offset:8704
    ds_read_b64_tr_b16 a[40:41], v30 offset:16384
    ds_read_b64_tr_b16 a[42:43], v30 offset:16896
    ds_read_b64_tr_b16 a[44:45], v30 offset:24576
    ds_read_b64_tr_b16 a[46:47], v30 offset:25088
    s_waitcnt lgkmcnt(4)
    ds_read_b64_tr_b16 a[48:49], v30 offset:32768
    ds_read_b64_tr_b16 a[50:51], v30 offset:33280
    ds_read_b64_tr_b16 a[52:53], v30 offset:40960
    ds_read_b64_tr_b16 a[54:55], v30 offset:41472
    ds_read_b64_tr_b16 a[56:57], v30 offset:49152
    ds_read_b64_tr_b16 a[58:59], v30 offset:49664
    ds_read_b64_tr_b16 a[60:61], v30 offset:57344
    ds_read_b64_tr_b16 a[62:63], v30 offset:57856
    s_waitcnt lgkmcnt(4)
    ds_read_b64_tr_b16 a[96:97], v31 offset:0
    ds_read_b64_tr_b16 a[98:99], v31 offset:512
    ds_read_b64_tr_b16 a[100:101], v31 offset:8192
    ds_read_b64_tr_b16 a[102:103], v31 offset:8704
    ds_read_b64_tr_b16 a[104:105], v31 offset:16384
    ds_read_b64_tr_b16 a[106:107], v31 offset:16896
    ds_read_b64_tr_b16 a[108:109], v31 offset:24576
    ds_read_b64_tr_b16 a[110:111], v31 offset:25088
    s_waitcnt lgkmcnt(4)
    ds_read_b64_tr_b16 a[112:113], v31 offset:32768
    ds_read_b64_tr_b16 a[114:115], v31 offset:33280
    ds_read_b64_tr_b16 a[116:117], v31 offset:40960
    ds_read_b64_tr_b16 a[118:119], v31 offset:41472
    ds_read_b64_tr_b16 a[120:121], v31 offset:49152
    ds_read_b64_tr_b16 a[122:123], v31 offset:49664
    ds_read_b64_tr_b16 a[124:125], v31 offset:57344
    ds_read_b64_tr_b16 a[126:127], v31 offset:57856
    s_waitcnt lgkmcnt(4)
    s_waitcnt lgkmcnt(0)
    s_barrier
    s_lshl_b32 s24, s9, 10
    s_add_u32 s24, s24, 98304
    s_lshl_b32 s25, s8, 17
    s_lshl_b32 s26, s9, 10
    s_add_u32 s25, s25, s26
    s_add_u32 s25, s25, 65536
    s_mov_b32 s28, 0
wdma_116:
    s_mov_b32 m0, s24
    s_add_u32 s24, s24, 4096
    buffer_load_dwordx4 v33, s[76:79], s25 offen  lds
    s_add_u32 s25, s25, 4096
    s_mov_b32 m0, s24
    s_add_u32 s24, s24, 4096
    buffer_load_dwordx4 v34, s[76:79], s25 offen  lds
    s_add_u32 s25, s25, 4096
    s_mov_b32 m0, s24
    s_add_u32 s24, s24, 4096
    buffer_load_dwordx4 v35, s[76:79], s25 offen  lds
    s_add_u32 s25, s25, 4096
    s_mov_b32 m0, s24
    s_add_u32 s24, s24, 4096
    buffer_load_dwordx4 v36, s[76:79], s25 offen  lds
    s_add_u32 s25, s25, 4096
    s_add_u32 s28, s28, 1
    s_cmp_lt_u32 s28, 4
    s_cbranch_scc1 wdma_116
    s_waitcnt vmcnt(16)
    s_barrier
    v_xor_b32 v29, 0, v25
    v_add_u32 v29, v29, v37
    ds_read_b64_tr_b16 v[40:41], v29 offset:0
    ds_read_b64_tr_b16 v[42:43], v29 offset:2048
    ds_read_b64_tr_b16 v[44:45], v29 offset:32768
    ds_read_b64_tr_b16 v[46:47], v29 offset:34816
    s_waitcnt lgkmcnt(4)
    v_xor_b32 v29, 32, v25
    v_add_u32 v29, v29, v37
    ds_read_b64_tr_b16 v[48:49], v29 offset:0
    ds_read_b64_tr_b16 v[50:51], v29 offset:2048
    ds_read_b64_tr_b16 v[52:53], v29 offset:32768
    ds_read_b64_tr_b16 v[54:55], v29 offset:34816
    s_waitcnt lgkmcnt(4)
    v_xor_b32 v29, 64, v25
    v_add_u32 v29, v29, v37
    ds_read_b64_tr_b16 v[56:57], v29 offset:0
    ds_read_b64_tr_b16 v[58:59], v29 offset:2048
    ds_read_b64_tr_b16 v[60:61], v29 offset:32768
    ds_read_b64_tr_b16 v[62:63], v29 offset:34816
    s_waitcnt lgkmcnt(4)
    v_xor_b32 v29, 96, v25
    v_add_u32 v29, v29, v37
    ds_read_b64_tr_b16 v[64:65], v29 offset:0
    ds_read_b64_tr_b16 v[66:67], v29 offset:2048
    ds_read_b64_tr_b16 v[68:69], v29 offset:32768
    ds_read_b64_tr_b16 v[70:71], v29 offset:34816
    s_waitcnt lgkmcnt(4)
    v_xor_b32 v29, 128, v25
    v_add_u32 v29, v29, v37
    ds_read_b64_tr_b16 v[72:73], v29 offset:0
    ds_read_b64_tr_b16 v[74:75], v29 offset:2048
    ds_read_b64_tr_b16 v[76:77], v29 offset:32768
    ds_read_b64_tr_b16 v[78:79], v29 offset:34816
    s_waitcnt lgkmcnt(4)
    v_xor_b32 v29, 160, v25
    v_add_u32 v29, v29, v37
    ds_read_b64_tr_b16 v[80:81], v29 offset:0
    ds_read_b64_tr_b16 v[82:83], v29 offset:2048
    ds_read_b64_tr_b16 v[84:85], v29 offset:32768
    ds_read_b64_tr_b16 v[86:87], v29 offset:34816
    s_waitcnt lgkmcnt(4)
    v_xor_b32 v29, 192, v25
    v_add_u32 v29, v29, v37
    ds_read_b64_tr_b16 v[88:89], v29 offset:0
    ds_read_b64_tr_b16 v[90:91], v29 offset:2048
    ds_read_b64_tr_b16 v[92:93], v29 offset:32768
    ds_read_b64_tr_b16 v[94:95], v29 offset:34816
    s_waitcnt lgkmcnt(4)
    v_xor_b32 v29, 224, v25
    v_add_u32 v29, v29, v37
    ds_read_b64_tr_b16 v[96:97], v29 offset:0
    ds_read_b64_tr_b16 v[98:99], v29 offset:2048
    ds_read_b64_tr_b16 v[100:101], v29 offset:32768
    ds_read_b64_tr_b16 v[102:103], v29 offset:34816
    s_waitcnt lgkmcnt(4)
    s_waitcnt lgkmcnt(0)
    s_barrier
    ds_write_b128 v2, v[40:43] offset:0
    ds_write_b128 v2, v[44:47] offset:1024
    s_waitcnt lgkmcnt(4)
    ds_write_b128 v2, v[48:51] offset:2048
    ds_write_b128 v2, v[52:55] offset:3072
    s_waitcnt lgkmcnt(4)
    ds_write_b128 v2, v[56:59] offset:4096
    ds_write_b128 v2, v[60:63] offset:5120
    s_waitcnt lgkmcnt(4)
    ds_write_b128 v2, v[64:67] offset:6144
    ds_write_b128 v2, v[68:71] offset:7168
    s_waitcnt lgkmcnt(4)
    ds_write_b128 v2, v[72:75] offset:8192
    ds_write_b128 v2, v[76:79] offset:9216
    s_waitcnt lgkmcnt(4)
    ds_write_b128 v2, v[80:83] offset:10240
    ds_write_b128 v2, v[84:87] offset:11264
    s_waitcnt lgkmcnt(4)
    ds_write_b128 v2, v[88:91] offset:12288
    ds_write_b128 v2, v[92:95] offset:13312
    s_waitcnt lgkmcnt(4)
    ds_write_b128 v2, v[96:99] offset:14336
    ds_write_b128 v2, v[100:103] offset:15360
    s_waitcnt lgkmcnt(4)
    s_waitcnt lgkmcnt(0)
    s_waitcnt vmcnt(0)
    s_barrier
    v_xor_b32 v29, 0, v25
    v_add_u32 v29, v29, v37
    v_add_u32 v29, 0x10000, v29
    ds_read_b64_tr_b16 v[40:41], v29 offset:0
    ds_read_b64_tr_b16 v[42:43], v29 offset:2048
    ds_read_b64_tr_b16 v[44:45], v29 offset:32768
    ds_read_b64_tr_b16 v[46:47], v29 offset:34816
    s_waitcnt lgkmcnt(4)
    v_xor_b32 v29, 32, v25
    v_add_u32 v29, v29, v37
    v_add_u32 v29, 0x10000, v29
    ds_read_b64_tr_b16 v[48:49], v29 offset:0
    ds_read_b64_tr_b16 v[50:51], v29 offset:2048
    ds_read_b64_tr_b16 v[52:53], v29 offset:32768
    ds_read_b64_tr_b16 v[54:55], v29 offset:34816
    s_waitcnt lgkmcnt(4)
    v_xor_b32 v29, 64, v25
    v_add_u32 v29, v29, v37
    v_add_u32 v29, 0x10000, v29
    ds_read_b64_tr_b16 v[56:57], v29 offset:0
    ds_read_b64_tr_b16 v[58:59], v29 offset:2048
    ds_read_b64_tr_b16 v[60:61], v29 offset:32768
    ds_read_b64_tr_b16 v[62:63], v29 offset:34816
    s_waitcnt lgkmcnt(4)
    v_xor_b32 v29, 96, v25
    v_add_u32 v29, v29, v37
    v_add_u32 v29, 0x10000, v29
    ds_read_b64_tr_b16 v[64:65], v29 offset:0
    ds_read_b64_tr_b16 v[66:67], v29 offset:2048
    ds_read_b64_tr_b16 v[68:69], v29 offset:32768
    ds_read_b64_tr_b16 v[70:71], v29 offset:34816
    s_waitcnt lgkmcnt(4)
    v_xor_b32 v29, 128, v25
    v_add_u32 v29, v29, v37
    v_add_u32 v29, 0x10000, v29
    ds_read_b64_tr_b16 v[72:73], v29 offset:0
    ds_read_b64_tr_b16 v[74:75], v29 offset:2048
    ds_read_b64_tr_b16 v[76:77], v29 offset:32768
    ds_read_b64_tr_b16 v[78:79], v29 offset:34816
    s_waitcnt lgkmcnt(4)
    v_xor_b32 v29, 160, v25
    v_add_u32 v29, v29, v37
    v_add_u32 v29, 0x10000, v29
    ds_read_b64_tr_b16 v[80:81], v29 offset:0
    ds_read_b64_tr_b16 v[82:83], v29 offset:2048
    ds_read_b64_tr_b16 v[84:85], v29 offset:32768
    ds_read_b64_tr_b16 v[86:87], v29 offset:34816
    s_waitcnt lgkmcnt(4)
    v_xor_b32 v29, 192, v25
    v_add_u32 v29, v29, v37
    v_add_u32 v29, 0x10000, v29
    ds_read_b64_tr_b16 v[88:89], v29 offset:0
    ds_read_b64_tr_b16 v[90:91], v29 offset:2048
    ds_read_b64_tr_b16 v[92:93], v29 offset:32768
    ds_read_b64_tr_b16 v[94:95], v29 offset:34816
    s_waitcnt lgkmcnt(4)
    v_xor_b32 v29, 224, v25
    v_add_u32 v29, v29, v37
    v_add_u32 v29, 0x10000, v29
    ds_read_b64_tr_b16 v[96:97], v29 offset:0
    ds_read_b64_tr_b16 v[98:99], v29 offset:2048
    ds_read_b64_tr_b16 v[100:101], v29 offset:32768
    ds_read_b64_tr_b16 v[102:103], v29 offset:34816
    s_waitcnt lgkmcnt(4)
    s_waitcnt lgkmcnt(0)
    s_barrier
    ds_write_b128 v3, v[40:43] offset:0
    ds_write_b128 v3, v[44:47] offset:1024
    s_waitcnt lgkmcnt(4)
    ds_write_b128 v3, v[48:51] offset:2048
    ds_write_b128 v3, v[52:55] offset:3072
    s_waitcnt lgkmcnt(4)
    ds_write_b128 v3, v[56:59] offset:4096
    ds_write_b128 v3, v[60:63] offset:5120
    s_waitcnt lgkmcnt(4)
    ds_write_b128 v3, v[64:67] offset:6144
    ds_write_b128 v3, v[68:71] offset:7168
    s_waitcnt lgkmcnt(4)
    ds_write_b128 v3, v[72:75] offset:8192
    ds_write_b128 v3, v[76:79] offset:9216
    s_waitcnt lgkmcnt(4)
    ds_write_b128 v3, v[80:83] offset:10240
    ds_write_b128 v3, v[84:87] offset:11264
    s_waitcnt lgkmcnt(4)
    ds_write_b128 v3, v[88:91] offset:12288
    ds_write_b128 v3, v[92:95] offset:13312
    s_waitcnt lgkmcnt(4)
    ds_write_b128 v3, v[96:99] offset:14336
    ds_write_b128 v3, v[100:103] offset:15360
    s_waitcnt lgkmcnt(4)
    s_waitcnt lgkmcnt(0)
    s_barrier
    s_cmp_lg_u32 s95, 0
    s_cbranch_scc1 R_RWB
    s_mov_b32 s94, 0
    v_mbcnt_lo_u32_b32 v118, -1, 0
    v_mbcnt_hi_u32_b32 v118, -1, v118
    v_and_b32 v120, 7, v118
    v_lshrrev_b32 v119, 2, v120
    v_lshlrev_b32 v119, 7, v119
    v_and_b32 v120, 3, v120
    v_lshlrev_b32 v120, 2, v120
    v_add_u32 v120, v120, v119
R_RW:
    global_load_dword v121, v120, s[88:89] sc1
    s_add_u32 s94, s94, 1
    s_cmp_gt_u32 s94, 200000
    s_cbranch_scc1 K_FAIL
    s_waitcnt vmcnt(0)
    s_mov_b32 s93, 0
    v_readlane_b32 s92, v121, 0
    s_nop 0
    s_add_u32 s93, s93, s92
    v_readlane_b32 s92, v121, 1
    s_nop 0
    s_add_u32 s93, s93, s92
    v_readlane_b32 s92, v121, 2
    s_nop 0
    s_add_u32 s93, s93, s92
    v_readlane_b32 s92, v121, 3
    s_nop 0
    s_add_u32 s93, s93, s92
    v_readlane_b32 s92, v121, 4
    s_nop 0
    s_add_u32 s93, s93, s92
    v_readlane_b32 s92, v121, 5
    s_nop 0
    s_add_u32 s93, s93, s92
    v_readlane_b32 s92, v121, 6
    s_nop 0
    s_add_u32 s93, s93, s92
    v_readlane_b32 s92, v121, 7
    s_nop 0
    s_add_u32 s93, s93, s92
    s_cmp_ge_u32 s93, 256
    s_cbranch_scc1 R_RWD
    s_sleep 2
    s_branch R_RW
R_RWD:
    v_cmp_ne_u32 vcc, 32, v121
    s_nop 0
    s_cmp_eq_u64 vcc, 0
    s_cselect_b32 s92, 0, 1
    v_mov_b32 v120, 30000
    v_mov_b32 v121, s92
    ds_write_b32 v120, v121
    s_waitcnt lgkmcnt(0)
R_RWB:
    s_barrier
    v_mov_b32 v120, 30000
    ds_read_b32 v121, v120
    s_waitcnt lgkmcnt(0)
    v_readfirstlane_b32 s92, v121
    s_nop 0
    s_and_b32 s92, s92, 1
    s_barrier
ROLE_R3:
    s_add_u32 s25, s29, 0
    buffer_load_dwordx4 v[104:107], v5, s[4:7], s25 offen offset:0 sc1
    buffer_load_dwordx4 v[104:107], v5, s[4:7], s25 offen offset:1024 sc1
    s_add_u32 s25, s29, 262144
    buffer_load_dwordx4 v[104:107], v5, s[4:7], s25 offen offset:0 sc1
    buffer_load_dwordx4 v[104:107], v5, s[4:7], s25 offen offset:1024 sc1
    s_add_u32 s25, s29, 524288
    buffer_load_dwordx4 v[104:107], v1, s[4:7], s25 offen offset:0 sc1
    buffer_load_dwordx4 v[104:107], v1, s[4:7], s25 offen offset:1024 sc1
    s_add_u32 s25, s29, 532480
    buffer_load_dwordx4 v[104:107], v1, s[4:7], s25 offen offset:0 sc1
    buffer_load_dwordx4 v[104:107], v1, s[4:7], s25 offen offset:1024 sc1
    s_add_u32 s25, s29, 540672
    buffer_load_dwordx4 v[104:107], v1, s[4:7], s25 offen offset:0 sc1
    buffer_load_dwordx4 v[104:107], v1, s[4:7], s25 offen offset:1024 sc1
    s_cmp_eq_u32 s92, 0
    s_cbranch_scc0 R_SAFE
    s_mov_b32 s17, 0
    s_mov_b32 s10, s29
    s_add_u32 s11, s10, 32768
    s_add_u32 s12, s29, 0x40000
    s_add_u32 s13, s29, 532480
    s_add_u32 s14, s29, 540672
    s_lshl_b32 s24, s36, 22
    s_add_u32 s74, s24, 16777216
    s_lshl_b32 s24, s8, 14
    s_add_u32 s74, s74, s24
    s_lshl_b32 s24, s36, 20
    s_add_u32 s75, s24, 25165824
    s_lshl_b32 s24, s8, 12
    s_add_u32 s75, s75, s24
    s_mov_b32 s15, s74
    s_mov_b32 s16, s75
    s_lshl_b32 s24, s36, 5
    s_add_u32 s24, s24, s8
    s_mul_i32 s25, s24, 256
    s_add_u32 s37, s25, 0
    s_mul_i32 s25, s24, 128
    s_add_u32 s19, s25, 32768
    s_mov_b32 s25, 0
    s_mov_b32 s18, s37
    s_mov_b32 s28, 0
kv0_117:
    v_bfe_u32 v18, v0, 4, 2
    v_lshlrev_b32 v18, 2, v18
    buffer_load_dword v19, v18, s[4:7], s18 offen sc1
    s_add_u32 s28, s28, 1
    s_cmp_gt_u32 s28, 200000
    s_cbranch_scc1 K_FAIL
    s_waitcnt vmcnt(0)
    v_cmp_ge_u32 vcc, s25, v19
    s_cbranch_vccnz kv0_117
    s_mov_b32 s27, 8192
    s_mov_b32 s30, 16384
    s_lshl_b32 s24, s9, 11
    s_add_u32 s24, s24, s27
    s_mov_b32 m0, s24
    s_nop 0
    buffer_load_dwordx4 v7, s[4:7], s15 offen offset:0 sc1 lds
    buffer_load_dwordx4 v7, s[4:7], s15 offen offset:1024 sc1 lds
    s_add_u32 s39, s15, 8192
    s_add_u32 s18, s37, 128
    s_mov_b32 s25, 0
    s_mov_b32 s28, 0
kv1_118:
    v_bfe_u32 v18, v0, 4, 2
    v_lshlrev_b32 v18, 2, v18
    buffer_load_dword v19, v18, s[4:7], s18 offen sc1
    s_add_u32 s28, s28, 1
    s_cmp_gt_u32 s28, 200000
    s_cbranch_scc1 K_FAIL
    s_waitcnt vmcnt(0)
    v_cmp_ge_u32 vcc, s25, v19
    s_cbranch_vccnz kv1_118
    s_load_dwordx2 s[32:33], s[0:1], 32
    s_mov_b32 s34, 8192
    s_mov_b32 s35, 0x20000
    v_lshrrev_b32 v24, 4, v0
    v_and_b32 v25, 15, v24
    v_lshrrev_b32 v27, 2, v25
    v_lshlrev_b32 v27, 1, v27
    v_and_b32 v28, 1, v25
    v_add_u32 v27, v27, v28
    v_bfe_u32 v28, v25, 1, 1
    v_lshlrev_b32 v25, 10, v27
    v_lshrrev_b32 v26, 4, v24
    v_lshlrev_b32 v26, 5, v26
    v_add_u32 v25, v25, v26
    v_lshlrev_b32 v26, 4, v28
    s_lshl_b32 s24, s9, 8
    v_add3_u32 v25, v25, v26, s24
    s_waitcnt lgkmcnt(0)
    buffer_load_dwordx4 v[120:123], v25, s[32:35], 0 offen
    buffer_load_dwordx4 v[124:127], v25, s[32:35], 0 offen offset:128
    v_mov_b64 v[56:57], 0
    v_mov_b64 v[58:59], 0
    v_mov_b64 v[60:61], 0
    v_mov_b64 v[62:63], 0
    v_mov_b64 v[64:65], 0
    v_mov_b64 v[66:67], 0
    v_mov_b64 v[68:69], 0
    v_mov_b64 v[70:71], 0
    v_mov_b64 v[72:73], 0
    v_mov_b64 v[74:75], 0
    v_mov_b64 v[76:77], 0
    v_mov_b64 v[78:79], 0
    s_waitcnt vmcnt(0)
    ds_write_b128 v7, v[120:123] offset:0
    ds_write_b128 v7, v[124:127] offset:1024
RF_STEP:
    buffer_load_dwordx4 v[112:115], v7, s[4:7], s39 offen offset:0 sc1
    buffer_load_dwordx4 v[116:119], v7, s[4:7], s39 offen offset:1024 sc1
    s_add_u32 s26, s17, 1
    s_lshr_b32 s25, s26, 1
    s_cmp_eq_u32 s17, 63
    s_cbranch_scc1 RF_NODMA
    v_cmp_ge_u32 vcc, s25, v19
    s_cbranch_vccnz RF_KVW
RF_KVOK:
    s_and_b32 s15, s26, 7
    s_lshl_b32 s15, s15, 19
    s_add_u32 s15, s15, s74
    s_lshl_b32 s24, s9, 11
    s_add_u32 s24, s24, s30
    s_mov_b32 m0, s24
    s_add_u32 s39, s15, 8192
    buffer_load_dwordx4 v7, s[4:7], s15 offen offset:0 sc1 lds
    buffer_load_dwordx4 v7, s[4:7], s15 offen offset:1024 sc1 lds
RF_NODMA:
    s_waitcnt lgkmcnt(0)
    s_barrier
    ds_read_b128 v[24:27], v0 offset:0
    ds_read_b128 v[28:31], v0 offset:1024
    ds_read_b128 v[32:35], v0 offset:2048
    ds_read_b128 v[36:39], v0 offset:3072
    ds_read_b128 v[40:43], v0 offset:4096
    ds_read_b128 v[44:47], v0 offset:5120
    ds_read_b128 v[48:51], v0 offset:6144
    ds_read_b128 v[52:55], v0 offset:7168
    v_add_u32 v17, s27, v8
    v_mov_b32 v18, s17
    s_cmp_eq_u32 s9, 0
    s_cselect_b64 exec, 1, 0
    buffer_store_dword v18, off, s[4:7], s19 sc1
    s_mov_b64 exec, -1
    s_add_u32 s26, s17, 2
    s_and_b32 s18, s26, 1
    s_mul_i32 s18, s18, 128
    s_add_u32 s18, s18, s37
    v_mov_b64 v[120:121], -1
    v_mov_b64 v[122:123], -1
    s_waitcnt lgkmcnt(7)
    v_smfmac_f32_16x16x64_bf16 v[56:59], v[24:27], a[0:7], v13
    v_smfmac_f32_16x16x64_bf16 v[60:63], v[24:27], a[64:71], v13
    s_waitcnt lgkmcnt(6)
    v_smfmac_f32_16x16x64_bf16 v[56:59], v[28:31], a[8:15], v13
    v_smfmac_f32_16x16x64_bf16 v[60:63], v[28:31], a[72:79], v13
    buffer_store_dwordx4 v[120:123], v5, s[4:7], s12 offen
    s_waitcnt lgkmcnt(5)
    v_smfmac_f32_16x16x64_bf16 v[56:59], v[32:35], a[16:23], v13
    v_smfmac_f32_16x16x64_bf16 v[60:63], v[32:35], a[80:87], v13
    buffer_store_dwordx4 v[120:123], v5, s[4:7], s12 offen offset:1024
    s_waitcnt lgkmcnt(4)
    v_smfmac_f32_16x16x64_bf16 v[56:59], v[36:39], a[24:31], v13
    v_smfmac_f32_16x16x64_bf16 v[60:63], v[36:39], a[88:95], v13
    s_mov_b64 exec, s[20:21]
    buffer_store_dword v120, v6, s[4:7], s14 offen
    s_mov_b64 exec, -1
    s_waitcnt lgkmcnt(0)
    v_smfmac_f32_16x16x64_bf16 v[56:59], v[40:43], a[32:39], v13
    ds_read_b128 v[80:83], v17 offset:0
    v_smfmac_f32_16x16x64_bf16 v[60:63], v[40:43], a[96:103], v13
    ds_read_b128 v[84:87], v17 offset:2048
    v_smfmac_f32_16x16x64_bf16 v[56:59], v[44:47], a[40:47], v13
    ds_read_b128 v[88:91], v17 offset:4096
    v_smfmac_f32_16x16x64_bf16 v[60:63], v[44:47], a[104:111], v13
    ds_read_b128 v[92:95], v17 offset:6144
    v_smfmac_f32_16x16x64_bf16 v[56:59], v[48:51], a[48:55], v13
    ds_read_b128 v[96:99], v17 offset:256
    v_smfmac_f32_16x16x64_bf16 v[60:63], v[48:51], a[112:119], v13
    ds_read_b128 v[100:103], v17 offset:2304
    v_smfmac_f32_16x16x64_bf16 v[56:59], v[52:55], a[56:63], v13
    ds_read_b128 v[104:107], v17 offset:4352
    v_smfmac_f32_16x16x64_bf16 v[60:63], v[52:55], a[120:127], v13
    ds_read_b128 v[108:111], v17 offset:6400
    v_smfmac_f32_16x16x64_bf16 v[64:67], v[24:27], a[128:135], v13
    v_bfe_u32 v18, v0, 4, 2
    v_smfmac_f32_16x16x64_bf16 v[68:71], v[24:27], a[192:199], v13
    v_lshlrev_b32 v18, 2, v18
    v_smfmac_f32_16x16x64_bf16 v[64:67], v[28:31], a[136:143], v13
    buffer_load_dword v19, v18, s[4:7], s18 offen sc1
    v_smfmac_f32_16x16x64_bf16 v[68:71], v[28:31], a[200:207], v13
    v_add_f32 v56, v56, v58
    v_smfmac_f32_16x16x64_bf16 v[64:67], v[32:35], a[144:151], v13
    v_add_f32 v57, v57, v59
    v_smfmac_f32_16x16x64_bf16 v[68:71], v[32:35], a[208:215], v13
    v_add_f32 v60, v60, v62
    v_smfmac_f32_16x16x64_bf16 v[64:67], v[36:39], a[152:159], v13
    v_add_f32 v61, v61, v63
    v_smfmac_f32_16x16x64_bf16 v[68:71], v[36:39], a[216:223], v13
    v_cvt_pk_bf16_f32 v56, v56, v57
    v_smfmac_f32_16x16x64_bf16 v[64:67], v[40:43], a[160:167], v13
    v_cvt_pk_bf16_f32 v60, v60, v61
    v_smfmac_f32_16x16x64_bf16 v[68:71], v[40:43], a[224:231], v13
    ds_write_b16 v9, v56 offset:24576
    v_smfmac_f32_16x16x64_bf16 v[64:67], v[44:47], a[168:175], v13
    ds_write_b16_d16_hi v9, v56 offset:24864
    v_smfmac_f32_16x16x64_bf16 v[68:71], v[44:47], a[232:239], v13
    ds_write_b16 v9, v60 offset:24608
    v_smfmac_f32_16x16x64_bf16 v[64:67], v[48:51], a[176:183], v13
    ds_write_b16_d16_hi v9, v60 offset:24896
    v_smfmac_f32_16x16x64_bf16 v[68:71], v[48:51], a[240:247], v13
    v_smfmac_f32_16x16x64_bf16 v[64:67], v[52:55], a[184:191], v13
    v_smfmac_f32_16x16x64_bf16 v[68:71], v[52:55], a[248:255], v13
    v_smfmac_f32_16x16x64_bf16 v[72:75], v[24:27], v[128:135], v13
    s_nop 0
    s_nop 0
    v_smfmac_f32_16x16x64_bf16 v[76:79], v[24:27], v[192:199], v13
    s_nop 0
    s_nop 0
    v_smfmac_f32_16x16x64_bf16 v[72:75], v[28:31], v[136:143], v13
    s_nop 0
    v_smfmac_f32_16x16x64_bf16 v[76:79], v[28:31], v[200:207], v13
    v_add_f32 v64, v64, v66
    v_add_f32 v65, v65, v67
    v_smfmac_f32_16x16x64_bf16 v[72:75], v[32:35], v[144:151], v13
    v_add_f32 v68, v68, v70
    v_add_f32 v69, v69, v71
    v_smfmac_f32_16x16x64_bf16 v[76:79], v[32:35], v[208:215], v13
    v_cvt_pk_bf16_f32 v64, v64, v65
    v_cvt_pk_bf16_f32 v68, v68, v69
    v_smfmac_f32_16x16x64_bf16 v[72:75], v[36:39], v[152:159], v13
    ds_write_b16 v9, v64 offset:26880
    ds_write_b16_d16_hi v9, v64 offset:27168
    v_smfmac_f32_16x16x64_bf16 v[76:79], v[36:39], v[216:223], v13
    ds_write_b16 v9, v68 offset:26912
    ds_write_b16_d16_hi v9, v68 offset:27200
    v_smfmac_f32_16x16x64_bf16 v[72:75], v[40:43], v[160:167], v13
    v_mov_b32 v65, v68
    v_smfmac_f32_16x16x64_bf16 v[76:79], v[40:43], v[224:231], v13
    s_nop 0
    v_permlane16_swap_b32 v64, v65
    v_smfmac_f32_16x16x64_bf16 v[72:75], v[44:47], v[168:175], v13
    buffer_store_dwordx2 v[64:65], v16, s[4:7], s16 offen sc1
    v_smfmac_f32_16x16x64_bf16 v[76:79], v[44:47], v[232:239], v13
    s_waitcnt lgkmcnt(0)
    s_barrier
    ds_read_b128 v[24:27], v10 offset:24576
    ds_read_b128 v[28:31], v10 offset:24640
    ds_read_b128 v[32:35], v10 offset:24704
    ds_read_b128 v[36:39], v10 offset:24768
    ds_read_b128 v[40:43], v15 offset:26880
    ds_read_b128 v[44:47], v15 offset:26944
    v_smfmac_f32_16x16x64_bf16 v[72:75], v[48:51], v[176:183], v13
    v_smfmac_f32_16x16x64_bf16 v[76:79], v[48:51], v[240:247], v13
    v_smfmac_f32_16x16x64_bf16 v[72:75], v[52:55], v[184:191], v13
    v_smfmac_f32_16x16x64_bf16 v[76:79], v[52:55], v[248:255], v13
    ds_read_b128 v[48:51], v15 offset:27008
    ds_read_b128 v[52:55], v15 offset:27072
    s_cmp_eq_u32 s17, 63
    s_nop 1
    s_cbranch_scc1 RF_LAST
    s_waitcnt lgkmcnt(7)
    v_mfma_f32_16x16x32_bf16 v[60:63], v[80:83], v[24:27], 0
    v_mfma_f32_16x16x32_bf16 v[64:67], v[96:99], v[24:27], 0
    s_waitcnt lgkmcnt(6)
    v_mfma_f32_16x16x32_bf16 v[60:63], v[84:87], v[28:31], v[60:63]
    v_add_f32 v72, v72, v74
    v_mfma_f32_16x16x32_bf16 v[64:67], v[100:103], v[28:31], v[64:67]
    v_add_f32 v73, v73, v75
    s_waitcnt lgkmcnt(5)
    v_mfma_f32_16x16x32_bf16 v[60:63], v[88:91], v[32:35], v[60:63]
    v_add_f32 v76, v76, v78
    v_mfma_f32_16x16x32_bf16 v[64:67], v[104:107], v[32:35], v[64:67]
    v_add_f32 v77, v77, v79
    s_waitcnt lgkmcnt(4)
    v_mfma_f32_16x16x32_bf16 v[60:63], v[92:95], v[36:39], v[60:63]
    v_cvt_pk_bf16_f32 v72, v72, v73
    v_mfma_f32_16x16x32_bf16 v[64:67], v[108:111], v[36:39], v[64:67]
    v_cvt_pk_bf16_f32 v76, v76, v77
    s_waitcnt lgkmcnt(3)
    v_mfma_f32_16x16x32_bf16 v[56:59], v[40:43], v[24:27], 0
    v_mov_b32 v74, v72
    s_waitcnt lgkmcnt(2)
    v_mfma_f32_16x16x32_bf16 v[56:59], v[44:47], v[28:31], v[56:59]
    v_mov_b32 v75, v76
    s_waitcnt lgkmcnt(1)
    v_mfma_f32_16x16x32_bf16 v[56:59], v[48:51], v[32:35], v[56:59]
    v_mov_b32 v73, 0
    s_waitcnt lgkmcnt(0)
    v_mfma_f32_16x16x32_bf16 v[56:59], v[52:55], v[36:39], v[56:59]
    v_mov_b32 v77, 0
    v_permlane16_swap_b32 v74, v75
    v_max3_f32 v68, v60, v61, v62
    buffer_store_dwordx2 v[74:75], v16, s[4:7], s16 offen offset:2048 sc1
    v_max3_f32 v69, v63, v64, v65
    ds_read_b128 v[80:83], v2 offset:0
    v_max_f32 v70, v66, v67
    ds_read_b128 v[84:87], v2 offset:1024
    v_max3_f32 v68, v68, v69, v70
    ds_read_b128 v[88:91], v2 offset:2048
    v_max3_f32 v68, v68, v56, v57
    v_mov_b32 v69, v68
    ds_read_b128 v[92:95], v2 offset:3072
    ds_read_b128 v[96:99], v2 offset:4096
    v_permlane16_swap_b32 v68, v69
    v_max_f32 v68, v68, v69
    v_mov_b32 v69, v68
    ds_read_b128 v[100:103], v2 offset:5120
    ds_read_b128 v[104:107], v2 offset:6144
    v_permlane32_swap_b32 v68, v69
    v_max_f32 v68, v68, v69
    v_mul_f32 v68, s23, v68
    v_fma_f32 v60, v60, s22, v68
    v_fma_f32 v61, v61, s22, v68
    v_fma_f32 v62, v62, s22, v68
    v_fma_f32 v63, v63, s22, v68
    v_fma_f32 v64, v64, s22, v68
    v_fma_f32 v65, v65, s22, v68
    v_fma_f32 v66, v66, s22, v68
    v_fma_f32 v67, v67, s22, v68
    v_fma_f32 v56, v56, s22, v68
    v_fma_f32 v57, v57, s22, v68
    v_exp_f32 v60, v60
    ds_read_b128 v[108:111], v2 offset:7168
    v_exp_f32 v61, v61
    ds_read_b128 v[24:27], v3 offset:0
    v_exp_f32 v62, v62
    ds_read_b128 v[28:31], v3 offset:1024
    v_exp_f32 v63, v63
    ds_read_b128 v[32:35], v3 offset:2048
    v_exp_f32 v64, v64
    ds_read_b128 v[36:39], v3 offset:3072
    v_exp_f32 v65, v65
    ds_read_b128 v[40:43], v3 offset:4096
    v_exp_f32 v66, v66
    ds_read_b128 v[44:47], v3 offset:5120
    v_exp_f32 v67, v67
    v_exp_f32 v56, v56
    v_exp_f32 v57, v57
    v_mov_b32 v125, 0
    v_cvt_pk_bf16_f32 v120, v60, v61
    v_cvt_pk_bf16_f32 v121, v62, v63
    v_cvt_pk_bf16_f32 v122, v64, v65
    v_cvt_pk_bf16_f32 v123, v66, v67
    v_cvt_pk_bf16_f32 v124, v56, v57
    s_waitcnt vmcnt(9)
    v_mfma_f32_16x16x32_bf16 v[48:51], v[112:115], v[120:123], 0
    v_add_f32 v68, v56, v57
    v_mfma_f32_16x16x32_bf16 v[52:55], v[116:119], v[120:123], 0
    v_add_f32 v70, v60, v61
    v_mfma_f32_16x16x16_bf16 v[48:51], v[72:73], v[124:125], v[48:51]
    v_add_f32 v71, v62, v63
    v_mfma_f32_16x16x16_bf16 v[52:55], v[76:77], v[124:125], v[52:55]
    v_add_f32 v69, v64, v65
    v_add_f32 v68, v68, v70
    v_add_f32 v70, v66, v67
    v_add_f32 v71, v71, v69
    v_add_f32 v68, v68, v70
    v_add_f32 v68, v68, v71
    v_mov_b32 v69, v68
    v_mov_b64 v[56:57], 0
    v_mov_b64 v[58:59], 0
    v_permlane16_swap_b32 v68, v69
    v_add_f32 v68, v68, v69
    v_mov_b32 v69, v68
    v_mov_b64 v[60:61], 0
    v_mov_b64 v[62:63], 0
    v_permlane32_swap_b32 v68, v69
    v_add_f32 v68, v68, v69
    v_rcp_f32 v68, v68
    s_nop 0
    v_mul_f32 v48, v48, v68
    v_mul_f32 v49, v49, v68
    v_mul_f32 v50, v50, v68
    v_mul_f32 v51, v51, v68
    v_cvt_pk_bf16_f32 v64, v48, v49
    v_cvt_pk_bf16_f32 v65, v50, v51
    s_waitcnt lgkmcnt(6)
    ds_write_b64 v11, v[64:65] offset:0
    v_mul_f32 v52, v52, v68
    v_mul_f32 v53, v53, v68
    v_mul_f32 v54, v54, v68
    v_mul_f32 v55, v55, v68
    v_cvt_pk_bf16_f32 v66, v52, v53
    v_cvt_pk_bf16_f32 v67, v54, v55
    ds_write_b64 v11, v[66:67] offset:32
    s_cmp_lt_u32 s17, 2
    s_cbranch_scc1 RF_EFR
RF_EFRB:
    s_waitcnt lgkmcnt(0)
    s_barrier
    ds_read_b128 v[120:123], v12 offset:0
    ds_read_b128 v[124:127], v12 offset:128
    v_mov_b64 v[64:65], 0
    v_mov_b64 v[66:67], 0
    v_mov_b64 v[68:69], 0
    v_mov_b64 v[70:71], 0
    s_waitcnt lgkmcnt(1)
    v_smfmac_f32_16x16x64_bf16 v[56:59], v[120:123], v[80:87], v13
    ds_read_b128 v[80:83], v3 offset:6144
    ds_read_b128 v[84:87], v3 offset:7168
    v_mov_b64 v[48:49], 0
    v_smfmac_f32_16x16x64_bf16 v[60:63], v[120:123], v[88:95], v13
    ds_read_b128 v[88:91], v2 offset:8192
    ds_read_b128 v[92:95], v2 offset:9216
    v_mov_b64 v[50:51], 0
    v_smfmac_f32_16x16x64_bf16 v[64:67], v[120:123], v[96:103], v13
    ds_read_b128 v[96:99], v2 offset:10240
    ds_read_b128 v[100:103], v2 offset:11264
    v_mov_b64 v[52:53], 0
    v_smfmac_f32_16x16x64_bf16 v[68:71], v[120:123], v[104:111], v13
    ds_read_b128 v[104:107], v2 offset:12288
    ds_read_b128 v[108:111], v2 offset:13312
    v_mov_b64 v[54:55], 0
    s_waitcnt lgkmcnt(8)
    v_smfmac_f32_16x16x64_bf16 v[56:59], v[124:127], v[24:31], v13
    ds_read_b128 v[24:27], v2 offset:14336
    ds_read_b128 v[28:31], v2 offset:15360
    v_mov_b64 v[112:113], 0
    v_smfmac_f32_16x16x64_bf16 v[60:63], v[124:127], v[32:39], v13
    ds_read_b128 v[32:35], v3 offset:8192
    ds_read_b128 v[36:39], v3 offset:9216
    v_mov_b64 v[114:115], 0
    v_smfmac_f32_16x16x64_bf16 v[64:67], v[124:127], v[40:47], v13
    ds_read_b128 v[40:43], v3 offset:10240
    ds_read_b128 v[44:47], v3 offset:11264
    v_mov_b64 v[116:117], 0
    s_waitcnt lgkmcnt(12)
    v_smfmac_f32_16x16x64_bf16 v[68:71], v[124:127], v[80:87], v13
    ds_read_b128 v[80:83], v3 offset:12288
    ds_read_b128 v[84:87], v3 offset:13312
    v_mov_b64 v[118:119], 0
    s_waitcnt lgkmcnt(12)
    v_smfmac_f32_16x16x64_bf16 v[48:51], v[120:123], v[88:95], v13
    ds_read_b128 v[88:91], v3 offset:14336
    ds_read_b128 v[92:95], v3 offset:15360
    s_waitcnt lgkmcnt(12)
    v_smfmac_f32_16x16x64_bf16 v[52:55], v[120:123], v[96:103], v13
    v_add_f32 v56, v56, v58
    v_add_f32 v57, v57, v59
    v_add_f32 v60, v60, v62
    v_add_f32 v61, v61, v63
    s_waitcnt lgkmcnt(10)
    v_smfmac_f32_16x16x64_bf16 v[112:115], v[120:123], v[104:111], v13
    v_add_f32 v64, v64, v66
    v_add_f32 v65, v65, v67
    v_add_f32 v68, v68, v70
    v_add_f32 v69, v69, v71
    s_waitcnt lgkmcnt(8)
    v_smfmac_f32_16x16x64_bf16 v[116:119], v[120:123], v[24:31], v13
    v_cvt_pk_bf16_f32 v72, v56, v57
    v_cvt_pk_bf16_f32 v73, v60, v61
    v_cvt_pk_bf16_f32 v74, v64, v65
    v_cvt_pk_bf16_f32 v75, v68, v69
    s_waitcnt lgkmcnt(6)
    v_smfmac_f32_16x16x64_bf16 v[48:51], v[124:127], v[32:39], v13
    v_permlane32_swap_b32 v72, v74
    v_permlane32_swap_b32 v73, v75
    s_nop 1
    v_permlane16_swap_b32 v72, v73
    v_permlane16_swap_b32 v74, v75
    s_waitcnt lgkmcnt(4)
    v_smfmac_f32_16x16x64_bf16 v[52:55], v[124:127], v[40:47], v13
    buffer_store_dwordx4 v[72:75], v4, s[4:7], s10 offen
    s_waitcnt lgkmcnt(2)
    v_smfmac_f32_16x16x64_bf16 v[112:115], v[124:127], v[80:87], v13
    s_waitcnt lgkmcnt(0)
    v_smfmac_f32_16x16x64_bf16 v[116:119], v[124:127], v[88:95], v13
    v_add_f32 v48, v48, v50
    v_add_f32 v49, v49, v51
    s_nop 0
    v_add_f32 v52, v52, v54
    v_add_f32 v53, v53, v55
    v_cvt_pk_bf16_f32 v76, v48, v49
    v_cvt_pk_bf16_f32 v77, v52, v53
    v_add_f32 v112, v112, v114
    v_add_f32 v113, v113, v115
    v_add_f32 v116, v116, v118
    v_add_f32 v117, v117, v119
    v_cvt_pk_bf16_f32 v78, v112, v113
    v_cvt_pk_bf16_f32 v79, v116, v117
    s_nop 0
    v_permlane32_swap_b32 v76, v78
    v_permlane32_swap_b32 v77, v79
    s_nop 1
    v_permlane16_swap_b32 v76, v77
    v_permlane16_swap_b32 v78, v79
    buffer_store_dwordx4 v[76:79], v4, s[4:7], s11 offen
    s_mov_b32 s28, 0
    v_mov_b64 v[56:57], 0
    v_mov_b64 v[58:59], 0
    v_mov_b64 v[60:61], 0
    v_mov_b64 v[62:63], 0
    v_mov_b64 v[64:65], 0
    v_mov_b64 v[66:67], 0
    v_mov_b64 v[68:69], 0
    v_mov_b64 v[70:71], 0
    v_mov_b64 v[72:73], 0
    v_mov_b64 v[74:75], 0
    v_mov_b64 v[76:77], 0
    v_mov_b64 v[78:79], 0
    s_waitcnt vmcnt(0)
RF_P1:
    buffer_load_dwordx4 v[24:27], v5, s[4:7], s10 offen sc1
    buffer_load_dwordx4 v[28:31], v5, s[4:7], s10 offen offset:1024 sc1
    s_add_u32 s28, s28, 1
    s_cmp_gt_u32 s28, 200000
    s_cbranch_scc1 K_FAIL
    s_waitcnt vmcnt(0)
    v_mfma_f32_16x16x32_bf16 v[32:35], v[24:27], v[20:23], 0
    v_mfma_f32_16x16x32_bf16 v[32:35], v[28:31], v[20:23], v[32:35]
    v_max3_u32 v17, v24, v25, v26
    v_max3_u32 v18, v27, v28, v29
    v_max3_u32 v17, v17, v30, v31
    v_max_u32 v17, v17, v18
    v_cmp_eq_u32 vcc, -1, v17
    s_cbranch_vccnz RF_P1
    s_nop 1
    v_add_f32 v32, v32, v33
    v_add_f32 v34, v34, v35
    v_add_f32 v32, v32, v34
    v_mov_b32 v33, v32
    s_nop 1
    v_permlane16_swap_b32 v32, v33
    v_cvt_pk_bf16_f32 v32, v32, v33
    s_mov_b64 exec, s[20:21]
    buffer_store_dword v32, v6, s[4:7], s13 offen
    s_mov_b64 exec, -1
    s_mov_b32 s12, s10
    s_xor_b32 s10, s10, 0x40000
    s_add_u32 s11, s10, 32768
    s_add_u32 s25, s29, 548864
    s_add_u32 s14, s14, 0x2000
    s_cmp_ge_u32 s14, s25
    s_cselect_b32 s24, 0x6000, 0
    s_sub_u32 s14, s14, s24
    s_mov_b32 s26, s13
    s_add_u32 s13, s13, 0x2000
    s_cmp_ge_u32 s13, s25
    s_cselect_b32 s24, 0x6000, 0
    s_sub_u32 s13, s13, s24
    s_add_u32 s16, s17, 1
    s_and_b32 s16, s16, 7
    s_lshl_b32 s16, s16, 17
    s_add_u32 s16, s16, s75
    s_mov_b32 s24, s27
    s_mov_b32 s27, s30
    s_mov_b32 s30, s24
    s_mov_b32 s28, 0
    s_waitcnt vmcnt(0)
RF_P2:
    buffer_load_dwordx4 v[120:123], v1, s[4:7], s26 offen sc1
    buffer_load_dwordx4 v[124:127], v1, s[4:7], s26 offen offset:1024 sc1
    s_add_u32 s28, s28, 1
    s_cmp_gt_u32 s28, 200000
    s_cbranch_scc1 K_FAIL
    s_waitcnt vmcnt(0)
    v_max3_u32 v17, v120, v121, v122
    v_max3_u32 v18, v123, v124, v125
    v_max3_u32 v17, v17, v126, v127
    v_max_u32 v17, v17, v18
    v_cmp_eq_u32 vcc, -1, v17
    s_cbranch_vccnz RF_P2
    ds_write_b128 v7, v[120:123] offset:0
    ds_write_b128 v7, v[124:127] offset:1024
    s_add_u32 s17, s17, 1
    s_branch RF_STEP
RF_KVW:
    s_and_b32 s18, s26, 1
    s_mul_i32 s18, s18, 128
    s_add_u32 s18, s18, s37
    s_mov_b32 s28, 0
kvw_119:
    v_bfe_u32 v18, v0, 4, 2
    v_lshlrev_b32 v18, 2, v18
    buffer_load_dword v19, v18, s[4:7], s18 offen sc1
    s_add_u32 s28, s28, 1
    s_cmp_gt_u32 s28, 200000
    s_cbranch_scc1 K_FAIL
    s_waitcnt vmcnt(0)
    v_cmp_ge_u32 vcc, s25, v19
    s_cbranch_vccnz kvw_119
    s_branch RF_KVOK
RF_EFR:
    s_waitcnt vmcnt(0) lgkmcnt(0)
    s_barrier
    s_add_u32 s24, s17, 1
    v_mov_b32 v18, s24
    s_cmp_eq_u32 s9, 0
    s_cselect_b64 exec, 1, 0
    buffer_store_dword v18, off, s[4:7], s19 sc1
    s_mov_b64 exec, -1
    s_branch RF_EFRB
RF_LAST:
    s_waitcnt lgkmcnt(0)
    v_add_f32 v72, v72, v74
    v_add_f32 v73, v73, v75
    v_add_f32 v76, v76, v78
    v_add_f32 v77, v77, v79
    v_cvt_pk_bf16_f32 v72, v72, v73
    v_cvt_pk_bf16_f32 v76, v76, v77
    v_mov_b32 v74, v72
    v_mov_b32 v75, v76
    s_nop 1
    v_permlane16_swap_b32 v74, v75
    buffer_store_dwordx2 v[74:75], v16, s[4:7], s16 offen offset:2048 sc1
    s_waitcnt vmcnt(0)
    s_barrier
    v_mov_b32 v19, 64
    s_cmp_lg_u32 s9, 0
    s_cbranch_scc1 K_DONE
    buffer_store_dword v19, off, s[4:7], s19 sc1
    s_waitcnt vmcnt(0)
    s_branch K_DONE
R_SAFE:
    s_mov_b32 s17, 0
    s_mov_b32 s10, s29
    s_add_u32 s11, s10, 32768
    s_add_u32 s12, s29, 0x40000
    s_add_u32 s13, s29, 532480
    s_add_u32 s14, s29, 540672
    s_lshl_b32 s24, s36, 22
    s_add_u32 s74, s24, 16777216
    s_lshl_b32 s24, s8, 14
    s_add_u32 s74, s74, s24
    s_lshl_b32 s24, s36, 20
    s_add_u32 s75, s24, 25165824
    s_lshl_b32 s24, s8, 12
    s_add_u32 s75, s75, s24
    s_mov_b32 s15, s74
    s_mov_b32 s16, s75
    s_lshl_b32 s24, s36, 5
    s_add_u32 s24, s24, s8
    s_mul_i32 s25, s24, 256
    s_add_u32 s37, s25, 0
    s_mul_i32 s25, s24, 128
    s_add_u32 s19, s25, 32768
    s_mov_b32 s25, 0
    s_mov_b32 s18, s37
    s_mov_b32 s28, 0
kv0_120:
    v_bfe_u32 v18, v0, 4, 2
    v_lshlrev_b32 v18, 2, v18
    buffer_load_dword v19, v18, s[4:7], s18 offen sc1
    s_add_u32 s28, s28, 1
    s_cmp_gt_u32 s28, 200000
    s_cbranch_scc1 K_FAIL
    s_waitcnt vmcnt(0)
    v_cmp_ge_u32 vcc, s25, v19
    s_cbranch_vccnz kv0_120
    s_mov_b32 s27, 8192
    s_mov_b32 s30, 16384
    s_lshl_b32 s24, s9, 11
    s_add_u32 s24, s24, s27
    s_mov_b32 m0, s24
    s_nop 0
    buffer_load_dwordx4 v7, s[4:7], s15 offen offset:0 sc1 lds
    buffer_load_dwordx4 v7, s[4:7], s15 offen offset:1024 sc1 lds
    s_add_u32 s39, s15, 8192
    s_add_u32 s18, s37, 128
    s_mov_b32 s25, 0
    s_mov_b32 s28, 0
kv1_121:
    v_bfe_u32 v18, v0, 4, 2
    v_lshlrev_b32 v18, 2, v18
    buffer_load_dword v19, v18, s[4:7], s18 offen sc1
    s_add_u32 s28, s28, 1
    s_cmp_gt_u32 s28, 200000
    s_cbranch_scc1 K_FAIL
    s_waitcnt vmcnt(0)
    v_cmp_ge_u32 vcc, s25, v19
    s_cbranch_vccnz kv1_121
    s_load_dwordx2 s[32:33], s[0:1], 32
    s_mov_b32 s34, 8192
    s_mov_b32 s35, 0x20000
    v_lshrrev_b32 v24, 4, v0
    v_and_b32 v25, 15, v24
    v_lshrrev_b32 v27, 2, v25
    v_lshlrev_b32 v27, 1, v27
    v_and_b32 v28, 1, v25
    v_add_u32 v27, v27, v28
    v_bfe_u32 v28, v25, 1, 1
    v_lshlrev_b32 v25, 10, v27
    v_lshrrev_b32 v26, 4, v24
    v_lshlrev_b32 v26, 5, v26
    v_add_u32 v25, v25, v26
    v_lshlrev_b32 v26, 4, v28
    s_lshl_b32 s24, s9, 8
    v_add3_u32 v25, v25, v26, s24
    s_waitcnt lgkmcnt(0)
    buffer_load_dwordx4 v[120:123], v25, s[32:35], 0 offen
    buffer_load_dwordx4 v[124:127], v25, s[32:35], 0 offen offset:128
    v_mov_b64 v[56:57], 0
    v_mov_b64 v[58:59], 0
    v_mov_b64 v[60:61], 0
    v_mov_b64 v[62:63], 0
    v_mov_b64 v[64:65], 0
    v_mov_b64 v[66:67], 0
    v_mov_b64 v[68:69], 0
    v_mov_b64 v[70:71], 0
    v_mov_b64 v[72:73], 0
    v_mov_b64 v[74:75], 0
    v_mov_b64 v[76:77], 0
    v_mov_b64 v[78:79], 0
    s_waitcnt vmcnt(0)
    ds_write_b128 v7, v[120:123] offset:0
    ds_write_b128 v7, v[124:127] offset:1024
RS_STEP:
    buffer_load_dwordx4 v[112:115], v7, s[4:7], s39 offen offset:0 sc1
    buffer_load_dwordx4 v[116:119], v7, s[4:7], s39 offen offset:1024 sc1
    s_add_u32 s26, s17, 1
    s_lshr_b32 s25, s26, 1
    s_cmp_eq_u32 s17, 63
    s_cbranch_scc1 RS_NODMA
    v_cmp_ge_u32 vcc, s25, v19
    s_cbranch_vccnz RS_KVW
RS_KVOK:
    s_and_b32 s15, s26, 7
    s_lshl_b32 s15, s15, 19
    s_add_u32 s15, s15, s74
    s_lshl_b32 s24, s9, 11
    s_add_u32 s24, s24, s30
    s_mov_b32 m0, s24
    s_add_u32 s39, s15, 8192
    buffer_load_dwordx4 v7, s[4:7], s15 offen offset:0 sc1 lds
    buffer_load_dwordx4 v7, s[4:7], s15 offen offset:1024 sc1 lds
RS_NODMA:
    s_waitcnt lgkmcnt(0)
    s_barrier
    ds_read_b128 v[24:27], v0 offset:0
    ds_read_b128 v[28:31], v0 offset:1024
    ds_read_b128 v[32:35], v0 offset:2048
    ds_read_b128 v[36:39], v0 offset:3072
    ds_read_b128 v[40:43], v0 offset:4096
    ds_read_b128 v[44:47], v0 offset:5120
    ds_read_b128 v[48:51], v0 offset:6144
    ds_read_b128 v[52:55], v0 offset:7168
    v_add_u32 v17, s27, v8
    v_mov_b32 v18, s17
    s_cmp_eq_u32 s9, 0
    s_cselect_b64 exec, 1, 0
    buffer_store_dword v18, off, s[4:7], s19 sc1
    s_mov_b64 exec, -1
    s_add_u32 s26, s17, 2
    s_and_b32 s18, s26, 1
    s_mul_i32 s18, s18, 128
    s_add_u32 s18, s18, s37
    v_mov_b64 v[120:121], -1
    v_mov_b64 v[122:123], -1
    s_waitcnt lgkmcnt(7)
    v_smfmac_f32_16x16x64_bf16 v[56:59], v[24:27], a[0:7], v13
    v_smfmac_f32_16x16x64_bf16 v[60:63], v[24:27], a[64:71], v13
    s_waitcnt lgkmcnt(6)
    v_smfmac_f32_16x16x64_bf16 v[56:59], v[28:31], a[8:15], v13
    v_smfmac_f32_16x16x64_bf16 v[60:63], v[28:31], a[72:79], v13
    buffer_store_dwordx4 v[120:123], v5, s[4:7], s12 offen sc1
    s_waitcnt lgkmcnt(5)
    v_smfmac_f32_16x16x64_bf16 v[56:59], v[32:35], a[16:23], v13
    v_smfmac_f32_16x16x64_bf16 v[60:63], v[32:35], a[80:87], v13
    buffer_store_dwordx4 v[120:123], v5, s[4:7], s12 offen offset:1024 sc1
    s_waitcnt lgkmcnt(4)
    v_smfmac_f32_16x16x64_bf16 v[56:59], v[36:39], a[24:31], v13
    v_smfmac_f32_16x16x64_bf16 v[60:63], v[36:39], a[88:95], v13
    s_mov_b64 exec, s[20:21]
    buffer_store_dword v120, v6, s[4:7], s14 offen sc1
    s_mov_b64 exec, -1
    s_waitcnt lgkmcnt(0)
    v_smfmac_f32_16x16x64_bf16 v[56:59], v[40:43], a[32:39], v13
    ds_read_b128 v[80:83], v17 offset:0
    v_smfmac_f32_16x16x64_bf16 v[60:63], v[40:43], a[96:103], v13
    ds_read_b128 v[84:87], v17 offset:2048
    v_smfmac_f32_16x16x64_bf16 v[56:59], v[44:47], a[40:47], v13
    ds_read_b128 v[88:91], v17 offset:4096
    v_smfmac_f32_16x16x64_bf16 v[60:63], v[44:47], a[104:111], v13
    ds_read_b128 v[92:95], v17 offset:6144
    v_smfmac_f32_16x16x64_bf16 v[56:59], v[48:51], a[48:55], v13
    ds_read_b128 v[96:99], v17 offset:256
    v_smfmac_f32_16x16x64_bf16 v[60:63], v[48:51], a[112:119], v13
    ds_read_b128 v[100:103], v17 offset:2304
    v_smfmac_f32_16x16x64_bf16 v[56:59], v[52:55], a[56:63], v13
    ds_read_b128 v[104:107], v17 offset:4352
    v_smfmac_f32_16x16x64_bf16 v[60:63], v[52:55], a[120:127], v13
    ds_read_b128 v[108:111], v17 offset:6400
    v_smfmac_f32_16x16x64_bf16 v[64:67], v[24:27], a[128:135], v13
    v_bfe_u32 v18, v0, 4, 2
    v_smfmac_f32_16x16x64_bf16 v[68:71], v[24:27], a[192:199], v13
    v_lshlrev_b32 v18, 2, v18
    v_smfmac_f32_16x16x64_bf16 v[64:67], v[28:31], a[136:143], v13
    buffer_load_dword v19, v18, s[4:7], s18 offen sc1
    v_smfmac_f32_16x16x64_bf16 v[68:71], v[28:31], a[200:207], v13
    v_add_f32 v56, v56, v58
    v_smfmac_f32_16x16x64_bf16 v[64:67], v[32:35], a[144:151], v13
    v_add_f32 v57, v57, v59
    v_smfmac_f32_16x16x64_bf16 v[68:71], v[32:35], a[208:215], v13
    v_add_f32 v60, v60, v62
    v_smfmac_f32_16x16x64_bf16 v[64:67], v[36:39], a[152:159], v13
    v_add_f32 v61, v61, v63
    v_smfmac_f32_16x16x64_bf16 v[68:71], v[36:39], a[216:223], v13
    v_cvt_pk_bf16_f32 v56, v56, v57
    v_smfmac_f32_16x16x64_bf16 v[64:67], v[40:43], a[160:167], v13
    v_cvt_pk_bf16_f32 v60, v60, v61
    v_smfmac_f32_16x16x64_bf16 v[68:71], v[40:43], a[224:231], v13
    ds_write_b16 v9, v56 offset:24576
    v_smfmac_f32_16x16x64_bf16 v[64:67], v[44:47], a[168:175], v13
    ds_write_b16_d16_hi v9, v56 offset:24864
    v_smfmac_f32_16x16x64_bf16 v[68:71], v[44:47], a[232:239], v13
    ds_write_b16 v9, v60 offset:24608
    v_smfmac_f32_16x16x64_bf16 v[64:67], v[48:51], a[176:183], v13
    ds_write_b16_d16_hi v9, v60 offset:24896
    v_smfmac_f32_16x16x64_bf16 v[68:71], v[48:51], a[240:247], v13
    v_smfmac_f32_16x16x64_bf16 v[64:67], v[52:55], a[184:191], v13
    v_smfmac_f32_16x16x64_bf16 v[68:71], v[52:55], a[248:255], v13
    v_smfmac_f32_16x16x64_bf16 v[72:75], v[24:27], v[128:135], v13
    s_nop 0
    s_nop 0
    v_smfmac_f32_16x16x64_bf16 v[76:79], v[24:27], v[192:199], v13
    s_nop 0
    s_nop 0
    v_smfmac_f32_16x16x64_bf16 v[72:75], v[28:31], v[136:143], v13
    s_nop 0
    v_smfmac_f32_16x16x64_bf16 v[76:79], v[28:31], v[200:207], v13
    v_add_f32 v64, v64, v66
    v_add_f32 v65, v65, v67
    v_smfmac_f32_16x16x64_bf16 v[72:75], v[32:35], v[144:151], v13
    v_add_f32 v68, v68, v70
    v_add_f32 v69, v69, v71
    v_smfmac_f32_16x16x64_bf16 v[76:79], v[32:35], v[208:215], v13
    v_cvt_pk_bf16_f32 v64, v64, v65
    v_cvt_pk_bf16_f32 v68, v68, v69
    v_smfmac_f32_16x16x64_bf16 v[72:75], v[36:39], v[152:159], v13
    ds_write_b16 v9, v64 offset:26880
    ds_write_b16_d16_hi v9, v64 offset:27168
    v_smfmac_f32_16x16x64_bf16 v[76:79], v[36:39], v[216:223], v13
    ds_write_b16 v9, v68 offset:26912
    ds_write_b16_d16_hi v9, v68 offset:27200
    v_smfmac_f32_16x16x64_bf16 v[72:75], v[40:43], v[160:167], v13
    v_mov_b32 v65, v68
    v_smfmac_f32_16x16x64_bf16 v[76:79], v[40:43], v[224:231], v13
    s_nop 0
    v_permlane16_swap_b32 v64, v65
    v_smfmac_f32_16x16x64_bf16 v[72:75], v[44:47], v[168:175], v13
    buffer_store_dwordx2 v[64:65], v16, s[4:7], s16 offen sc1
    v_smfmac_f32_16x16x64_bf16 v[76:79], v[44:47], v[232:239], v13
    s_waitcnt lgkmcnt(0)
    s_barrier
    ds_read_b128 v[24:27], v10 offset:24576
    ds_read_b128 v[28:31], v10 offset:24640
    ds_read_b128 v[32:35], v10 offset:24704
    ds_read_b128 v[36:39], v10 offset:24768
    ds_read_b128 v[40:43], v15 offset:26880
    ds_read_b128 v[44:47], v15 offset:26944
    v_smfmac_f32_16x16x64_bf16 v[72:75], v[48:51], v[176:183], v13
    v_smfmac_f32_16x16x64_bf16 v[76:79], v[48:51], v[240:247], v13
    v_smfmac_f32_16x16x64_bf16 v[72:75], v[52:55], v[184:191], v13
    v_smfmac_f32_16x16x64_bf16 v[76:79], v[52:55], v[248:255], v13
    ds_read_b128 v[48:51], v15 offset:27008
    ds_read_b128 v[52:55], v15 offset:27072
    s_cmp_eq_u32 s17, 63
    s_nop 1
    s_cbranch_scc1 RS_LAST
    s_waitcnt lgkmcnt(7)
    v_mfma_f32_16x16x32_bf16 v[60:63], v[80:83], v[24:27], 0
    v_mfma_f32_16x16x32_bf16 v[64:67], v[96:99], v[24:27], 0
    s_waitcnt lgkmcnt(6)
    v_mfma_f32_16x16x32_bf16 v[60:63], v[84:87], v[28:31], v[60:63]
    v_add_f32 v72, v72, v74
    v_mfma_f32_16x16x32_bf16 v[64:67], v[100:103], v[28:31], v[64:67]
    v_add_f32 v73, v73, v75
    s_waitcnt lgkmcnt(5)
    v_mfma_f32_16x16x32_bf16 v[60:63], v[88:91], v[32:35], v[60:63]
    v_add_f32 v76, v76, v78
    v_mfma_f32_16x16x32_bf16 v[64:67], v[104:107], v[32:35], v[64:67]
    v_add_f32 v77, v77, v79
    s_waitcnt lgkmcnt(4)
    v_mfma_f32_16x16x32_bf16 v[60:63], v[92:95], v[36:39], v[60:63]
    v_cvt_pk_bf16_f32 v72, v72, v73
    v_mfma_f32_16x16x32_bf16 v[64:67], v[108:111], v[36:39], v[64:67]
    v_cvt_pk_bf16_f32 v76, v76, v77
    s_waitcnt lgkmcnt(3)
    v_mfma_f32_16x16x32_bf16 v[56:59], v[40:43], v[24:27], 0
    v_mov_b32 v74, v72
    s_waitcnt lgkmcnt(2)
    v_mfma_f32_16x16x32_bf16 v[56:59], v[44:47], v[28:31], v[56:59]
    v_mov_b32 v75, v76
    s_waitcnt lgkmcnt(1)
    v_mfma_f32_16x16x32_bf16 v[56:59], v[48:51], v[32:35], v[56:59]
    v_mov_b32 v73, 0
    s_waitcnt lgkmcnt(0)
    v_mfma_f32_16x16x32_bf16 v[56:59], v[52:55], v[36:39], v[56:59]
    v_mov_b32 v77, 0
    v_permlane16_swap_b32 v74, v75
    v_max3_f32 v68, v60, v61, v62
    buffer_store_dwordx2 v[74:75], v16, s[4:7], s16 offen offset:2048 sc1
    v_max3_f32 v69, v63, v64, v65
    ds_read_b128 v[80:83], v2 offset:0
    v_max_f32 v70, v66, v67
    ds_read_b128 v[84:87], v2 offset:1024
    v_max3_f32 v68, v68, v69, v70
    ds_read_b128 v[88:91], v2 offset:2048
    v_max3_f32 v68, v68, v56, v57
    v_mov_b32 v69, v68
    ds_read_b128 v[92:95], v2 offset:3072
    ds_read_b128 v[96:99], v2 offset:4096
    v_permlane16_swap_b32 v68, v69
    v_max_f32 v68, v68, v69
    v_mov_b32 v69, v68
    ds_read_b128 v[100:103], v2 offset:5120
    ds_read_b128 v[104:107], v2 offset:6144
    v_permlane32_swap_b32 v68, v69
    v_max_f32 v68, v68, v69
    v_mul_f32 v68, s23, v68
    v_fma_f32 v60, v60, s22, v68
    v_fma_f32 v61, v61, s22, v68
    v_fma_f32 v62, v62, s22, v68
    v_fma_f32 v63, v63, s22, v68
    v_fma_f32 v64, v64, s22, v68
    v_fma_f32 v65, v65, s22, v68
    v_fma_f32 v66, v66, s22, v68
    v_fma_f32 v67, v67, s22, v68
    v_fma_f32 v56, v56, s22, v68
    v_fma_f32 v57, v57, s22, v68
    v_exp_f32 v60, v60
    ds_read_b128 v[108:111], v2 offset:7168
    v_exp_f32 v61, v61
    ds_read_b128 v[24:27], v3 offset:0
    v_exp_f32 v62, v62
    ds_read_b128 v[28:31], v3 offset:1024
    v_exp_f32 v63, v63
    ds_read_b128 v[32:35], v3 offset:2048
    v_exp_f32 v64, v64
    ds_read_b128 v[36:39], v3 offset:3072
    v_exp_f32 v65, v65
    ds_read_b128 v[40:43], v3 offset:4096
    v_exp_f32 v66, v66
    ds_read_b128 v[44:47], v3 offset:5120
    v_exp_f32 v67, v67
    v_exp_f32 v56, v56
    v_exp_f32 v57, v57
    v_mov_b32 v125, 0
    v_cvt_pk_bf16_f32 v120, v60, v61
    v_cvt_pk_bf16_f32 v121, v62, v63
    v_cvt_pk_bf16_f32 v122, v64, v65
    v_cvt_pk_bf16_f32 v123, v66, v67
    v_cvt_pk_bf16_f32 v124, v56, v57
    s_waitcnt vmcnt(9)
    v_mfma_f32_16x16x32_bf16 v[48:51], v[112:115], v[120:123], 0
    v_add_f32 v68, v56, v57
    v_mfma_f32_16x16x32_bf16 v[52:55], v[116:119], v[120:123], 0
    v_add_f32 v70, v60, v61
    v_mfma_f32_16x16x16_bf16 v[48:51], v[72:73], v[124:125], v[48:51]
    v_add_f32 v71, v62, v63
    v_mfma_f32_16x16x16_bf16 v[52:55], v[76:77], v[124:125], v[52:55]
    v_add_f32 v69, v64, v65
    v_add_f32 v68, v68, v70
    v_add_f32 v70, v66, v67
    v_add_f32 v71, v71, v69
    v_add_f32 v68, v68, v70
    v_add_f32 v68, v68, v71
    v_mov_b32 v69, v68
    v_mov_b64 v[56:57], 0
    v_mov_b64 v[58:59], 0
    v_permlane16_swap_b32 v68, v69
    v_add_f32 v68, v68, v69
    v_mov_b32 v69, v68
    v_mov_b64 v[60:61], 0
    v_mov_b64 v[62:63], 0
    v_permlane32_swap_b32 v68, v69
    v_add_f32 v68, v68, v69
    v_rcp_f32 v68, v68
    s_nop 0
    v_mul_f32 v48, v48, v68
    v_mul_f32 v49, v49, v68
    v_mul_f32 v50, v50, v68
    v_mul_f32 v51, v51, v68
    v_cvt_pk_bf16_f32 v64, v48, v49
    v_cvt_pk_bf16_f32 v65, v50, v51
    s_waitcnt lgkmcnt(6)
    ds_write_b64 v11, v[64:65] offset:0
    v_mul_f32 v52, v52, v68
    v_mul_f32 v53, v53, v68
    v_mul_f32 v54, v54, v68
    v_mul_f32 v55, v55, v68
    v_cvt_pk_bf16_f32 v66, v52, v53
    v_cvt_pk_bf16_f32 v67, v54, v55
    ds_write_b64 v11, v[66:67] offset:32
    s_cmp_lt_u32 s17, 2
    s_cbranch_scc1 RS_EFR
RS_EFRB:
    s_waitcnt lgkmcnt(0)
    s_barrier
    ds_read_b128 v[120:123], v12 offset:0
    ds_read_b128 v[124:127], v12 offset:128
    v_mov_b64 v[64:65], 0
    v_mov_b64 v[66:67], 0
    v_mov_b64 v[68:69], 0
    v_mov_b64 v[70:71], 0
    s_waitcnt lgkmcnt(1)
    v_smfmac_f32_16x16x64_bf16 v[56:59], v[120:123], v[80:87], v13
    ds_read_b128 v[80:83], v3 offset:6144
    ds_read_b128 v[84:87], v3 offset:7168
    v_mov_b64 v[48:49], 0
    v_smfmac_f32_16x16x64_bf16 v[60:63], v[120:123], v[88:95], v13
    ds_read_b128 v[88:91], v2 offset:8192
    ds_read_b128 v[92:95], v2 offset:9216
    v_mov_b64 v[50:51], 0
    v_smfmac_f32_16x16x64_bf16 v[64:67], v[120:123], v[96:103], v13
    ds_read_b128 v[96:99], v2 offset:10240
    ds_read_b128 v[100:103], v2 offset:11264
    v_mov_b64 v[52:53], 0
    v_smfmac_f32_16x16x64_bf16 v[68:71], v[120:123], v[104:111], v13
    ds_read_b128 v[104:107], v2 offset:12288
    ds_read_b128 v[108:111], v2 offset:13312
    v_mov_b64 v[54:55], 0
    s_waitcnt lgkmcnt(8)
    v_smfmac_f32_16x16x64_bf16 v[56:59], v[124:127], v[24:31], v13
    ds_read_b128 v[24:27], v2 offset:14336
    ds_read_b128 v[28:31], v2 offset:15360
    v_mov_b64 v[112:113], 0
    v_smfmac_f32_16x16x64_bf16 v[60:63], v[124:127], v[32:39], v13
    ds_read_b128 v[32:35], v3 offset:8192
    ds_read_b128 v[36:39], v3 offset:9216
    v_mov_b64 v[114:115], 0
    v_smfmac_f32_16x16x64_bf16 v[64:67], v[124:127], v[40:47], v13
    ds_read_b128 v[40:43], v3 offset:10240
    ds_read_b128 v[44:47], v3 offset:11264
    v_mov_b64 v[116:117], 0
    s_waitcnt lgkmcnt(12)
    v_smfmac_f32_16x16x64_bf16 v[68:71], v[124:127], v[80:87], v13
    ds_read_b128 v[80:83], v3 offset:12288
    ds_read_b128 v[84:87], v3 offset:13312
    v_mov_b64 v[118:119], 0
    s_waitcnt lgkmcnt(12)
    v_smfmac_f32_16x16x64_bf16 v[48:51], v[120:123], v[88:95], v13
    ds_read_b128 v[88:91], v3 offset:14336
    ds_read_b128 v[92:95], v3 offset:15360
    s_waitcnt lgkmcnt(12)
    v_smfmac_f32_16x16x64_bf16 v[52:55], v[120:123], v[96:103], v13
    v_add_f32 v56, v56, v58
    v_add_f32 v57, v57, v59
    v_add_f32 v60, v60, v62
    v_add_f32 v61, v61, v63
    s_waitcnt lgkmcnt(10)
    v_smfmac_f32_16x16x64_bf16 v[112:115], v[120:123], v[104:111], v13
    v_add_f32 v64, v64, v66
    v_add_f32 v65, v65, v67
    v_add_f32 v68, v68, v70
    v_add_f32 v69, v69, v71
    s_waitcnt lgkmcnt(8)
    v_smfmac_f32_16x16x64_bf16 v[116:119], v[120:123], v[24:31], v13
    v_cvt_pk_bf16_f32 v72, v56, v57
    v_cvt_pk_bf16_f32 v73, v60, v61
    v_cvt_pk_bf16_f32 v74, v64, v65
    v_cvt_pk_bf16_f32 v75, v68, v69
    s_waitcnt lgkmcnt(6)
    v_smfmac_f32_16x16x64_bf16 v[48:51], v[124:127], v[32:39], v13
    v_permlane32_swap_b32 v72, v74
    v_permlane32_swap_b32 v73, v75
    s_nop 1
    v_permlane16_swap_b32 v72, v73
    v_permlane16_swap_b32 v74, v75
    s_waitcnt lgkmcnt(4)
    v_smfmac_f32_16x16x64_bf16 v[52:55], v[124:127], v[40:47], v13
    buffer_store_dwordx4 v[72:75], v4, s[4:7], s10 offen sc1
    s_waitcnt lgkmcnt(2)
    v_smfmac_f32_16x16x64_bf16 v[112:115], v[124:127], v[80:87], v13
    s_waitcnt lgkmcnt(0)
    v_smfmac_f32_16x16x64_bf16 v[116:119], v[124:127], v[88:95], v13
    v_add_f32 v48, v48, v50
    v_add_f32 v49, v49, v51
    s_nop 0
    v_add_f32 v52, v52, v54
    v_add_f32 v53, v53, v55
    v_cvt_pk_bf16_f32 v76, v48, v49
    v_cvt_pk_bf16_f32 v77, v52, v53
    v_add_f32 v112, v112, v114
    v_add_f32 v113, v113, v115
    v_add_f32 v116, v116, v118
    v_add_f32 v117, v117, v119
    v_cvt_pk_bf16_f32 v78, v112, v113
    v_cvt_pk_bf16_f32 v79, v116, v117
    s_nop 0
    v_permlane32_swap_b32 v76, v78
    v_permlane32_swap_b32 v77, v79
    s_nop 1
    v_permlane16_swap_b32 v76, v77
    v_permlane16_swap_b32 v78, v79
    buffer_store_dwordx4 v[76:79], v4, s[4:7], s11 offen sc1
    s_mov_b32 s28, 0
    v_mov_b64 v[56:57], 0
    v_mov_b64 v[58:59], 0
    v_mov_b64 v[60:61], 0
    v_mov_b64 v[62:63], 0
    v_mov_b64 v[64:65], 0
    v_mov_b64 v[66:67], 0
    v_mov_b64 v[68:69], 0
    v_mov_b64 v[70:71], 0
    v_mov_b64 v[72:73], 0
    v_mov_b64 v[74:75], 0
    v_mov_b64 v[76:77], 0
    v_mov_b64 v[78:79], 0
    s_waitcnt vmcnt(0)
RS_P1:
    buffer_load_dwordx4 v[24:27], v5, s[4:7], s10 offen sc1
    buffer_load_dwordx4 v[28:31], v5, s[4:7], s10 offen offset:1024 sc1
    s_add_u32 s28, s28, 1
    s_cmp_gt_u32 s28, 200000
    s_cbranch_scc1 K_FAIL
    s_waitcnt vmcnt(0)
    v_mfma_f32_16x16x32_bf16 v[32:35], v[24:27], v[20:23], 0
    v_mfma_f32_16x16x32_bf16 v[32:35], v[28:31], v[20:23], v[32:35]
    v_max3_u32 v17, v24, v25, v26
    v_max3_u32 v18, v27, v28, v29
    v_max3_u32 v17, v17, v30, v31
    v_max_u32 v17, v17, v18
    v_cmp_eq_u32 vcc, -1, v17
    s_cbranch_vccnz RS_P1
    s_nop 1
    v_add_f32 v32, v32, v33
    v_add_f32 v34, v34, v35
    v_add_f32 v32, v32, v34
    v_mov_b32 v33, v32
    s_nop 1
    v_permlane16_swap_b32 v32, v33
    v_cvt_pk_bf16_f32 v32, v32, v33
    s_mov_b64 exec, s[20:21]
    buffer_store_dword v32, v6, s[4:7], s13 offen sc1
    s_mov_b64 exec, -1
    s_mov_b32 s12, s10
    s_xor_b32 s10, s10, 0x40000
    s_add_u32 s11, s10, 32768
    s_add_u32 s25, s29, 548864
    s_add_u32 s14, s14, 0x2000
    s_cmp_ge_u32 s14, s25
    s_cselect_b32 s24, 0x6000, 0
    s_sub_u32 s14, s14, s24
    s_mov_b32 s26, s13
    s_add_u32 s13, s13, 0x2000
    s_cmp_ge_u32 s13, s25
    s_cselect_b32 s24, 0x6000, 0
    s_sub_u32 s13, s13, s24
    s_add_u32 s16, s17, 1
    s_and_b32 s16, s16, 7
    s_lshl_b32 s16, s16, 17
    s_add_u32 s16, s16, s75
    s_mov_b32 s24, s27
    s_mov_b32 s27, s30
    s_mov_b32 s30, s24
    s_mov_b32 s28, 0
    s_waitcnt vmcnt(0)
RS_P2:
    buffer_load_dwordx4 v[120:123], v1, s[4:7], s26 offen sc1
    buffer_load_dwordx4 v[124:127], v1, s[4:7], s26 offen offset:1024 sc1
    s_add_u32 s28, s28, 1
    s_cmp_gt_u32 s28, 200000
    s_cbranch_scc1 K_FAIL
    s_waitcnt vmcnt(0)
    v_max3_u32 v17, v120, v121, v122
    v_max3_u32 v18, v123, v124, v125
    v_max3_u32 v17, v17, v126, v127
    v_max_u32 v17, v17, v18
    v_cmp_eq_u32 vcc, -1, v17
    s_cbranch_vccnz RS_P2
    ds_write_b128 v7, v[120:123] offset:0
    ds_write_b128 v7, v[124:127] offset:1024
    s_add_u32 s17, s17, 1
    s_branch RS_STEP
RS_KVW:
    s_and_b32 s18, s26, 1
    s_mul_i32 s18, s18, 128
    s_add_u32 s18, s18, s37
    s_mov_b32 s28, 0
kvw_122:
    v_bfe_u32 v18, v0, 4, 2
    v_lshlrev_b32 v18, 2, v18
    buffer_load_dword v19, v18, s[4:7], s18 offen sc1
    s_add_u32 s28, s28, 1
    s_cmp_gt_u32 s28, 200000
    s_cbranch_scc1 K_FAIL
    s_waitcnt vmcnt(0)
    v_cmp_ge_u32 vcc, s25, v19
    s_cbranch_vccnz kvw_122
    s_branch RS_KVOK
RS_EFR:
    s_waitcnt vmcnt(0) lgkmcnt(0)
    s_barrier
    s_add_u32 s24, s17, 1
    v_mov_b32 v18, s24
    s_cmp_eq_u32 s9, 0
    s_cselect_b64 exec, 1, 0
    buffer_store_dword v18, off, s[4:7], s19 sc1
    s_mov_b64 exec, -1
    s_branch RS_EFRB
RS_LAST:
    s_waitcnt lgkmcnt(0)
    v_add_f32 v72, v72, v74
    v_add_f32 v73, v73, v75
    v_add_f32 v76, v76, v78
    v_add_f32 v77, v77, v79
    v_cvt_pk_bf16_f32 v72, v72, v73
    v_cvt_pk_bf16_f32 v76, v76, v77
    v_mov_b32 v74, v72
    v_mov_b32 v75, v76
    s_nop 1
    v_permlane16_swap_b32 v74, v75
    buffer_store_dwordx2 v[74:75], v16, s[4:7], s16 offen offset:2048 sc1
    s_waitcnt vmcnt(0)
    s_barrier
    v_mov_b32 v19, 64
    s_cmp_lg_u32 s9, 0
    s_cbranch_scc1 K_DONE
    buffer_store_dword v19, off, s[4:7], s19 sc1
    s_waitcnt vmcnt(0)
    s_branch K_DONE
ROLE_O:
    s_lshr_b32 s36, s91, 4
    s_bfe_u32 s8, s91, 0x30001
    s_and_b32 s10, s91, 1
    s_load_dwordx2 s[4:5], s[0:1], 96
    v_lshrrev_b32 v8, 6, v0
    v_and_b32 v9, 63, v0
    v_readfirstlane_b32 s9, v8
    s_mov_b32 s6, 268435456
    s_mov_b32 s7, 0x20000
    v_lshlrev_b32 v0, 4, v9
    s_lshl_b32 s20, s9, 13
    v_add_u32 v1, s20, v0
    s_lshl_b32 s20, s10, 2
    s_add_u32 s20, s20, s9
    s_lshl_b32 s20, s20, 12
    v_add_u32 v2, s20, v0
    v_bfe_u32 v10, v9, 2, 2
    v_mul_u32_u24 v10, 256, v10
    v_and_b32 v11, 3, v9
    v_lshlrev_b32 v11, 2, v11
    v_add_u32 v3, v10, v11
    v_and_b32 v11, 3, v9
    v_lshlrev_b32 v11, 2, v11
    s_cmp_eq_u32 s36, 0
    s_cselect_b32 s21, 0, -1
    v_and_b32 v11, s21, v11
    s_lshl_b32 s20, s10, 2
    s_add_u32 s20, s20, s9
    s_lshl_b32 s20, s20, 7
    v_add_u32 v5, s20, v11
    s_waitcnt lgkmcnt(0)
    v_lshrrev_b32 v10, 5, v9
    s_lshl_b32 s20, s9, 1
    v_add_u32 v10, s20, v10
    v_and_b32 v11, 3, v10
    v_lshlrev_b32 v11, 2, v11
    v_and_b32 v12, 31, v9
    v_xor_b32 v11, v11, v12
    v_lshlrev_b32 v11, 4, v11
    v_lshlrev_b32 v10, 10, v10
    s_lshl_b32 s20, s10, 9
    v_add3_u32 v48, v10, v11, s20
    v_lshrrev_b32 v10, 4, v9
    v_and_b32 v11, 15, v9
    v_lshrrev_b32 v11, 2, v11
    v_lshrrev_b32 v12, 1, v10
    v_lshlrev_b32 v12, 3, v12
    v_add_u32 v12, v12, v11
    v_lshlrev_b32 v12, 9, v12
    v_and_b32 v13, 1, v10
    v_lshlrev_b32 v13, 5, v13
    v_add_u32 v12, v12, v13
    v_and_b32 v13, 3, v9
    v_lshlrev_b32 v13, 3, v13
    v_add_u32 v12, v12, v13
    s_lshl_b32 s20, s9, 1
    s_add_u32 s20, s20, 0
    v_xor_b32 v13, s20, v11
    v_lshlrev_b32 v13, 6, v13
    v_add_u32 v49, v12, v13
    s_lshl_b32 s20, s9, 1
    s_add_u32 s20, s20, 1
    v_xor_b32 v13, s20, v11
    v_lshlrev_b32 v13, 6, v13
    v_add_u32 v50, v12, v13
    v_add_u32 v52, 0x10000, v49
    v_add_u32 v53, 0x10000, v50
    s_load_dwordx2 s[32:33], s[0:1], 64
    s_mov_b32 s34, 4194304
    s_mov_b32 s35, 0x20000
    s_lshl_b32 s20, s9, 10
    s_lshl_b32 s21, s8, 19
    s_add_u32 s21, s21, 0
    s_mov_b32 s24, 0
    s_waitcnt lgkmcnt(0)
    s_barrier
owdma_123:
    s_mov_b32 m0, s20
    s_add_u32 s20, s20, 4096
    buffer_load_dwordx4 v48, s[32:35], s21 offen  lds
    s_add_u32 s21, s21, 8192
    s_add_u32 s24, s24, 1
    s_cmp_lt_u32 s24, 32
    s_cbranch_scc1 owdma_123
    s_waitcnt vmcnt(0)
    s_barrier
    ds_read_b64_tr_b16 a[0:1], v49 offset:0
    ds_read_b64_tr_b16 a[2:3], v49 offset:2048
    ds_read_b64_tr_b16 a[4:5], v49 offset:8192
    ds_read_b64_tr_b16 a[6:7], v49 offset:10240
    ds_read_b64_tr_b16 a[8:9], v49 offset:16384
    ds_read_b64_tr_b16 a[10:11], v49 offset:18432
    ds_read_b64_tr_b16 a[12:13], v49 offset:24576
    ds_read_b64_tr_b16 a[14:15], v49 offset:26624
    s_waitcnt lgkmcnt(4)
    ds_read_b64_tr_b16 a[16:17], v49 offset:32768
    ds_read_b64_tr_b16 a[18:19], v49 offset:34816
    ds_read_b64_tr_b16 a[20:21], v49 offset:40960
    ds_read_b64_tr_b16 a[22:23], v49 offset:43008
    ds_read_b64_tr_b16 a[24:25], v49 offset:49152
    ds_read_b64_tr_b16 a[26:27], v49 offset:51200
    ds_read_b64_tr_b16 a[28:29], v49 offset:57344
    ds_read_b64_tr_b16 a[30:31], v49 offset:59392
    s_waitcnt lgkmcnt(4)
    ds_read_b64_tr_b16 a[32:33], v52 offset:0
    ds_read_b64_tr_b16 a[34:35], v52 offset:2048
    ds_read_b64_tr_b16 a[36:37], v52 offset:8192
    ds_read_b64_tr_b16 a[38:39], v52 offset:10240
    ds_read_b64_tr_b16 a[40:41], v52 offset:16384
    ds_read_b64_tr_b16 a[42:43], v52 offset:18432
    ds_read_b64_tr_b16 a[44:45], v52 offset:24576
    ds_read_b64_tr_b16 a[46:47], v52 offset:26624
    s_waitcnt lgkmcnt(4)
    ds_read_b64_tr_b16 a[48:49], v52 offset:32768
    ds_read_b64_tr_b16 a[50:51], v52 offset:34816
    ds_read_b64_tr_b16 a[52:53], v52 offset:40960
    ds_read_b64_tr_b16 a[54:55], v52 offset:43008
    ds_read_b64_tr_b16 a[56:57], v52 offset:49152
    ds_read_b64_tr_b16 a[58:59], v52 offset:51200
    ds_read_b64_tr_b16 a[60:61], v52 offset:57344
    ds_read_b64_tr_b16 a[62:63], v52 offset:59392
    s_waitcnt lgkmcnt(4)
    ds_read_b64_tr_b16 a[128:129], v50 offset:0
    ds_read_b64_tr_b16 a[130:131], v50 offset:2048
    ds_read_b64_tr_b16 a[132:133], v50 offset:8192
    ds_read_b64_tr_b16 a[134:135], v50 offset:10240
    ds_read_b64_tr_b16 a[136:137], v50 offset:16384
    ds_read_b64_tr_b16 a[138:139], v50 offset:18432
    ds_read_b64_tr_b16 a[140:141], v50 offset:24576
    ds_read_b64_tr_b16 a[142:143], v50 offset:26624
    s_waitcnt lgkmcnt(4)
    ds_read_b64_tr_b16 a[144:145], v50 offset:32768
    ds_read_b64_tr_b16 a[146:147], v50 offset:34816
    ds_read_b64_tr_b16 a[148:149], v50 offset:40960
    ds_read_b64_tr_b16 a[150:151], v50 offset:43008
    ds_read_b64_tr_b16 a[152:153], v50 offset:49152
    ds_read_b64_tr_b16 a[154:155], v50 offset:51200
    ds_read_b64_tr_b16 a[156:157], v50 offset:57344
    ds_read_b64_tr_b16 a[158:159], v50 offset:59392
    s_waitcnt lgkmcnt(4)
    ds_read_b64_tr_b16 a[160:161], v53 offset:0
    ds_read_b64_tr_b16 a[162:163], v53 offset:2048
    ds_read_b64_tr_b16 a[164:165], v53 offset:8192
    ds_read_b64_tr_b16 a[166:167], v53 offset:10240
    ds_read_b64_tr_b16 a[168:169], v53 offset:16384
    ds_read_b64_tr_b16 a[170:171], v53 offset:18432
    ds_read_b64_tr_b16 a[172:173], v53 offset:24576
    ds_read_b64_tr_b16 a[174:175], v53 offset:26624
    s_waitcnt lgkmcnt(4)
    ds_read_b64_tr_b16 a[176:177], v53 offset:32768
    ds_read_b64_tr_b16 a[178:179], v53 offset:34816
    ds_read_b64_tr_b16 a[180:181], v53 offset:40960
    ds_read_b64_tr_b16 a[182:183], v53 offset:43008
    ds_read_b64_tr_b16 a[184:185], v53 offset:49152
    ds_read_b64_tr_b16 a[186:187], v53 offset:51200
    ds_read_b64_tr_b16 a[188:189], v53 offset:57344
    ds_read_b64_tr_b16 a[190:191], v53 offset:59392
    s_waitcnt lgkmcnt(4)
    s_waitcnt lgkmcnt(0)
    s_lshl_b32 s20, s9, 10
    s_lshl_b32 s21, s8, 19
    s_add_u32 s21, s21, 262144
    s_mov_b32 s24, 0
    s_waitcnt lgkmcnt(0)
    s_barrier
owdma_124:
    s_mov_b32 m0, s20
    s_add_u32 s20, s20, 4096
    buffer_load_dwordx4 v48, s[32:35], s21 offen  lds
    s_add_u32 s21, s21, 8192
    s_add_u32 s24, s24, 1
    s_cmp_lt_u32 s24, 32
    s_cbranch_scc1 owdma_124
    s_waitcnt vmcnt(0)
    s_barrier
    ds_read_b64_tr_b16 a[64:65], v49 offset:0
    ds_read_b64_tr_b16 a[66:67], v49 offset:2048
    ds_read_b64_tr_b16 a[68:69], v49 offset:8192
    ds_read_b64_tr_b16 a[70:71], v49 offset:10240
    ds_read_b64_tr_b16 a[72:73], v49 offset:16384
    ds_read_b64_tr_b16 a[74:75], v49 offset:18432
    ds_read_b64_tr_b16 a[76:77], v49 offset:24576
    ds_read_b64_tr_b16 a[78:79], v49 offset:26624
    s_waitcnt lgkmcnt(4)
    ds_read_b64_tr_b16 a[80:81], v49 offset:32768
    ds_read_b64_tr_b16 a[82:83], v49 offset:34816
    ds_read_b64_tr_b16 a[84:85], v49 offset:40960
    ds_read_b64_tr_b16 a[86:87], v49 offset:43008
    ds_read_b64_tr_b16 a[88:89], v49 offset:49152
    ds_read_b64_tr_b16 a[90:91], v49 offset:51200
    ds_read_b64_tr_b16 a[92:93], v49 offset:57344
    ds_read_b64_tr_b16 a[94:95], v49 offset:59392
    s_waitcnt lgkmcnt(4)
    ds_read_b64_tr_b16 a[96:97], v52 offset:0
    ds_read_b64_tr_b16 a[98:99], v52 offset:2048
    ds_read_b64_tr_b16 a[100:101], v52 offset:8192
    ds_read_b64_tr_b16 a[102:103], v52 offset:10240
    ds_read_b64_tr_b16 a[104:105], v52 offset:16384
    ds_read_b64_tr_b16 a[106:107], v52 offset:18432
    ds_read_b64_tr_b16 a[108:109], v52 offset:24576
    ds_read_b64_tr_b16 a[110:111], v52 offset:26624
    s_waitcnt lgkmcnt(4)
    ds_read_b64_tr_b16 a[112:113], v52 offset:32768
    ds_read_b64_tr_b16 a[114:115], v52 offset:34816
    ds_read_b64_tr_b16 a[116:117], v52 offset:40960
    ds_read_b64_tr_b16 a[118:119], v52 offset:43008
    ds_read_b64_tr_b16 a[120:121], v52 offset:49152
    ds_read_b64_tr_b16 a[122:123], v52 offset:51200
    ds_read_b64_tr_b16 a[124:125], v52 offset:57344
    ds_read_b64_tr_b16 a[126:127], v52 offset:59392
    s_waitcnt lgkmcnt(4)
    ds_read_b64_tr_b16 a[192:193], v50 offset:0
    ds_read_b64_tr_b16 a[194:195], v50 offset:2048
    ds_read_b64_tr_b16 a[196:197], v50 offset:8192
    ds_read_b64_tr_b16 a[198:199], v50 offset:10240
    ds_read_b64_tr_b16 a[200:201], v50 offset:16384
    ds_read_b64_tr_b16 a[202:203], v50 offset:18432
    ds_read_b64_tr_b16 a[204:205], v50 offset:24576
    ds_read_b64_tr_b16 a[206:207], v50 offset:26624
    s_waitcnt lgkmcnt(4)
    ds_read_b64_tr_b16 a[208:209], v50 offset:32768
    ds_read_b64_tr_b16 a[210:211], v50 offset:34816
    ds_read_b64_tr_b16 a[212:213], v50 offset:40960
    ds_read_b64_tr_b16 a[214:215], v50 offset:43008
    ds_read_b64_tr_b16 a[216:217], v50 offset:49152
    ds_read_b64_tr_b16 a[218:219], v50 offset:51200
    ds_read_b64_tr_b16 a[220:221], v50 offset:57344
    ds_read_b64_tr_b16 a[222:223], v50 offset:59392
    s_waitcnt lgkmcnt(4)
    ds_read_b64_tr_b16 a[224:225], v53 offset:0
    ds_read_b64_tr_b16 a[226:227], v53 offset:2048
    ds_read_b64_tr_b16 a[228:229], v53 offset:8192
    ds_read_b64_tr_b16 a[230:231], v53 offset:10240
    ds_read_b64_tr_b16 a[232:233], v53 offset:16384
    ds_read_b64_tr_b16 a[234:235], v53 offset:18432
    ds_read_b64_tr_b16 a[236:237], v53 offset:24576
    ds_read_b64_tr_b16 a[238:239], v53 offset:26624
    s_waitcnt lgkmcnt(4)
    ds_read_b64_tr_b16 a[240:241], v53 offset:32768
    ds_read_b64_tr_b16 a[242:243], v53 offset:34816
    ds_read_b64_tr_b16 a[244:245], v53 offset:40960
    ds_read_b64_tr_b16 a[246:247], v53 offset:43008
    ds_read_b64_tr_b16 a[248:249], v53 offset:49152
    ds_read_b64_tr_b16 a[250:251], v53 offset:51200
    ds_read_b64_tr_b16 a[252:253], v53 offset:57344
    ds_read_b64_tr_b16 a[254:255], v53 offset:59392
    s_waitcnt lgkmcnt(4)
    s_waitcnt lgkmcnt(0)
    s_barrier
    s_lshl_b32 s20, s36, 5
    s_lshl_b32 s21, s8, 2
    s_add_u32 s21, s21, s20
    s_mul_i32 s14, s21, 256
    s_add_u32 s14, s14, 16384
    s_lshl_b32 s20, s36, 4
    s_lshl_b32 s21, s8, 1
    s_add_u32 s21, s21, s10
    s_add_u32 s21, s21, s20
    s_mul_i32 s15, s21, 128
    s_lshl_b32 s20, s9, 2
    s_add_u32 s15, s15, s20
    s_add_u32 s15, s15, 40960
    s_cmp_eq_u32 s36, 0
    s_mov_b32 s20, 45056
    s_cselect_b32 s27, 49152, s20
    s_mov_b32 s11, 0
    s_mov_b32 s25, -1
    s_lshl_b32 s20, s36, 21
    s_lshl_b32 s21, s8, 15
    s_add_u32 s28, s20, s21
    s_add_u32 s28, s28, 27262976
    s_add_u32 s29, s20, s21
    s_add_u32 s29, s29, 31457280
O_SEG:
    s_cmp_ge_i32 s25, s11
    s_cbranch_scc1 O_PFD
    s_waitcnt vmcnt(0)
    v_mov_b32 v10, s11
    buffer_store_dword v10, off, s[4:7], s15 sc1
    s_and_b32 s26, s11, 1
    s_mul_i32 s26, s26, 128
    s_add_u32 s26, s26, s14
    s_lshr_b32 s23, s11, 1
    s_mov_b32 s24, 0
ow_125:
    buffer_load_dword v8, v3, s[4:7], s26 offen sc1
    s_add_u32 s24, s24, 1
    s_cmp_gt_u32 s24, 200000
    s_cbranch_scc1 K_FAIL
    s_waitcnt vmcnt(0)
    v_cmp_ge_u32 vcc, s23, v8
    s_cbranch_vccz owok_126
    s_sleep 1
    s_branch ow_125
owok_126:
    s_and_b32 s12, s11, 7
    s_lshl_b32 s12, s12, 18
    s_add_u32 s12, s12, s28
    s_and_b32 s20, s11, 1
    s_lshl_b32 s20, s20, 15
    s_lshl_b32 s21, s9, 13
    s_add_u32 s20, s20, s21
    s_mov_b32 m0, s20
    s_nop 0
    buffer_load_dwordx4 v1, s[4:7], s12 offen offset:0 sc1 lds
    buffer_load_dwordx4 v1, s[4:7], s12 offen offset:1024 sc1 lds
    buffer_load_dwordx4 v1, s[4:7], s12 offen offset:2048 sc1 lds
    buffer_load_dwordx4 v1, s[4:7], s12 offen offset:3072 sc1 lds
    s_add_u32 s20, s20, 4096
    s_mov_b32 m0, s20
    s_add_u32 s21, s12, 4096
    buffer_load_dwordx4 v1, s[4:7], s21 offen offset:0 sc1 lds
    buffer_load_dwordx4 v1, s[4:7], s21 offen offset:1024 sc1 lds
    buffer_load_dwordx4 v1, s[4:7], s21 offen offset:2048 sc1 lds
    buffer_load_dwordx4 v1, s[4:7], s21 offen offset:3072 sc1 lds
    s_mov_b32 s25, s11
    s_waitcnt vmcnt(0)
    s_branch O_HAVE
O_PFD:
    s_waitcnt vmcnt(4)
O_HAVE:
    s_and_b32 s20, s11, 1
    s_lshl_b32 s20, s20, 15
    v_add_u32 v4, s20, v0
    s_barrier
    ds_read_b128 v[48:51], v4 offset:0
    ds_read_b128 v[52:55], v4 offset:1024
    ds_read_b128 v[56:59], v4 offset:2048
    s_add_u32 s22, s11, 1
    s_and_b32 s26, s22, 1
    s_mul_i32 s26, s26, 128
    s_add_u32 s26, s26, s14
    s_lshr_b32 s23, s22, 1
    s_and_b32 s13, s11, 7
    s_lshl_b32 s13, s13, 18
    s_add_u32 s13, s13, s29
    s_and_b32 s30, s11, 3
    s_lshl_b32 s30, s30, 10
    s_add_u32 s30, s30, s27
    s_waitcnt lgkmcnt(2)
    v_mfma_f32_32x32x16_bf16 v[16:31], a[0:3], v[48:51], 0
    ds_read_b128 v[60:63], v4 offset:3072
    v_mfma_f32_32x32x16_bf16 v[32:47], a[128:131], v[48:51], 0
    s_waitcnt lgkmcnt(2)
    v_mfma_f32_32x32x16_bf16 v[16:31], a[4:7], v[52:55], v[16:31]
    ds_read_b128 v[48:51], v4 offset:4096
    v_mfma_f32_32x32x16_bf16 v[32:47], a[132:135], v[52:55], v[32:47]
    s_waitcnt lgkmcnt(2)
    v_mfma_f32_32x32x16_bf16 v[16:31], a[8:11], v[56:59], v[16:31]
    ds_read_b128 v[52:55], v4 offset:5120
    v_mfma_f32_32x32x16_bf16 v[32:47], a[136:139], v[56:59], v[32:47]
    s_waitcnt lgkmcnt(2)
    v_mfma_f32_32x32x16_bf16 v[16:31], a[12:15], v[60:63], v[16:31]
    ds_read_b128 v[56:59], v4 offset:6144
    v_mfma_f32_32x32x16_bf16 v[32:47], a[140:143], v[60:63], v[32:47]
    s_waitcnt lgkmcnt(2)
    v_mfma_f32_32x32x16_bf16 v[16:31], a[16:19], v[48:51], v[16:31]
    ds_read_b128 v[60:63], v4 offset:7168
    v_mfma_f32_32x32x16_bf16 v[32:47], a[144:147], v[48:51], v[32:47]
    s_waitcnt lgkmcnt(2)
    v_mfma_f32_32x32x16_bf16 v[16:31], a[20:23], v[52:55], v[16:31]
    ds_read_b128 v[48:51], v4 offset:8192
    v_mfma_f32_32x32x16_bf16 v[32:47], a[148:151], v[52:55], v[32:47]
    s_waitcnt lgkmcnt(2)
    v_mfma_f32_32x32x16_bf16 v[16:31], a[24:27], v[56:59], v[16:31]
    ds_read_b128 v[52:55], v4 offset:9216
    v_mfma_f32_32x32x16_bf16 v[32:47], a[152:155], v[56:59], v[32:47]
    s_waitcnt lgkmcnt(2)
    v_mfma_f32_32x32x16_bf16 v[16:31], a[28:31], v[60:63], v[16:31]
    ds_read_b128 v[56:59], v4 offset:10240
    v_mfma_f32_32x32x16_bf16 v[32:47], a[156:159], v[60:63], v[32:47]
    s_waitcnt lgkmcnt(2)
    v_mfma_f32_32x32x16_bf16 v[16:31], a[32:35], v[48:51], v[16:31]
    ds_read_b128 v[60:63], v4 offset:11264
    v_mfma_f32_32x32x16_bf16 v[32:47], a[160:163], v[48:51], v[32:47]
    s_waitcnt lgkmcnt(2)
    v_mfma_f32_32x32x16_bf16 v[16:31], a[36:39], v[52:55], v[16:31]
    ds_read_b128 v[48:51], v4 offset:12288
    v_mfma_f32_32x32x16_bf16 v[32:47], a[164:167], v[52:55], v[32:47]
    s_waitcnt lgkmcnt(2)
    v_mfma_f32_32x32x16_bf16 v[16:31], a[40:43], v[56:59], v[16:31]
    ds_read_b128 v[52:55], v4 offset:13312
    v_mfma_f32_32x32x16_bf16 v[32:47], a[168:171], v[56:59], v[32:47]
    s_waitcnt lgkmcnt(2)
    v_mfma_f32_32x32x16_bf16 v[16:31], a[44:47], v[60:63], v[16:31]
    ds_read_b128 v[56:59], v4 offset:14336
    v_mfma_f32_32x32x16_bf16 v[32:47], a[172:175], v[60:63], v[32:47]
    s_waitcnt lgkmcnt(2)
    v_mfma_f32_32x32x16_bf16 v[16:31], a[48:51], v[48:51], v[16:31]
    ds_read_b128 v[60:63], v4 offset:15360
    s_waitcnt vmcnt(0)
    v_mov_b32 v10, s11
    buffer_store_dword v10, off, s[4:7], s15 sc1
    v_mfma_f32_32x32x16_bf16 v[32:47], a[176:179], v[48:51], v[32:47]
    s_waitcnt lgkmcnt(2)
    v_mfma_f32_32x32x16_bf16 v[16:31], a[52:55], v[52:55], v[16:31]
    ds_read_b128 v[48:51], v4 offset:16384
    v_mfma_f32_32x32x16_bf16 v[32:47], a[180:183], v[52:55], v[32:47]
    s_waitcnt lgkmcnt(2)
    v_mfma_f32_32x32x16_bf16 v[16:31], a[56:59], v[56:59], v[16:31]
    ds_read_b128 v[52:55], v4 offset:17408
    v_mfma_f32_32x32x16_bf16 v[32:47], a[184:187], v[56:59], v[32:47]
    s_waitcnt lgkmcnt(2)
    v_mfma_f32_32x32x16_bf16 v[16:31], a[60:63], v[60:63], v[16:31]
    ds_read_b128 v[56:59], v4 offset:18432
    v_mfma_f32_32x32x16_bf16 v[32:47], a[188:191], v[60:63], v[32:47]
    s_waitcnt lgkmcnt(2)
    v_mfma_f32_32x32x16_bf16 v[16:31], a[64:67], v[48:51], v[16:31]
    ds_read_b128 v[60:63], v4 offset:19456
    v_mfma_f32_32x32x16_bf16 v[32:47], a[192:195], v[48:51], v[32:47]
    s_waitcnt lgkmcnt(2)
    v_mfma_f32_32x32x16_bf16 v[16:31], a[68:71], v[52:55], v[16:31]
    ds_read_b128 v[48:51], v4 offset:20480
    v_mfma_f32_32x32x16_bf16 v[32:47], a[196:199], v[52:55], v[32:47]
    s_waitcnt lgkmcnt(2)
    v_mfma_f32_32x32x16_bf16 v[16:31], a[72:75], v[56:59], v[16:31]
    ds_read_b128 v[52:55], v4 offset:21504
    v_mfma_f32_32x32x16_bf16 v[32:47], a[200:203], v[56:59], v[32:47]
    s_waitcnt lgkmcnt(2)
    v_mfma_f32_32x32x16_bf16 v[16:31], a[76:79], v[60:63], v[16:31]
    ds_read_b128 v[56:59], v4 offset:22528
    v_mfma_f32_32x32x16_bf16 v[32:47], a[204:207], v[60:63], v[32:47]
    s_waitcnt lgkmcnt(2)
    v_mfma_f32_32x32x16_bf16 v[16:31], a[80:83], v[48:51], v[16:31]
    ds_read_b128 v[60:63], v4 offset:23552
    buffer_load_dword v8, v3, s[4:7], s26 offen sc1
    buffer_load_dword v12, v5, s[4:7], s30 offen sc1
    v_mfma_f32_32x32x16_bf16 v[32:47], a[208:211], v[48:51], v[32:47]
    s_waitcnt lgkmcnt(2)
    v_mfma_f32_32x32x16_bf16 v[16:31], a[84:87], v[52:55], v[16:31]
    ds_read_b128 v[48:51], v4 offset:24576
    v_mfma_f32_32x32x16_bf16 v[32:47], a[212:215], v[52:55], v[32:47]
    s_waitcnt lgkmcnt(2)
    v_mfma_f32_32x32x16_bf16 v[16:31], a[88:91], v[56:59], v[16:31]
    ds_read_b128 v[52:55], v4 offset:25600
    v_mfma_f32_32x32x16_bf16 v[32:47], a[216:219], v[56:59], v[32:47]
    s_waitcnt lgkmcnt(2)
    v_mfma_f32_32x32x16_bf16 v[16:31], a[92:95], v[60:63], v[16:31]
    ds_read_b128 v[56:59], v4 offset:26624
    v_mfma_f32_32x32x16_bf16 v[32:47], a[220:223], v[60:63], v[32:47]
    s_waitcnt lgkmcnt(2)
    v_mfma_f32_32x32x16_bf16 v[16:31], a[96:99], v[48:51], v[16:31]
    ds_read_b128 v[60:63], v4 offset:27648
    v_mfma_f32_32x32x16_bf16 v[32:47], a[224:227], v[48:51], v[32:47]
    s_waitcnt lgkmcnt(2)
    v_mfma_f32_32x32x16_bf16 v[16:31], a[100:103], v[52:55], v[16:31]
    ds_read_b128 v[48:51], v4 offset:28672
    v_mfma_f32_32x32x16_bf16 v[32:47], a[228:231], v[52:55], v[32:47]
    s_waitcnt lgkmcnt(2)
    v_mfma_f32_32x32x16_bf16 v[16:31], a[104:107], v[56:59], v[16:31]
    ds_read_b128 v[52:55], v4 offset:29696
    v_mfma_f32_32x32x16_bf16 v[32:47], a[232:235], v[56:59], v[32:47]
    s_waitcnt lgkmcnt(2)
    v_mfma_f32_32x32x16_bf16 v[16:31], a[108:111], v[60:63], v[16:31]
    ds_read_b128 v[56:59], v4 offset:30720
    v_mfma_f32_32x32x16_bf16 v[32:47], a[236:239], v[60:63], v[32:47]
    s_waitcnt lgkmcnt(2)
    v_mfma_f32_32x32x16_bf16 v[16:31], a[112:115], v[48:51], v[16:31]
    ds_read_b128 v[60:63], v4 offset:31744
    v_mfma_f32_32x32x16_bf16 v[32:47], a[240:243], v[48:51], v[32:47]
    s_waitcnt lgkmcnt(2)
    v_mfma_f32_32x32x16_bf16 v[16:31], a[116:119], v[52:55], v[16:31]
    v_mfma_f32_32x32x16_bf16 v[32:47], a[244:247], v[52:55], v[32:47]
    s_waitcnt lgkmcnt(1)
    v_mfma_f32_32x32x16_bf16 v[16:31], a[120:123], v[56:59], v[16:31]
    v_mfma_f32_32x32x16_bf16 v[32:47], a[248:251], v[56:59], v[32:47]
    s_waitcnt lgkmcnt(0)
    v_mfma_f32_32x32x16_bf16 v[16:31], a[124:127], v[60:63], v[16:31]
    v_mfma_f32_32x32x16_bf16 v[32:47], a[252:255], v[60:63], v[32:47]
    s_waitcnt vmcnt(0)
    s_cmp_eq_u32 s11, 63
    s_nop 6
    s_nop 0
    s_cbranch_scc1 O_NOPF
    v_cmp_ge_u32 vcc, s23, v8
    s_cbranch_vccnz O_NOPF
    s_add_u32 s23, s11, 1
    s_and_b32 s22, s23, 7
    s_lshl_b32 s22, s22, 18
    s_add_u32 s22, s22, s28
    s_and_b32 s20, s23, 1
    s_lshl_b32 s20, s20, 15
    s_lshl_b32 s21, s9, 13
    s_add_u32 s20, s20, s21
    s_mov_b32 m0, s20
    s_nop 0
    buffer_load_dwordx4 v1, s[4:7], s22 offen offset:0 sc1 lds
    buffer_load_dwordx4 v1, s[4:7], s22 offen offset:1024 sc1 lds
    buffer_load_dwordx4 v1, s[4:7], s22 offen offset:2048 sc1 lds
    buffer_load_dwordx4 v1, s[4:7], s22 offen offset:3072 sc1 lds
    s_add_u32 s20, s20, 4096
    s_mov_b32 m0, s20
    s_add_u32 s21, s22, 4096
    buffer_load_dwordx4 v1, s[4:7], s21 offen offset:0 sc1 lds
    buffer_load_dwordx4 v1, s[4:7], s21 offen offset:1024 sc1 lds
    buffer_load_dwordx4 v1, s[4:7], s21 offen offset:2048 sc1 lds
    buffer_load_dwordx4 v1, s[4:7], s21 offen offset:3072 sc1 lds
    s_mov_b32 s25, s23
O_NOPF:
    v_cvt_pk_bf16_f32 v64, v16, v17
    v_cvt_pk_bf16_f32 v65, v18, v19
    v_cvt_pk_bf16_f32 v66, v20, v21
    v_cvt_pk_bf16_f32 v67, v22, v23
    v_cvt_pk_bf16_f32 v68, v24, v25
    v_cvt_pk_bf16_f32 v69, v26, v27
    v_cvt_pk_bf16_f32 v70, v28, v29
    v_cvt_pk_bf16_f32 v71, v30, v31
    v_permlane32_swap_b32 v64, v66
    v_permlane32_swap_b32 v65, v67
    v_permlane32_swap_b32 v68, v70
    v_permlane32_swap_b32 v69, v71
    v_cvt_pk_bf16_f32 v72, v32, v33
    v_cvt_pk_bf16_f32 v73, v34, v35
    v_cvt_pk_bf16_f32 v74, v36, v37
    v_cvt_pk_bf16_f32 v75, v38, v39
    v_cvt_pk_bf16_f32 v76, v40, v41
    v_cvt_pk_bf16_f32 v77, v42, v43
    v_cvt_pk_bf16_f32 v78, v44, v45
    v_cvt_pk_bf16_f32 v79, v46, v47
    v_permlane32_swap_b32 v72, v74
    v_permlane32_swap_b32 v73, v75
    v_permlane32_swap_b32 v76, v78
    v_permlane32_swap_b32 v77, v79
    s_sub_u32 s22, s11, 8
    s_cmp_lt_i32 s22, 0
    s_cbranch_scc1 O_SLOT
    v_cmp_ge_u32 vcc, s22, v12
    s_cbranch_vccz O_SLOT
    s_mov_b32 s24, 0
os_127:
    buffer_load_dword v12, v5, s[4:7], s30 offen sc1
    s_add_u32 s24, s24, 1
    s_cmp_gt_u32 s24, 200000
    s_cbranch_scc1 K_FAIL
    s_waitcnt vmcnt(0)
    v_cmp_ge_u32 vcc, s22, v12
    s_cbranch_vccz osok_128
    s_sleep 1
    s_branch os_127
osok_128:
O_SLOT:
    buffer_store_dwordx4 v[64:67], v2, s[4:7], s13 offen offset:0 sc1
    buffer_store_dwordx4 v[68:71], v2, s[4:7], s13 offen offset:1024 sc1
    buffer_store_dwordx4 v[72:75], v2, s[4:7], s13 offen offset:2048 sc1
    buffer_store_dwordx4 v[76:79], v2, s[4:7], s13 offen offset:3072 sc1
    s_add_u32 s11, s11, 1
    s_cmp_lt_u32 s11, 64
    s_cbranch_scc1 O_SEG
    s_waitcnt vmcnt(0)
    v_mov_b32 v10, s11
    buffer_store_dword v10, off, s[4:7], s15 sc1
    s_waitcnt vmcnt(0)
    s_branch K_DONE
ROLE_H:
    s_load_dwordx2 s[4:5], s[0:1], 96
    v_lshrrev_b32 v14, 6, v0
    v_and_b32 v15, 63, v0
    v_readfirstlane_b32 s9, v14
    s_mov_b32 s6, 268435456
    s_mov_b32 s7, 0x20000
    v_lshlrev_b32 v0, 4, v15
    s_lshl_b32 s20, s9, 13
    v_add_u32 v1, s20, v0
    s_lshl_b32 s20, s9, 11
    v_add_u32 v2, s20, v0
    v_and_b32 v16, 31, v15
    v_lshrrev_b32 v17, 5, v15
    v_lshrrev_b32 v18, 4, v16
    v_lshlrev_b32 v18, 10, v18
    v_lshlrev_b32 v19, 8, v17
    v_add_u32 v18, v18, v19
    v_and_b32 v19, 15, v16
    v_lshlrev_b32 v19, 4, v19
    s_add_u32 s21, s20, 8192
    v_add3_u32 v3, v18, v19, s21
    s_lshl_b32 s20, s9, 9
    v_add_u32 v4, s20, v0
    v_and_b32 v18, 15, v15
    v_lshrrev_b32 v18, 2, v18
    v_lshlrev_b32 v19, 3, v17
    v_add_u32 v18, v18, v19
    v_lshlrev_b32 v18, 4, v18
    v_and_b32 v19, 1, v15
    v_lshlrev_b32 v19, 3, v19
    s_lshl_b32 s20, s9, 10
    s_add_u32 s20, s20, 159744
    v_add3_u32 v5, v18, v19, s20
    s_lshl_b32 s20, s9, 5
    v_add_u32 v18, s20, v16
    v_lshlrev_b32 v18, 4, v18
    v_lshlrev_b32 v19, 3, v17
    v_add_u32 v18, v18, v19
    v_add_u32 v6, 2048, v18
    s_xor_b32 s20, s9, 0
    s_mul_i32 s20, s20, 5120
    s_add_u32 s20, s20, 139264
    v_add_u32 v7, s20, v0
    s_xor_b32 s20, s9, 1
    s_mul_i32 s20, s20, 5120
    s_add_u32 s20, s20, 139264
    v_add_u32 v8, s20, v0
    s_xor_b32 s20, s9, 2
    s_mul_i32 s20, s20, 5120
    s_add_u32 s20, s20, 139264
    v_add_u32 v9, s20, v0
    s_xor_b32 s20, s9, 3
    s_mul_i32 s20, s20, 5120
    s_add_u32 s20, s20, 139264
    v_add_u32 v10, s20, v0
    s_mul_i32 s20, s9, 6144
    s_add_u32 s20, s20, 65536
    v_add_u32 v11, s20, v0
    v_and_b32 v18, 7, v15
    v_lshlrev_b32 v12, 7, v18
    v_lshlrev_b32 v18, 2, v17
    v_add_u32 v18, 0, v18
    v_cmp_le_u32 s[40:41], v18, v16
    v_lshlrev_b32 v18, 2, v17
    v_add_u32 v18, 1, v18
    v_cmp_le_u32 s[42:43], v18, v16
    v_lshlrev_b32 v18, 2, v17
    v_add_u32 v18, 2, v18
    v_cmp_le_u32 s[44:45], v18, v16
    v_lshlrev_b32 v18, 2, v17
    v_add_u32 v18, 3, v18
    v_cmp_le_u32 s[46:47], v18, v16
    v_lshlrev_b32 v18, 2, v17
    v_add_u32 v18, 8, v18
    v_cmp_le_u32 s[48:49], v18, v16
    v_lshlrev_b32 v18, 2, v17
    v_add_u32 v18, 9, v18
    v_cmp_le_u32 s[50:51], v18, v16
    v_lshlrev_b32 v18, 2, v17
    v_add_u32 v18, 10, v18
    v_cmp_le_u32 s[52:53], v18, v16
    v_lshlrev_b32 v18, 2, v17
    v_add_u32 v18, 11, v18
    v_cmp_le_u32 s[54:55], v18, v16
    v_lshlrev_b32 v18, 2, v17
    v_add_u32 v18, 16, v18
    v_cmp_le_u32 s[56:57], v18, v16
    v_lshlrev_b32 v18, 2, v17
    v_add_u32 v18, 17, v18
    v_cmp_le_u32 s[58:59], v18, v16
    v_lshlrev_b32 v18, 2, v17
    v_add_u32 v18, 18, v18
    v_cmp_le_u32 s[60:61], v18, v16
    v_lshlrev_b32 v18, 2, v17
    v_add_u32 v18, 19, v18
    v_cmp_le_u32 s[62:63], v18, v16
    v_lshlrev_b32 v18, 2, v17
    v_add_u32 v18, 24, v18
    v_cmp_le_u32 s[64:65], v18, v16
    v_lshlrev_b32 v18, 2, v17
    v_add_u32 v18, 25, v18
    v_cmp_le_u32 s[66:67], v18, v16
    v_lshlrev_b32 v18, 2, v17
    v_add_u32 v18, 26, v18
    v_cmp_le_u32 s[68:69], v18, v16
    v_lshlrev_b32 v18, 2, v17
    v_add_u32 v18, 27, v18
    v_cmp_le_u32 s[70:71], v18, v16
    s_mov_b32 s26, 0x3e0293ee
    s_mov_b32 s27, 0xbe0293ee
    s_waitcnt lgkmcnt(0)
    v_lshrrev_b32 v16, 4, v15
    v_and_b32 v17, 15, v15
    v_lshlrev_b32 v18, 2, v16
    v_xor_b32 v18, v18, v17
    v_lshlrev_b32 v18, 4, v18
    s_lshl_b32 s20, s9, 2
    v_add_u32 v19, s20, v16
    v_lshlrev_b32 v19, 13, v19
    s_lshl_b32 s20, s8, 8
    v_add3_u32 v68, v18, v19, s20
    v_lshrrev_b32 v17, 2, v17
    v_lshrrev_b32 v18, 1, v16
    v_lshlrev_b32 v18, 3, v18
    v_add_u32 v18, v18, v17
    v_lshlrev_b32 v18, 8, v18
    v_xor_b32 v19, s9, v17
    v_lshlrev_b32 v19, 6, v19
    v_add_u32 v18, v18, v19
    v_and_b32 v19, 1, v16
    v_lshlrev_b32 v19, 5, v19
    v_add_u32 v18, v18, v19
    v_and_b32 v19, 3, v15
    v_lshlrev_b32 v19, 3, v19
    v_add_u32 v69, v18, v19
    v_add_u32 v70, 0x10000, v69
    s_load_dwordx2 s[32:33], s[0:1], 40
    s_mov_b32 s34, 4194304
    s_mov_b32 s35, 0x20000
    s_waitcnt lgkmcnt(0)
    s_lshl_b32 s20, s9, 10
    s_add_u32 s20, s20, 0
    s_mov_b32 s21, 0
    s_mov_b32 s24, 0
hwdma_129:
    s_mov_b32 m0, s20
    s_add_u32 s20, s20, 4096
    buffer_load_dwordx4 v68, s[32:35], s21 offen  lds
    s_add_u32 s21, s21, 131072
    s_add_u32 s24, s24, 1
    s_cmp_lt_u32 s24, 16
    s_cbranch_scc1 hwdma_129
    s_lshl_b32 s20, s9, 10
    s_add_u32 s20, s20, 65536
    s_mov_b32 s21, 2097152
    s_mov_b32 s24, 0
hwdma_130:
    s_mov_b32 m0, s20
    s_add_u32 s20, s20, 4096
    buffer_load_dwordx4 v68, s[32:35], s21 offen  lds
    s_add_u32 s21, s21, 131072
    s_add_u32 s24, s24, 1
    s_cmp_lt_u32 s24, 16
    s_cbranch_scc1 hwdma_130
    s_waitcnt vmcnt(16)
    s_barrier
    ds_read_b64_tr_b16 a[0:1], v69 offset:0
    ds_read_b64_tr_b16 a[2:3], v69 offset:1024
    ds_read_b64_tr_b16 a[4:5], v69 offset:4096
    ds_read_b64_tr_b16 a[6:7], v69 offset:5120
    ds_read_b64_tr_b16 a[8:9], v69 offset:8192
    ds_read_b64_tr_b16 a[10:11], v69 offset:9216
    ds_read_b64_tr_b16 a[12:13], v69 offset:12288
    ds_read_b64_tr_b16 a[14:15], v69 offset:13312
    s_waitcnt lgkmcnt(4)
    ds_read_b64_tr_b16 a[16:17], v69 offset:16384
    ds_read_b64_tr_b16 a[18:19], v69 offset:17408
    ds_read_b64_tr_b16 a[20:21], v69 offset:20480
    ds_read_b64_tr_b16 a[22:23], v69 offset:21504
    ds_read_b64_tr_b16 a[24:25], v69 offset:24576
    ds_read_b64_tr_b16 a[26:27], v69 offset:25600
    ds_read_b64_tr_b16 a[28:29], v69 offset:28672
    ds_read_b64_tr_b16 a[30:31], v69 offset:29696
    s_waitcnt lgkmcnt(4)
    ds_read_b64_tr_b16 a[32:33], v69 offset:32768
    ds_read_b64_tr_b16 a[34:35], v69 offset:33792
    ds_read_b64_tr_b16 a[36:37], v69 offset:36864
    ds_read_b64_tr_b16 a[38:39], v69 offset:37888
    ds_read_b64_tr_b16 a[40:41], v69 offset:40960
    ds_read_b64_tr_b16 a[42:43], v69 offset:41984
    ds_read_b64_tr_b16 a[44:45], v69 offset:45056
    ds_read_b64_tr_b16 a[46:47], v69 offset:46080
    s_waitcnt lgkmcnt(4)
    ds_read_b64_tr_b16 a[48:49], v69 offset:49152
    ds_read_b64_tr_b16 a[50:51], v69 offset:50176
    ds_read_b64_tr_b16 a[52:53], v69 offset:53248
    ds_read_b64_tr_b16 a[54:55], v69 offset:54272
    ds_read_b64_tr_b16 a[56:57], v69 offset:57344
    ds_read_b64_tr_b16 a[58:59], v69 offset:58368
    ds_read_b64_tr_b16 a[60:61], v69 offset:61440
    ds_read_b64_tr_b16 a[62:63], v69 offset:62464
    s_waitcnt lgkmcnt(4)
    s_waitcnt lgkmcnt(0)
    s_barrier
    s_load_dwordx2 s[76:77], s[0:1], 48
    s_mov_b32 s78, 4194304
    s_mov_b32 s79, 0x20000
    s_waitcnt lgkmcnt(0)
    s_lshl_b32 s20, s9, 10
    s_add_u32 s20, s20, 0
    s_mov_b32 s21, 0
    s_mov_b32 s24, 0
hwdma_131:
    s_mov_b32 m0, s20
    s_add_u32 s20, s20, 4096
    buffer_load_dwordx4 v68, s[76:79], s21 offen  lds
    s_add_u32 s21, s21, 131072
    s_add_u32 s24, s24, 1
    s_cmp_lt_u32 s24, 16
    s_cbranch_scc1 hwdma_131
    s_waitcnt vmcnt(16)
    s_barrier
    ds_read_b64_tr_b16 a[64:65], v70 offset:0
    ds_read_b64_tr_b16 a[66:67], v70 offset:1024
    ds_read_b64_tr_b16 a[68:69], v70 offset:4096
    ds_read_b64_tr_b16 a[70:71], v70 offset:5120
    ds_read_b64_tr_b16 a[72:73], v70 offset:8192
    ds_read_b64_tr_b16 a[74:75], v70 offset:9216
    ds_read_b64_tr_b16 a[76:77], v70 offset:12288
    ds_read_b64_tr_b16 a[78:79], v70 offset:13312
    s_waitcnt lgkmcnt(4)
    ds_read_b64_tr_b16 a[80:81], v70 offset:16384
    ds_read_b64_tr_b16 a[82:83], v70 offset:17408
    ds_read_b64_tr_b16 a[84:85], v70 offset:20480
    ds_read_b64_tr_b16 a[86:87], v70 offset:21504
    ds_read_b64_tr_b16 a[88:89], v70 offset:24576
    ds_read_b64_tr_b16 a[90:91], v70 offset:25600
    ds_read_b64_tr_b16 a[92:93], v70 offset:28672
    ds_read_b64_tr_b16 a[94:95], v70 offset:29696
    s_waitcnt lgkmcnt(4)
    ds_read_b64_tr_b16 a[96:97], v70 offset:32768
    ds_read_b64_tr_b16 a[98:99], v70 offset:33792
    ds_read_b64_tr_b16 a[100:101], v70 offset:36864
    ds_read_b64_tr_b16 a[102:103], v70 offset:37888
    ds_read_b64_tr_b16 a[104:105], v70 offset:40960
    ds_read_b64_tr_b16 a[106:107], v70 offset:41984
    ds_read_b64_tr_b16 a[108:109], v70 offset:45056
    ds_read_b64_tr_b16 a[110:111], v70 offset:46080
    s_waitcnt lgkmcnt(4)
    ds_read_b64_tr_b16 a[112:113], v70 offset:49152
    ds_read_b64_tr_b16 a[114:115], v70 offset:50176
    ds_read_b64_tr_b16 a[116:117], v70 offset:53248
    ds_read_b64_tr_b16 a[118:119], v70 offset:54272
    ds_read_b64_tr_b16 a[120:121], v70 offset:57344
    ds_read_b64_tr_b16 a[122:123], v70 offset:58368
    ds_read_b64_tr_b16 a[124:125], v70 offset:61440
    ds_read_b64_tr_b16 a[126:127], v70 offset:62464
    s_waitcnt lgkmcnt(4)
    s_waitcnt lgkmcnt(0)
    s_barrier
    s_lshl_b32 s20, s9, 10
    s_add_u32 s20, s20, 65536
    s_mov_b32 s21, 2097152
    s_mov_b32 s24, 0
hwdma_132:
    s_mov_b32 m0, s20
    s_add_u32 s20, s20, 4096
    buffer_load_dwordx4 v68, s[76:79], s21 offen  lds
    s_add_u32 s21, s21, 131072
    s_add_u32 s24, s24, 1
    s_cmp_lt_u32 s24, 16
    s_cbranch_scc1 hwdma_132
    s_waitcnt vmcnt(16)
    s_barrier
    ds_read_b64_tr_b16 a[128:129], v69 offset:0
    ds_read_b64_tr_b16 a[130:131], v69 offset:1024
    ds_read_b64_tr_b16 a[132:133], v69 offset:4096
    ds_read_b64_tr_b16 a[134:135], v69 offset:5120
    ds_read_b64_tr_b16 a[136:137], v69 offset:8192
    ds_read_b64_tr_b16 a[138:139], v69 offset:9216
    ds_read_b64_tr_b16 a[140:141], v69 offset:12288
    ds_read_b64_tr_b16 a[142:143], v69 offset:13312
    s_waitcnt lgkmcnt(4)
    ds_read_b64_tr_b16 a[144:145], v69 offset:16384
    ds_read_b64_tr_b16 a[146:147], v69 offset:17408
    ds_read_b64_tr_b16 a[148:149], v69 offset:20480
    ds_read_b64_tr_b16 a[150:151], v69 offset:21504
    ds_read_b64_tr_b16 a[152:153], v69 offset:24576
    ds_read_b64_tr_b16 a[154:155], v69 offset:25600
    ds_read_b64_tr_b16 a[156:157], v69 offset:28672
    ds_read_b64_tr_b16 a[158:159], v69 offset:29696
    s_waitcnt lgkmcnt(4)
    ds_read_b64_tr_b16 a[160:161], v69 offset:32768
    ds_read_b64_tr_b16 a[162:163], v69 offset:33792
    ds_read_b64_tr_b16 a[164:165], v69 offset:36864
    ds_read_b64_tr_b16 a[166:167], v69 offset:37888
    ds_read_b64_tr_b16 a[168:169], v69 offset:40960
    ds_read_b64_tr_b16 a[170:171], v69 offset:41984
    ds_read_b64_tr_b16 a[172:173], v69 offset:45056
    ds_read_b64_tr_b16 a[174:175], v69 offset:46080
    s_waitcnt lgkmcnt(4)
    ds_read_b64_tr_b16 a[176:177], v69 offset:49152
    ds_read_b64_tr_b16 a[178:179], v69 offset:50176
    ds_read_b64_tr_b16 a[180:181], v69 offset:53248
    ds_read_b64_tr_b16 a[182:183], v69 offset:54272
    ds_read_b64_tr_b16 a[184:185], v69 offset:57344
    ds_read_b64_tr_b16 a[186:187], v69 offset:58368
    ds_read_b64_tr_b16 a[188:189], v69 offset:61440
    ds_read_b64_tr_b16 a[190:191], v69 offset:62464
    s_waitcnt lgkmcnt(4)
    s_waitcnt lgkmcnt(0)
    s_barrier
    s_load_dwordx2 s[32:33], s[0:1], 56
    s_mov_b32 s34, 4194304
    s_mov_b32 s35, 0x20000
    s_waitcnt lgkmcnt(0)
    s_lshl_b32 s20, s9, 10
    s_add_u32 s20, s20, 0
    s_mov_b32 s21, 0
    s_mov_b32 s24, 0
hwdma_133:
    s_mov_b32 m0, s20
    s_add_u32 s20, s20, 4096
    buffer_load_dwordx4 v68, s[32:35], s21 offen  lds
    s_add_u32 s21, s21, 131072
    s_add_u32 s24, s24, 1
    s_cmp_lt_u32 s24, 16
    s_cbranch_scc1 hwdma_133
    s_waitcnt vmcnt(16)
    s_barrier
    ds_read_b64_tr_b16 a[192:193], v70 offset:0
    ds_read_b64_tr_b16 a[194:195], v70 offset:1024
    ds_read_b64_tr_b16 a[196:197], v70 offset:4096
    ds_read_b64_tr_b16 a[198:199], v70 offset:5120
    ds_read_b64_tr_b16 a[200:201], v70 offset:8192
    ds_read_b64_tr_b16 a[202:203], v70 offset:9216
    ds_read_b64_tr_b16 a[204:205], v70 offset:12288
    ds_read_b64_tr_b16 a[206:207], v70 offset:13312
    s_waitcnt lgkmcnt(4)
    ds_read_b64_tr_b16 a[208:209], v70 offset:16384
    ds_read_b64_tr_b16 a[210:211], v70 offset:17408
    ds_read_b64_tr_b16 a[212:213], v70 offset:20480
    ds_read_b64_tr_b16 a[214:215], v70 offset:21504
    ds_read_b64_tr_b16 a[216:217], v70 offset:24576
    ds_read_b64_tr_b16 a[218:219], v70 offset:25600
    ds_read_b64_tr_b16 a[220:221], v70 offset:28672
    ds_read_b64_tr_b16 a[222:223], v70 offset:29696
    s_waitcnt lgkmcnt(4)
    ds_read_b64_tr_b16 a[224:225], v70 offset:32768
    ds_read_b64_tr_b16 a[226:227], v70 offset:33792
    ds_read_b64_tr_b16 a[228:229], v70 offset:36864
    ds_read_b64_tr_b16 a[230:231], v70 offset:37888
    ds_read_b64_tr_b16 a[232:233], v70 offset:40960
    ds_read_b64_tr_b16 a[234:235], v70 offset:41984
    ds_read_b64_tr_b16 a[236:237], v70 offset:45056
    ds_read_b64_tr_b16 a[238:239], v70 offset:46080
    s_waitcnt lgkmcnt(4)
    ds_read_b64_tr_b16 a[240:241], v70 offset:49152
    ds_read_b64_tr_b16 a[242:243], v70 offset:50176
    ds_read_b64_tr_b16 a[244:245], v70 offset:53248
    ds_read_b64_tr_b16 a[246:247], v70 offset:54272
    ds_read_b64_tr_b16 a[248:249], v70 offset:57344
    ds_read_b64_tr_b16 a[250:251], v70 offset:58368
    ds_read_b64_tr_b16 a[252:253], v70 offset:61440
    ds_read_b64_tr_b16 a[254:255], v70 offset:62464
    s_waitcnt lgkmcnt(4)
    s_waitcnt lgkmcnt(0)
    s_barrier
    s_lshl_b32 s20, s9, 10
    s_add_u32 s20, s20, 65536
    s_mov_b32 s21, 2097152
    s_mov_b32 s24, 0
hwdma_134:
    s_mov_b32 m0, s20
    s_add_u32 s20, s20, 4096
    buffer_load_dwordx4 v68, s[32:35], s21 offen  lds
    s_add_u32 s21, s21, 131072
    s_add_u32 s24, s24, 1
    s_cmp_lt_u32 s24, 16
    s_cbranch_scc1 hwdma_134
    s_waitcnt vmcnt(16)
    s_barrier
    ds_read_b64_tr_b16 v[128:129], v69 offset:0
    ds_read_b64_tr_b16 v[130:131], v69 offset:1024
    ds_read_b64_tr_b16 v[132:133], v69 offset:4096
    ds_read_b64_tr_b16 v[134:135], v69 offset:5120
    ds_read_b64_tr_b16 v[136:137], v69 offset:8192
    ds_read_b64_tr_b16 v[138:139], v69 offset:9216
    ds_read_b64_tr_b16 v[140:141], v69 offset:12288
    ds_read_b64_tr_b16 v[142:143], v69 offset:13312
    s_waitcnt lgkmcnt(4)
    ds_read_b64_tr_b16 v[144:145], v69 offset:16384
    ds_read_b64_tr_b16 v[146:147], v69 offset:17408
    ds_read_b64_tr_b16 v[148:149], v69 offset:20480
    ds_read_b64_tr_b16 v[150:151], v69 offset:21504
    ds_read_b64_tr_b16 v[152:153], v69 offset:24576
    ds_read_b64_tr_b16 v[154:155], v69 offset:25600
    ds_read_b64_tr_b16 v[156:157], v69 offset:28672
    ds_read_b64_tr_b16 v[158:159], v69 offset:29696
    s_waitcnt lgkmcnt(4)
    ds_read_b64_tr_b16 v[160:161], v69 offset:32768
    ds_read_b64_tr_b16 v[162:163], v69 offset:33792
    ds_read_b64_tr_b16 v[164:165], v69 offset:36864
    ds_read_b64_tr_b16 v[166:167], v69 offset:37888
    ds_read_b64_tr_b16 v[168:169], v69 offset:40960
    ds_read_b64_tr_b16 v[170:171], v69 offset:41984
    ds_read_b64_tr_b16 v[172:173], v69 offset:45056
    ds_read_b64_tr_b16 v[174:175], v69 offset:46080
    s_waitcnt lgkmcnt(4)
    ds_read_b64_tr_b16 v[176:177], v69 offset:49152
    ds_read_b64_tr_b16 v[178:179], v69 offset:50176
    ds_read_b64_tr_b16 v[180:181], v69 offset:53248
    ds_read_b64_tr_b16 v[182:183], v69 offset:54272
    ds_read_b64_tr_b16 v[184:185], v69 offset:57344
    ds_read_b64_tr_b16 v[186:187], v69 offset:58368
    ds_read_b64_tr_b16 v[188:189], v69 offset:61440
    ds_read_b64_tr_b16 v[190:191], v69 offset:62464
    s_waitcnt lgkmcnt(4)
    s_waitcnt lgkmcnt(0)
    s_barrier
    s_waitcnt vmcnt(0)
    s_barrier
    ds_read_b64_tr_b16 v[192:193], v70 offset:0
    ds_read_b64_tr_b16 v[194:195], v70 offset:1024
    ds_read_b64_tr_b16 v[196:197], v70 offset:4096
    ds_read_b64_tr_b16 v[198:199], v70 offset:5120
    ds_read_b64_tr_b16 v[200:201], v70 offset:8192
    ds_read_b64_tr_b16 v[202:203], v70 offset:9216
    ds_read_b64_tr_b16 v[204:205], v70 offset:12288
    ds_read_b64_tr_b16 v[206:207], v70 offset:13312
    s_waitcnt lgkmcnt(4)
    ds_read_b64_tr_b16 v[208:209], v70 offset:16384
    ds_read_b64_tr_b16 v[210:211], v70 offset:17408
    ds_read_b64_tr_b16 v[212:213], v70 offset:20480
    ds_read_b64_tr_b16 v[214:215], v70 offset:21504
    ds_read_b64_tr_b16 v[216:217], v70 offset:24576
    ds_read_b64_tr_b16 v[218:219], v70 offset:25600
    ds_read_b64_tr_b16 v[220:221], v70 offset:28672
    ds_read_b64_tr_b16 v[222:223], v70 offset:29696
    s_waitcnt lgkmcnt(4)
    ds_read_b64_tr_b16 v[224:225], v70 offset:32768
    ds_read_b64_tr_b16 v[226:227], v70 offset:33792
    ds_read_b64_tr_b16 v[228:229], v70 offset:36864
    ds_read_b64_tr_b16 v[230:231], v70 offset:37888
    ds_read_b64_tr_b16 v[232:233], v70 offset:40960
    ds_read_b64_tr_b16 v[234:235], v70 offset:41984
    ds_read_b64_tr_b16 v[236:237], v70 offset:45056
    ds_read_b64_tr_b16 v[238:239], v70 offset:46080
    s_waitcnt lgkmcnt(4)
    ds_read_b64_tr_b16 v[240:241], v70 offset:49152
    ds_read_b64_tr_b16 v[242:243], v70 offset:50176
    ds_read_b64_tr_b16 v[244:245], v70 offset:53248
    ds_read_b64_tr_b16 v[246:247], v70 offset:54272
    ds_read_b64_tr_b16 v[248:249], v70 offset:57344
    ds_read_b64_tr_b16 v[250:251], v70 offset:58368
    ds_read_b64_tr_b16 v[252:253], v70 offset:61440
    ds_read_b64_tr_b16 v[254:255], v70 offset:62464
    s_waitcnt lgkmcnt(4)
    s_waitcnt lgkmcnt(0)
    s_barrier
    s_cmp_lg_u32 s95, 0
    s_cbranch_scc1 H_RWB
    s_mov_b32 s94, 0
    v_mbcnt_lo_u32_b32 v118, -1, 0
    v_mbcnt_hi_u32_b32 v118, -1, v118
    v_and_b32 v120, 7, v118
    v_lshrrev_b32 v119, 2, v120
    v_lshlrev_b32 v119, 7, v119
    v_and_b32 v120, 3, v120
    v_lshlrev_b32 v120, 2, v120
    v_add_u32 v120, v120, v119
H_RW:
    global_load_dword v121, v120, s[88:89] sc1
    s_add_u32 s94, s94, 1
    s_cmp_gt_u32 s94, 200000
    s_cbranch_scc1 K_FAIL
    s_waitcnt vmcnt(0)
    s_mov_b32 s93, 0
    v_readlane_b32 s92, v121, 0
    s_nop 0
    s_add_u32 s93, s93, s92
    v_readlane_b32 s92, v121, 1
    s_nop 0
    s_add_u32 s93, s93, s92
    v_readlane_b32 s92, v121, 2
    s_nop 0
    s_add_u32 s93, s93, s92
    v_readlane_b32 s92, v121, 3
    s_nop 0
    s_add_u32 s93, s93, s92
    v_readlane_b32 s92, v121, 4
    s_nop 0
    s_add_u32 s93, s93, s92
    v_readlane_b32 s92, v121, 5
    s_nop 0
    s_add_u32 s93, s93, s92
    v_readlane_b32 s92, v121, 6
    s_nop 0
    s_add_u32 s93, s93, s92
    v_readlane_b32 s92, v121, 7
    s_nop 0
    s_add_u32 s93, s93, s92
    s_cmp_ge_u32 s93, 256
    s_cbranch_scc1 H_RWD
    s_sleep 2
    s_branch H_RW
H_RWD:
    v_cmp_ne_u32 vcc, 32, v121
    s_nop 0
    s_cmp_eq_u64 vcc, 0
    s_cselect_b32 s92, 0, 1
    v_mov_b32 v120, 163836
    v_mov_b32 v121, s92
    ds_write_b32 v120, v121
    s_waitcnt lgkmcnt(0)
H_RWB:
    s_barrier
    v_mov_b32 v120, 163836
    ds_read_b32 v121, v120
    s_waitcnt lgkmcnt(0)
    v_readfirstlane_b32 s92, v121
    s_nop 0
    s_and_b32 s92, s92, 1
    s_barrier
    s_branch ROLE_H3
ROLE_H2:
    v_lshrrev_b32 v16, 4, v15
    v_and_b32 v17, 15, v15
    v_lshlrev_b32 v18, 2, v16
    v_xor_b32 v18, v18, v17
    v_lshlrev_b32 v18, 4, v18
    s_lshl_b32 s20, s9, 2
    v_add_u32 v19, s20, v16
    v_lshlrev_b32 v19, 13, v19
    s_lshl_b32 s20, s8, 8
    v_add3_u32 v68, v18, v19, s20
    v_lshrrev_b32 v17, 2, v17
    v_lshrrev_b32 v18, 1, v16
    v_lshlrev_b32 v18, 3, v18
    v_add_u32 v18, v18, v17
    v_lshlrev_b32 v18, 8, v18
    v_xor_b32 v19, s9, v17
    v_lshlrev_b32 v19, 6, v19
    v_add_u32 v18, v18, v19
    v_and_b32 v19, 1, v16
    v_lshlrev_b32 v19, 5, v19
    v_add_u32 v18, v18, v19
    v_and_b32 v19, 3, v15
    v_lshlrev_b32 v19, 3, v19
    v_add_u32 v69, v18, v19
    v_add_u32 v70, 0x10000, v69
    s_load_dwordx2 s[32:33], s[0:1], 40
    s_mov_b32 s34, 4194304
    s_mov_b32 s35, 0x20000
    s_waitcnt lgkmcnt(0)
    s_lshl_b32 s20, s9, 10
    s_add_u32 s20, s20, 0
    s_mov_b32 s21, 0
    s_mov_b32 s24, 0
hwdma_135:
    s_mov_b32 m0, s20
    s_add_u32 s20, s20, 4096
    buffer_load_dwordx4 v68, s[32:35], s21 offen  lds
    s_add_u32 s21, s21, 131072
    s_add_u32 s24, s24, 1
    s_cmp_lt_u32 s24, 16
    s_cbranch_scc1 hwdma_135
    s_lshl_b32 s20, s9, 10
    s_add_u32 s20, s20, 65536
    s_mov_b32 s21, 2097152
    s_mov_b32 s24, 0
hwdma_136:
    s_mov_b32 m0, s20
    s_add_u32 s20, s20, 4096
    buffer_load_dwordx4 v68, s[32:35], s21 offen  lds
    s_add_u32 s21, s21, 131072
    s_add_u32 s24, s24, 1
    s_cmp_lt_u32 s24, 16
    s_cbranch_scc1 hwdma_136
    s_waitcnt vmcnt(16)
    s_barrier
    ds_read_b64_tr_b16 a[0:1], v69 offset:0
    ds_read_b64_tr_b16 a[2:3], v69 offset:1024
    ds_read_b64_tr_b16 a[4:5], v69 offset:4096
    ds_read_b64_tr_b16 a[6:7], v69 offset:5120
    ds_read_b64_tr_b16 a[8:9], v69 offset:8192
    ds_read_b64_tr_b16 a[10:11], v69 offset:9216
    ds_read_b64_tr_b16 a[12:13], v69 offset:12288
    ds_read_b64_tr_b16 a[14:15], v69 offset:13312
    s_waitcnt lgkmcnt(4)
    ds_read_b64_tr_b16 a[16:17], v69 offset:16384
    ds_read_b64_tr_b16 a[18:19], v69 offset:17408
    ds_read_b64_tr_b16 a[20:21], v69 offset:20480
    ds_read_b64_tr_b16 a[22:23], v69 offset:21504
    ds_read_b64_tr_b16 a[24:25], v69 offset:24576
    ds_read_b64_tr_b16 a[26:27], v69 offset:25600
    ds_read_b64_tr_b16 a[28:29], v69 offset:28672
    ds_read_b64_tr_b16 a[30:31], v69 offset:29696
    s_waitcnt lgkmcnt(4)
    ds_read_b64_tr_b16 a[32:33], v69 offset:32768
    ds_read_b64_tr_b16 a[34:35], v69 offset:33792
    ds_read_b64_tr_b16 a[36:37], v69 offset:36864
    ds_read_b64_tr_b16 a[38:39], v69 offset:37888
    ds_read_b64_tr_b16 a[40:41], v69 offset:40960
    ds_read_b64_tr_b16 a[42:43], v69 offset:41984
    ds_read_b64_tr_b16 a[44:45], v69 offset:45056
    ds_read_b64_tr_b16 a[46:47], v69 offset:46080
    s_waitcnt lgkmcnt(4)
    ds_read_b64_tr_b16 a[48:49], v69 offset:49152
    ds_read_b64_tr_b16 a[50:51], v69 offset:50176
    ds_read_b64_tr_b16 a[52:53], v69 offset:53248
    ds_read_b64_tr_b16 a[54:55], v69 offset:54272
    ds_read_b64_tr_b16 a[56:57], v69 offset:57344
    ds_read_b64_tr_b16 a[58:59], v69 offset:58368
    ds_read_b64_tr_b16 a[60:61], v69 offset:61440
    ds_read_b64_tr_b16 a[62:63], v69 offset:62464
    s_waitcnt lgkmcnt(4)
    s_waitcnt lgkmcnt(0)
    s_barrier
    s_load_dwordx2 s[76:77], s[0:1], 48
    s_mov_b32 s78, 4194304
    s_mov_b32 s79, 0x20000
    s_waitcnt lgkmcnt(0)
    s_lshl_b32 s20, s9, 10
    s_add_u32 s20, s20, 0
    s_mov_b32 s21, 0
    s_mov_b32 s24, 0
hwdma_137:
    s_mov_b32 m0, s20
    s_add_u32 s20, s20, 4096
    buffer_load_dwordx4 v68, s[76:79], s21 offen  lds
    s_add_u32 s21, s21, 131072
    s_add_u32 s24, s24, 1
    s_cmp_lt_u32 s24, 16
    s_cbranch_scc1 hwdma_137
    s_waitcnt vmcnt(16)
    s_barrier
    ds_read_b64_tr_b16 a[64:65], v70 offset:0
    ds_read_b64_tr_b16 a[66:67], v70 offset:1024
    ds_read_b64_tr_b16 a[68:69], v70 offset:4096
    ds_read_b64_tr_b16 a[70:71], v70 offset:5120
    ds_read_b64_tr_b16 a[72:73], v70 offset:8192
    ds_read_b64_tr_b16 a[74:75], v70 offset:9216
    ds_read_b64_tr_b16 a[76:77], v70 offset:12288
    ds_read_b64_tr_b16 a[78:79], v70 offset:13312
    s_waitcnt lgkmcnt(4)
    ds_read_b64_tr_b16 a[80:81], v70 offset:16384
    ds_read_b64_tr_b16 a[82:83], v70 offset:17408
    ds_read_b64_tr_b16 a[84:85], v70 offset:20480
    ds_read_b64_tr_b16 a[86:87], v70 offset:21504
    ds_read_b64_tr_b16 a[88:89], v70 offset:24576
    ds_read_b64_tr_b16 a[90:91], v70 offset:25600
    ds_read_b64_tr_b16 a[92:93], v70 offset:28672
    ds_read_b64_tr_b16 a[94:95], v70 offset:29696
    s_waitcnt lgkmcnt(4)
    ds_read_b64_tr_b16 a[96:97], v70 offset:32768
    ds_read_b64_tr_b16 a[98:99], v70 offset:33792
    ds_read_b64_tr_b16 a[100:101], v70 offset:36864
    ds_read_b64_tr_b16 a[102:103], v70 offset:37888
    ds_read_b64_tr_b16 a[104:105], v70 offset:40960
    ds_read_b64_tr_b16 a[106:107], v70 offset:41984
    ds_read_b64_tr_b16 a[108:109], v70 offset:45056
    ds_read_b64_tr_b16 a[110:111], v70 offset:46080
    s_waitcnt lgkmcnt(4)
    ds_read_b64_tr_b16 a[112:113], v70 offset:49152
    ds_read_b64_tr_b16 a[114:115], v70 offset:50176
    ds_read_b64_tr_b16 a[116:117], v70 offset:53248
    ds_read_b64_tr_b16 a[118:119], v70 offset:54272
    ds_read_b64_tr_b16 a[120:121], v70 offset:57344
    ds_read_b64_tr_b16 a[122:123], v70 offset:58368
    ds_read_b64_tr_b16 a[124:125], v70 offset:61440
    ds_read_b64_tr_b16 a[126:127], v70 offset:62464
    s_waitcnt lgkmcnt(4)
    s_waitcnt lgkmcnt(0)
    s_barrier
    s_lshl_b32 s20, s9, 10
    s_add_u32 s20, s20, 65536
    s_mov_b32 s21, 2097152
    s_mov_b32 s24, 0
hwdma_138:
    s_mov_b32 m0, s20
    s_add_u32 s20, s20, 4096
    buffer_load_dwordx4 v68, s[76:79], s21 offen  lds
    s_add_u32 s21, s21, 131072
    s_add_u32 s24, s24, 1
    s_cmp_lt_u32 s24, 16
    s_cbranch_scc1 hwdma_138
    s_waitcnt vmcnt(16)
    s_barrier
    ds_read_b64_tr_b16 a[128:129], v69 offset:0
    ds_read_b64_tr_b16 a[130:131], v69 offset:1024
    ds_read_b64_tr_b16 a[132:133], v69 offset:4096
    ds_read_b64_tr_b16 a[134:135], v69 offset:5120
    ds_read_b64_tr_b16 a[136:137], v69 offset:8192
    ds_read_b64_tr_b16 a[138:139], v69 offset:9216
    ds_read_b64_tr_b16 a[140:141], v69 offset:12288
    ds_read_b64_tr_b16 a[142:143], v69 offset:13312
    s_waitcnt lgkmcnt(4)
    ds_read_b64_tr_b16 a[144:145], v69 offset:16384
    ds_read_b64_tr_b16 a[146:147], v69 offset:17408
    ds_read_b64_tr_b16 a[148:149], v69 offset:20480
    ds_read_b64_tr_b16 a[150:151], v69 offset:21504
    ds_read_b64_tr_b16 a[152:153], v69 offset:24576
    ds_read_b64_tr_b16 a[154:155], v69 offset:25600
    ds_read_b64_tr_b16 a[156:157], v69 offset:28672
    ds_read_b64_tr_b16 a[158:159], v69 offset:29696
    s_waitcnt lgkmcnt(4)
    ds_read_b64_tr_b16 a[160:161], v69 offset:32768
    ds_read_b64_tr_b16 a[162:163], v69 offset:33792
    ds_read_b64_tr_b16 a[164:165], v69 offset:36864
    ds_read_b64_tr_b16 a[166:167], v69 offset:37888
    ds_read_b64_tr_b16 a[168:169], v69 offset:40960
    ds_read_b64_tr_b16 a[170:171], v69 offset:41984
    ds_read_b64_tr_b16 a[172:173], v69 offset:45056
    ds_read_b64_tr_b16 a[174:175], v69 offset:46080
    s_waitcnt lgkmcnt(4)
    ds_read_b64_tr_b16 a[176:177], v69 offset:49152
    ds_read_b64_tr_b16 a[178:179], v69 offset:50176
    ds_read_b64_tr_b16 a[180:181], v69 offset:53248
    ds_read_b64_tr_b16 a[182:183], v69 offset:54272
    ds_read_b64_tr_b16 a[184:185], v69 offset:57344
    ds_read_b64_tr_b16 a[186:187], v69 offset:58368
    ds_read_b64_tr_b16 a[188:189], v69 offset:61440
    ds_read_b64_tr_b16 a[190:191], v69 offset:62464
    s_waitcnt lgkmcnt(4)
    s_waitcnt lgkmcnt(0)
    s_barrier
    s_load_dwordx2 s[32:33], s[0:1], 56
    s_mov_b32 s34, 4194304
    s_mov_b32 s35, 0x20000
    s_waitcnt lgkmcnt(0)
    s_lshl_b32 s20, s9, 10
    s_add_u32 s20, s20, 0
    s_mov_b32 s21, 0
    s_mov_b32 s24, 0
hwdma_139:
    s_mov_b32 m0, s20
    s_add_u32 s20, s20, 4096
    buffer_load_dwordx4 v68, s[32:35], s21 offen  lds
    s_add_u32 s21, s21, 131072
    s_add_u32 s24, s24, 1
    s_cmp_lt_u32 s24, 16
    s_cbranch_scc1 hwdma_139
    s_waitcnt vmcnt(16)
    s_barrier
    ds_read_b64_tr_b16 a[192:193], v70 offset:0
    ds_read_b64_tr_b16 a[194:195], v70 offset:1024
    ds_read_b64_tr_b16 a[196:197], v70 offset:4096
    ds_read_b64_tr_b16 a[198:199], v70 offset:5120
    ds_read_b64_tr_b16 a[200:201], v70 offset:8192
    ds_read_b64_tr_b16 a[202:203], v70 offset:9216
    ds_read_b64_tr_b16 a[204:205], v70 offset:12288
    ds_read_b64_tr_b16 a[206:207], v70 offset:13312
    s_waitcnt lgkmcnt(4)
    ds_read_b64_tr_b16 a[208:209], v70 offset:16384
    ds_read_b64_tr_b16 a[210:211], v70 offset:17408
    ds_read_b64_tr_b16 a[212:213], v70 offset:20480
    ds_read_b64_tr_b16 a[214:215], v70 offset:21504
    ds_read_b64_tr_b16 a[216:217], v70 offset:24576
    ds_read_b64_tr_b16 a[218:219], v70 offset:25600
    ds_read_b64_tr_b16 a[220:221], v70 offset:28672
    ds_read_b64_tr_b16 a[222:223], v70 offset:29696
    s_waitcnt lgkmcnt(4)
    ds_read_b64_tr_b16 a[224:225], v70 offset:32768
    ds_read_b64_tr_b16 a[226:227], v70 offset:33792
    ds_read_b64_tr_b16 a[228:229], v70 offset:36864
    ds_read_b64_tr_b16 a[230:231], v70 offset:37888
    ds_read_b64_tr_b16 a[232:233], v70 offset:40960
    ds_read_b64_tr_b16 a[234:235], v70 offset:41984
    ds_read_b64_tr_b16 a[236:237], v70 offset:45056
    ds_read_b64_tr_b16 a[238:239], v70 offset:46080
    s_waitcnt lgkmcnt(4)
    ds_read_b64_tr_b16 a[240:241], v70 offset:49152
    ds_read_b64_tr_b16 a[242:243], v70 offset:50176
    ds_read_b64_tr_b16 a[244:245], v70 offset:53248
    ds_read_b64_tr_b16 a[246:247], v70 offset:54272
    ds_read_b64_tr_b16 a[248:249], v70 offset:57344
    ds_read_b64_tr_b16 a[250:251], v70 offset:58368
    ds_read_b64_tr_b16 a[252:253], v70 offset:61440
    ds_read_b64_tr_b16 a[254:255], v70 offset:62464
    s_waitcnt lgkmcnt(4)
    s_waitcnt lgkmcnt(0)
    s_barrier
    s_lshl_b32 s20, s9, 10
    s_add_u32 s20, s20, 65536
    s_mov_b32 s21, 2097152
    s_mov_b32 s24, 0
hwdma_140:
    s_mov_b32 m0, s20
    s_add_u32 s20, s20, 4096
    buffer_load_dwordx4 v68, s[32:35], s21 offen  lds
    s_add_u32 s21, s21, 131072
    s_add_u32 s24, s24, 1
    s_cmp_lt_u32 s24, 16
    s_cbranch_scc1 hwdma_140
    s_waitcnt vmcnt(16)
    s_barrier
    ds_read_b64_tr_b16 v[128:129], v69 offset:0
    ds_read_b64_tr_b16 v[130:131], v69 offset:1024
    ds_read_b64_tr_b16 v[132:133], v69 offset:4096
    ds_read_b64_tr_b16 v[134:135], v69 offset:5120
    ds_read_b64_tr_b16 v[136:137], v69 offset:8192
    ds_read_b64_tr_b16 v[138:139], v69 offset:9216
    ds_read_b64_tr_b16 v[140:141], v69 offset:12288
    ds_read_b64_tr_b16 v[142:143], v69 offset:13312
    s_waitcnt lgkmcnt(4)
    ds_read_b64_tr_b16 v[144:145], v69 offset:16384
    ds_read_b64_tr_b16 v[146:147], v69 offset:17408
    ds_read_b64_tr_b16 v[148:149], v69 offset:20480
    ds_read_b64_tr_b16 v[150:151], v69 offset:21504
    ds_read_b64_tr_b16 v[152:153], v69 offset:24576
    ds_read_b64_tr_b16 v[154:155], v69 offset:25600
    ds_read_b64_tr_b16 v[156:157], v69 offset:28672
    ds_read_b64_tr_b16 v[158:159], v69 offset:29696
    s_waitcnt lgkmcnt(4)
    ds_read_b64_tr_b16 v[160:161], v69 offset:32768
    ds_read_b64_tr_b16 v[162:163], v69 offset:33792
    ds_read_b64_tr_b16 v[164:165], v69 offset:36864
    ds_read_b64_tr_b16 v[166:167], v69 offset:37888
    ds_read_b64_tr_b16 v[168:169], v69 offset:40960
    ds_read_b64_tr_b16 v[170:171], v69 offset:41984
    ds_read_b64_tr_b16 v[172:173], v69 offset:45056
    ds_read_b64_tr_b16 v[174:175], v69 offset:46080
    s_waitcnt lgkmcnt(4)
    ds_read_b64_tr_b16 v[176:177], v69 offset:49152
    ds_read_b64_tr_b16 v[178:179], v69 offset:50176
    ds_read_b64_tr_b16 v[180:181], v69 offset:53248
    ds_read_b64_tr_b16 v[182:183], v69 offset:54272
    ds_read_b64_tr_b16 v[184:185], v69 offset:57344
    ds_read_b64_tr_b16 v[186:187], v69 offset:58368
    ds_read_b64_tr_b16 v[188:189], v69 offset:61440
    ds_read_b64_tr_b16 v[190:191], v69 offset:62464
    s_waitcnt lgkmcnt(4)
    s_waitcnt lgkmcnt(0)
    s_barrier
    s_waitcnt vmcnt(0)
    s_barrier
    ds_read_b64_tr_b16 v[192:193], v70 offset:0
    ds_read_b64_tr_b16 v[194:195], v70 offset:1024
    ds_read_b64_tr_b16 v[196:197], v70 offset:4096
    ds_read_b64_tr_b16 v[198:199], v70 offset:5120
    ds_read_b64_tr_b16 v[200:201], v70 offset:8192
    ds_read_b64_tr_b16 v[202:203], v70 offset:9216
    ds_read_b64_tr_b16 v[204:205], v70 offset:12288
    ds_read_b64_tr_b16 v[206:207], v70 offset:13312
    s_waitcnt lgkmcnt(4)
    ds_read_b64_tr_b16 v[208:209], v70 offset:16384
    ds_read_b64_tr_b16 v[210:211], v70 offset:17408
    ds_read_b64_tr_b16 v[212:213], v70 offset:20480
    ds_read_b64_tr_b16 v[214:215], v70 offset:21504
    ds_read_b64_tr_b16 v[216:217], v70 offset:24576
    ds_read_b64_tr_b16 v[218:219], v70 offset:25600
    ds_read_b64_tr_b16 v[220:221], v70 offset:28672
    ds_read_b64_tr_b16 v[222:223], v70 offset:29696
    s_waitcnt lgkmcnt(4)
    ds_read_b64_tr_b16 v[224:225], v70 offset:32768
    ds_read_b64_tr_b16 v[226:227], v70 offset:33792
    ds_read_b64_tr_b16 v[228:229], v70 offset:36864
    ds_read_b64_tr_b16 v[230:231], v70 offset:37888
    ds_read_b64_tr_b16 v[232:233], v70 offset:40960
    ds_read_b64_tr_b16 v[234:235], v70 offset:41984
    ds_read_b64_tr_b16 v[236:237], v70 offset:45056
    ds_read_b64_tr_b16 v[238:239], v70 offset:46080
    s_waitcnt lgkmcnt(4)
    ds_read_b64_tr_b16 v[240:241], v70 offset:49152
    ds_read_b64_tr_b16 v[242:243], v70 offset:50176
    ds_read_b64_tr_b16 v[244:245], v70 offset:53248
    ds_read_b64_tr_b16 v[246:247], v70 offset:54272
    ds_read_b64_tr_b16 v[248:249], v70 offset:57344
    ds_read_b64_tr_b16 v[250:251], v70 offset:58368
    ds_read_b64_tr_b16 v[252:253], v70 offset:61440
    ds_read_b64_tr_b16 v[254:255], v70 offset:62464
    s_waitcnt lgkmcnt(4)
    s_waitcnt lgkmcnt(0)
    s_barrier
ROLE_H3:
    s_lshl_b32 s20, s36, 5
    s_add_u32 s20, s20, s8
    s_lshl_b32 s21, s20, 1
    s_add_u32 s21, s21, s10
    s_mul_i32 s21, s21, 128
    s_lshl_b32 s22, s9, 2
    s_add_u32 s21, s21, s22
    s_add_u32 s17, s21, 0
    s_add_u32 s19, s21, 16384
    s_mul_i32 s21, s20, 128
    s_add_u32 s18, s21, 32768
    s_lshl_b32 s20, s36, 4
    s_lshr_b32 s21, s8, 2
    s_lshl_b32 s21, s21, 1
    s_add_u32 s20, s20, s21
    s_mul_i32 s74, s20, 128
    s_add_u32 s74, s74, 40960
    s_mov_b32 s11, 0
    s_mov_b32 s25, -1
    s_mov_b32 s28, s10
    s_mov_b32 s29, -1
    s_mov_b32 s72, 0
    s_mov_b32 s73, 0
    s_mov_b32 s31, 0
H_P:
    s_and_b32 s20, s28, 15
    s_lshl_b32 s20, s20, 15
    s_add_u32 s20, s20, 13631488
    s_lshl_b32 s12, s28, 15
    s_add_u32 s12, s12, 6291456
    s_cmp_eq_u32 s36, 0
    s_cselect_b32 s12, s12, s20
    s_lshl_b32 s20, s36, 22
    s_and_b32 s21, s28, 7
    s_lshl_b32 s21, s21, 5
    s_add_u32 s21, s21, s8
    s_lshl_b32 s21, s21, 14
    s_add_u32 s13, s20, s21
    s_add_u32 s13, s13, 16777216
    s_cmp_ge_i32 s25, s11
    s_cbranch_scc1 H_HAVEX
    s_waitcnt vmcnt(0)
    s_sub_u32 s23, s11, 3
    s_cmp_lt_i32 s23, 0
    s_cbranch_scc1 hnt_141
    s_add_u32 s20, s23, 1
    v_mov_b32 v16, s20
    buffer_store_dword v16, off, s[4:7], s19 sc1
hnt_141:
    s_mov_b32 s75, 0
    s_cmp_ge_u32 s28, 16
    s_cselect_b32 s20, 1, 0
    s_add_u32 s75, s75, s20
    s_cmp_ge_u32 s28, 32
    s_cselect_b32 s20, 1, 0
    s_add_u32 s75, s75, s20
    s_cmp_ge_u32 s28, 48
    s_cselect_b32 s20, 1, 0
    s_add_u32 s75, s75, s20
    s_cmp_ge_u32 s28, 56
    s_cselect_b32 s20, 1, 0
    s_add_u32 s75, s75, s20
    s_lshl_b32 s75, s75, 12
    s_add_u32 s75, s75, 65536
    s_cmp_eq_u32 s36, 0
    s_cselect_b32 s75, s75, 49152
    s_and_b32 s20, s28, 3
    s_lshl_b32 s20, s20, 10
    s_add_u32 s75, s75, s20
    s_mov_b32 s24, 0
hx_142:
    buffer_load_dword v14, v12, s[4:7], s75 offen sc1
    s_add_u32 s24, s24, 1
    s_cmp_gt_u32 s24, 200000
    s_cbranch_scc1 K_FAIL
    s_waitcnt vmcnt(0)
    v_cmp_ge_u32 vcc, s28, v14
    s_cbranch_vccz hxok_143
    s_sleep 1
    s_branch hx_142
hxok_143:
    s_and_b32 s20, s11, 1
    s_lshl_b32 s20, s20, 15
    s_lshl_b32 s21, s9, 13
    s_add_u32 s20, s20, s21
    s_mov_b32 m0, s20
    s_nop 0
    buffer_load_dwordx4 v1, s[4:7], s12 offen offset:0 sc1 lds
    buffer_load_dwordx4 v1, s[4:7], s12 offen offset:1024 sc1 lds
    buffer_load_dwordx4 v1, s[4:7], s12 offen offset:2048 sc1 lds
    buffer_load_dwordx4 v1, s[4:7], s12 offen offset:3072 sc1 lds
    s_add_u32 s20, s20, 4096
    s_mov_b32 m0, s20
    s_add_u32 s21, s12, 4096
    buffer_load_dwordx4 v1, s[4:7], s21 offen offset:0 sc1 lds
    buffer_load_dwordx4 v1, s[4:7], s21 offen offset:1024 sc1 lds
    buffer_load_dwordx4 v1, s[4:7], s21 offen offset:2048 sc1 lds
    buffer_load_dwordx4 v1, s[4:7], s21 offen offset:3072 sc1 lds
    s_mov_b32 s25, s11
    s_waitcnt vmcnt(0)
H_HAVEX:
    s_and_b32 s20, s11, 1
    s_lshl_b32 s20, s20, 15
    v_add_u32 v13, s20, v0
    s_barrier
    ds_read_b128 v[68:71], v13 offset:0
    ds_read_b128 v[72:75], v13 offset:1024
    ds_read_b128 v[76:79], v13 offset:2048
    s_add_u32 s22, s28, 2
    s_mov_b32 s75, 0
    s_cmp_ge_u32 s22, 16
    s_cselect_b32 s20, 1, 0
    s_add_u32 s75, s75, s20
    s_cmp_ge_u32 s22, 32
    s_cselect_b32 s20, 1, 0
    s_add_u32 s75, s75, s20
    s_cmp_ge_u32 s22, 48
    s_cselect_b32 s20, 1, 0
    s_add_u32 s75, s75, s20
    s_cmp_ge_u32 s22, 56
    s_cselect_b32 s20, 1, 0
    s_add_u32 s75, s75, s20
    s_lshl_b32 s75, s75, 12
    s_add_u32 s75, s75, 65536
    s_cmp_eq_u32 s36, 0
    s_cselect_b32 s75, s75, 49152
    s_and_b32 s20, s22, 3
    s_lshl_b32 s20, s20, 10
    s_add_u32 s75, s75, s20
    s_waitcnt lgkmcnt(2)
    v_mfma_f32_32x32x16_bf16 v[20:35], a[0:3], v[68:71], 0
    ds_read_b128 v[80:83], v13 offset:3072
    v_mfma_f32_32x32x16_bf16 v[36:51], a[128:131], v[68:71], 0
    v_mfma_f32_32x32x16_bf16 v[52:67], v[68:71], v[128:131], 0
    s_waitcnt lgkmcnt(2)
    v_mfma_f32_32x32x16_bf16 v[20:35], a[4:7], v[72:75], v[20:35]
    ds_read_b128 v[68:71], v13 offset:4096
    v_mfma_f32_32x32x16_bf16 v[36:51], a[132:135], v[72:75], v[36:51]
    v_mfma_f32_32x32x16_bf16 v[52:67], v[72:75], v[132:135], v[52:67]
    s_waitcnt lgkmcnt(2)
    v_mfma_f32_32x32x16_bf16 v[20:35], a[8:11], v[76:79], v[20:35]
    ds_read_b128 v[72:75], v13 offset:5120
    v_mfma_f32_32x32x16_bf16 v[36:51], a[136:139], v[76:79], v[36:51]
    v_mfma_f32_32x32x16_bf16 v[52:67], v[76:79], v[136:139], v[52:67]
    s_waitcnt lgkmcnt(2)
    v_mfma_f32_32x32x16_bf16 v[20:35], a[12:15], v[80:83], v[20:35]
    ds_read_b128 v[76:79], v13 offset:6144
    v_mfma_f32_32x32x16_bf16 v[36:51], a[140:143], v[80:83], v[36:51]
    v_mfma_f32_32x32x16_bf16 v[52:67], v[80:83], v[140:143], v[52:67]
    s_waitcnt lgkmcnt(2)
    v_mfma_f32_32x32x16_bf16 v[20:35], a[16:19], v[68:71], v[20:35]
    ds_read_b128 v[80:83], v13 offset:7168
    v_mfma_f32_32x32x16_bf16 v[36:51], a[144:147], v[68:71], v[36:51]
    v_mfma_f32_32x32x16_bf16 v[52:67], v[68:71], v[144:147], v[52:67]
    s_waitcnt lgkmcnt(2)
    v_mfma_f32_32x32x16_bf16 v[20:35], a[20:23], v[72:75], v[20:35]
    ds_read_b128 v[68:71], v13 offset:8192
    v_mfma_f32_32x32x16_bf16 v[36:51], a[148:151], v[72:75], v[36:51]
    v_mfma_f32_32x32x16_bf16 v[52:67], v[72:75], v[148:151], v[52:67]
    s_waitcnt lgkmcnt(2)
    v_mfma_f32_32x32x16_bf16 v[20:35], a[24:27], v[76:79], v[20:35]
    ds_read_b128 v[72:75], v13 offset:9216
    v_mfma_f32_32x32x16_bf16 v[36:51], a[152:155], v[76:79], v[36:51]
    v_mfma_f32_32x32x16_bf16 v[52:67], v[76:79], v[152:155], v[52:67]
    s_waitcnt lgkmcnt(2)
    v_mfma_f32_32x32x16_bf16 v[20:35], a[28:31], v[80:83], v[20:35]
    ds_read_b128 v[76:79], v13 offset:10240
    v_mfma_f32_32x32x16_bf16 v[36:51], a[156:159], v[80:83], v[36:51]
    v_mfma_f32_32x32x16_bf16 v[52:67], v[80:83], v[156:159], v[52:67]
    s_waitcnt lgkmcnt(2)
    v_mfma_f32_32x32x16_bf16 v[20:35], a[32:35], v[68:71], v[20:35]
    ds_read_b128 v[80:83], v13 offset:11264
    v_mfma_f32_32x32x16_bf16 v[36:51], a[160:163], v[68:71], v[36:51]
    v_mfma_f32_32x32x16_bf16 v[52:67], v[68:71], v[160:163], v[52:67]
    s_waitcnt lgkmcnt(2)
    v_mfma_f32_32x32x16_bf16 v[20:35], a[36:39], v[72:75], v[20:35]
    ds_read_b128 v[68:71], v13 offset:12288
    v_mfma_f32_32x32x16_bf16 v[36:51], a[164:167], v[72:75], v[36:51]
    s_waitcnt vmcnt(0)
    s_sub_u32 s23, s11, 3
    s_cmp_lt_i32 s23, 0
    s_cbranch_scc1 hnt_144
    s_add_u32 s20, s23, 1
    v_mov_b32 v16, s20
    buffer_store_dword v16, off, s[4:7], s19 sc1
hnt_144:
    v_mfma_f32_32x32x16_bf16 v[52:67], v[72:75], v[164:167], v[52:67]
    s_waitcnt lgkmcnt(2)
    v_mfma_f32_32x32x16_bf16 v[20:35], a[40:43], v[76:79], v[20:35]
    ds_read_b128 v[72:75], v13 offset:13312
    v_mfma_f32_32x32x16_bf16 v[36:51], a[168:171], v[76:79], v[36:51]
    v_mfma_f32_32x32x16_bf16 v[52:67], v[76:79], v[168:171], v[52:67]
    s_waitcnt lgkmcnt(2)
    v_mfma_f32_32x32x16_bf16 v[20:35], a[44:47], v[80:83], v[20:35]
    ds_read_b128 v[76:79], v13 offset:14336
    v_mfma_f32_32x32x16_bf16 v[36:51], a[172:175], v[80:83], v[36:51]
    v_mfma_f32_32x32x16_bf16 v[52:67], v[80:83], v[172:175], v[52:67]
    s_waitcnt lgkmcnt(2)
    v_mfma_f32_32x32x16_bf16 v[20:35], a[48:51], v[68:71], v[20:35]
    ds_read_b128 v[80:83], v13 offset:15360
    v_mfma_f32_32x32x16_bf16 v[36:51], a[176:179], v[68:71], v[36:51]
    v_mfma_f32_32x32x16_bf16 v[52:67], v[68:71], v[176:179], v[52:67]
    s_waitcnt lgkmcnt(2)
    v_mfma_f32_32x32x16_bf16 v[20:35], a[52:55], v[72:75], v[20:35]
    ds_read_b128 v[68:71], v13 offset:16384
    v_mfma_f32_32x32x16_bf16 v[36:51], a[180:183], v[72:75], v[36:51]
    v_mfma_f32_32x32x16_bf16 v[52:67], v[72:75], v[180:183], v[52:67]
    s_waitcnt lgkmcnt(2)
    v_mfma_f32_32x32x16_bf16 v[20:35], a[56:59], v[76:79], v[20:35]
    ds_read_b128 v[72:75], v13 offset:17408
    v_mfma_f32_32x32x16_bf16 v[36:51], a[184:187], v[76:79], v[36:51]
    v_mfma_f32_32x32x16_bf16 v[52:67], v[76:79], v[184:187], v[52:67]
    s_waitcnt lgkmcnt(2)
    v_mfma_f32_32x32x16_bf16 v[20:35], a[60:63], v[80:83], v[20:35]
    ds_read_b128 v[76:79], v13 offset:18432
    v_mfma_f32_32x32x16_bf16 v[36:51], a[188:191], v[80:83], v[36:51]
    v_mfma_f32_32x32x16_bf16 v[52:67], v[80:83], v[188:191], v[52:67]
    s_waitcnt lgkmcnt(2)
    v_mfma_f32_32x32x16_bf16 v[20:35], a[64:67], v[68:71], v[20:35]
    ds_read_b128 v[80:83], v13 offset:19456
    v_mfma_f32_32x32x16_bf16 v[36:51], a[192:195], v[68:71], v[36:51]
    v_mfma_f32_32x32x16_bf16 v[52:67], v[68:71], v[192:195], v[52:67]
    s_waitcnt lgkmcnt(2)
    v_mfma_f32_32x32x16_bf16 v[20:35], a[68:71], v[72:75], v[20:35]
    ds_read_b128 v[68:71], v13 offset:20480
    v_mfma_f32_32x32x16_bf16 v[36:51], a[196:199], v[72:75], v[36:51]
    v_mfma_f32_32x32x16_bf16 v[52:67], v[72:75], v[196:199], v[52:67]
    s_waitcnt lgkmcnt(2)
    v_mfma_f32_32x32x16_bf16 v[20:35], a[72:75], v[76:79], v[20:35]
    ds_read_b128 v[72:75], v13 offset:21504
    v_mfma_f32_32x32x16_bf16 v[36:51], a[200:203], v[76:79], v[36:51]
    v_mfma_f32_32x32x16_bf16 v[52:67], v[76:79], v[200:203], v[52:67]
    s_waitcnt lgkmcnt(2)
    v_mfma_f32_32x32x16_bf16 v[20:35], a[76:79], v[80:83], v[20:35]
    ds_read_b128 v[76:79], v13 offset:22528
    v_mfma_f32_32x32x16_bf16 v[36:51], a[204:207], v[80:83], v[36:51]
    v_mfma_f32_32x32x16_bf16 v[52:67], v[80:83], v[204:207], v[52:67]
    s_waitcnt lgkmcnt(2)
    v_mfma_f32_32x32x16_bf16 v[20:35], a[80:83], v[68:71], v[20:35]
    ds_read_b128 v[80:83], v13 offset:23552
    v_mfma_f32_32x32x16_bf16 v[36:51], a[208:211], v[68:71], v[36:51]
    v_mfma_f32_32x32x16_bf16 v[52:67], v[68:71], v[208:211], v[52:67]
    s_waitcnt lgkmcnt(2)
    v_mfma_f32_32x32x16_bf16 v[20:35], a[84:87], v[72:75], v[20:35]
    ds_read_b128 v[68:71], v13 offset:24576
    v_mfma_f32_32x32x16_bf16 v[36:51], a[212:215], v[72:75], v[36:51]
    v_mfma_f32_32x32x16_bf16 v[52:67], v[72:75], v[212:215], v[52:67]
    s_waitcnt lgkmcnt(2)
    v_mfma_f32_32x32x16_bf16 v[20:35], a[88:91], v[76:79], v[20:35]
    ds_read_b128 v[72:75], v13 offset:25600
    v_mfma_f32_32x32x16_bf16 v[36:51], a[216:219], v[76:79], v[36:51]
    buffer_load_dword v14, v12, s[4:7], s75 offen sc1
    buffer_load_dword v15, off, s[4:7], s18 sc1
    v_bfe_u32 v19, v0, 4, 1
    v_lshlrev_b32 v19, 7, v19
    buffer_load_dword v17, v19, s[4:7], s74 offen sc1
    v_mfma_f32_32x32x16_bf16 v[52:67], v[76:79], v[216:219], v[52:67]
    s_waitcnt lgkmcnt(2)
    v_mfma_f32_32x32x16_bf16 v[20:35], a[92:95], v[80:83], v[20:35]
    ds_read_b128 v[76:79], v13 offset:26624
    v_mfma_f32_32x32x16_bf16 v[36:51], a[220:223], v[80:83], v[36:51]
    v_mfma_f32_32x32x16_bf16 v[52:67], v[80:83], v[220:223], v[52:67]
    s_waitcnt lgkmcnt(2)
    v_mfma_f32_32x32x16_bf16 v[20:35], a[96:99], v[68:71], v[20:35]
    ds_read_b128 v[80:83], v13 offset:27648
    v_mfma_f32_32x32x16_bf16 v[36:51], a[224:227], v[68:71], v[36:51]
    v_mfma_f32_32x32x16_bf16 v[52:67], v[68:71], v[224:227], v[52:67]
    s_waitcnt lgkmcnt(2)
    v_mfma_f32_32x32x16_bf16 v[20:35], a[100:103], v[72:75], v[20:35]
    ds_read_b128 v[68:71], v13 offset:28672
    v_mfma_f32_32x32x16_bf16 v[36:51], a[228:231], v[72:75], v[36:51]
    v_mfma_f32_32x32x16_bf16 v[52:67], v[72:75], v[228:231], v[52:67]
    s_waitcnt lgkmcnt(2)
    v_mfma_f32_32x32x16_bf16 v[20:35], a[104:107], v[76:79], v[20:35]
    ds_read_b128 v[72:75], v13 offset:29696
    v_mfma_f32_32x32x16_bf16 v[36:51], a[232:235], v[76:79], v[36:51]
    v_mfma_f32_32x32x16_bf16 v[52:67], v[76:79], v[232:235], v[52:67]
    s_waitcnt lgkmcnt(2)
    v_mfma_f32_32x32x16_bf16 v[20:35], a[108:111], v[80:83], v[20:35]
    ds_read_b128 v[76:79], v13 offset:30720
    v_mfma_f32_32x32x16_bf16 v[36:51], a[236:239], v[80:83], v[36:51]
    v_mfma_f32_32x32x16_bf16 v[52:67], v[80:83], v[236:239], v[52:67]
    s_waitcnt lgkmcnt(2)
    v_mfma_f32_32x32x16_bf16 v[20:35], a[112:115], v[68:71], v[20:35]
    ds_read_b128 v[80:83], v13 offset:31744
    v_mfma_f32_32x32x16_bf16 v[36:51], a[240:243], v[68:71], v[36:51]
    v_mfma_f32_32x32x16_bf16 v[52:67], v[68:71], v[240:243], v[52:67]
    s_waitcnt lgkmcnt(2)
    v_mfma_f32_32x32x16_bf16 v[20:35], a[116:119], v[72:75], v[20:35]
    v_mfma_f32_32x32x16_bf16 v[36:51], a[244:247], v[72:75], v[36:51]
    v_mfma_f32_32x32x16_bf16 v[52:67], v[72:75], v[244:247], v[52:67]
    s_waitcnt lgkmcnt(1)
    v_mfma_f32_32x32x16_bf16 v[20:35], a[120:123], v[76:79], v[20:35]
    v_mfma_f32_32x32x16_bf16 v[36:51], a[248:251], v[76:79], v[36:51]
    v_mfma_f32_32x32x16_bf16 v[52:67], v[76:79], v[248:251], v[52:67]
    s_waitcnt lgkmcnt(0)
    v_mfma_f32_32x32x16_bf16 v[20:35], a[124:127], v[80:83], v[20:35]
    v_mfma_f32_32x32x16_bf16 v[36:51], a[252:255], v[80:83], v[36:51]
    v_mfma_f32_32x32x16_bf16 v[52:67], v[80:83], v[252:255], v[52:67]
    s_waitcnt vmcnt(0)
    s_cmp_eq_u32 s11, 31
    s_cbranch_scc1 H_NOPF
    s_add_u32 s22, s28, 2
    v_cmp_ge_u32 vcc, s22, v14
    s_cbranch_vccnz H_NOPF
    s_mov_b32 s23, s22
    s_and_b32 s20, s23, 15
    s_lshl_b32 s20, s20, 15
    s_add_u32 s20, s20, 13631488
    s_lshl_b32 s22, s23, 15
    s_add_u32 s22, s22, 6291456
    s_cmp_eq_u32 s36, 0
    s_cselect_b32 s22, s22, s20
    s_add_u32 s23, s11, 1
    s_and_b32 s20, s23, 1
    s_lshl_b32 s20, s20, 15
    s_lshl_b32 s21, s9, 13
    s_add_u32 s20, s20, s21
    s_mov_b32 m0, s20
    s_nop 0
    buffer_load_dwordx4 v1, s[4:7], s22 offen offset:0 sc1 lds
    buffer_load_dwordx4 v1, s[4:7], s22 offen offset:1024 sc1 lds
    buffer_load_dwordx4 v1, s[4:7], s22 offen offset:2048 sc1 lds
    buffer_load_dwordx4 v1, s[4:7], s22 offen offset:3072 sc1 lds
    s_add_u32 s20, s20, 4096
    s_mov_b32 m0, s20
    s_add_u32 s21, s22, 4096
    buffer_load_dwordx4 v1, s[4:7], s21 offen offset:0 sc1 lds
    buffer_load_dwordx4 v1, s[4:7], s21 offen offset:1024 sc1 lds
    buffer_load_dwordx4 v1, s[4:7], s21 offen offset:2048 sc1 lds
    buffer_load_dwordx4 v1, s[4:7], s21 offen offset:3072 sc1 lds
    s_mov_b32 s25, s23
H_NOPF:
    s_mov_b32 s30, 0
    s_cmp_lt_u32 s11, 2
    s_cbranch_scc1 H_NOKM
    v_readfirstlane_b32 s20, v15
    s_sub_u32 s21, s28, 4
    s_cmp_gt_u32 s20, s21
    s_cbranch_scc0 H_NOKM
    s_and_b32 s20, s21, 7
    s_lshl_b32 s20, s20, 5
    s_add_u32 s20, s20, s8
    s_lshl_b32 s22, s36, 20
    s_lshl_b32 s23, s20, 12
    s_add_u32 s14, s22, s23
    s_add_u32 s14, s14, 25165824
    s_and_b32 s20, s21, 7
    s_lshl_b32 s20, s20, 5
    s_add_u32 s20, s20, s8
    s_lshl_b32 s22, s36, 21
    s_lshl_b32 s23, s20, 13
    s_add_u32 s15, s22, s23
    s_add_u32 s15, s15, 27262976
    s_lshl_b32 s22, s9, 10
    s_add_u32 s22, s22, 159744
    s_mov_b32 m0, s22
    buffer_load_dwordx2 v[126:127], v6, s[4:7], s14 offen sc1
    buffer_load_dwordx4 v4, s[4:7], s14 offen sc1 lds
    s_mov_b32 s30, 1
H_NOKM:
    v_cvt_pk_bf16_f32 v92, v36, v37
    v_cvt_pk_bf16_f32 v93, v38, v39
    v_cvt_pk_bf16_f32 v94, v40, v41
    v_cvt_pk_bf16_f32 v95, v42, v43
    v_cvt_pk_bf16_f32 v96, v44, v45
    v_cvt_pk_bf16_f32 v97, v46, v47
    v_cvt_pk_bf16_f32 v98, v48, v49
    v_cvt_pk_bf16_f32 v99, v50, v51
    v_permlane32_swap_b32 v92, v94
    v_permlane32_swap_b32 v93, v95
    v_permlane32_swap_b32 v96, v98
    v_permlane32_swap_b32 v97, v99
    buffer_store_dwordx4 v[92:95], v2, s[4:7], s13 offen sc1
    buffer_store_dwordx4 v[96:99], v2, s[4:7], s13 offen offset:1024 sc1
    v_cvt_pk_bf16_f32 v100, v52, v53
    v_cvt_pk_bf16_f32 v101, v54, v55
    v_cvt_pk_bf16_f32 v102, v60, v61
    v_cvt_pk_bf16_f32 v103, v62, v63
    v_cvt_pk_bf16_f32 v104, v56, v57
    v_cvt_pk_bf16_f32 v105, v58, v59
    v_cvt_pk_bf16_f32 v106, v64, v65
    v_cvt_pk_bf16_f32 v107, v66, v67
    buffer_store_dwordx4 v[100:103], v3, s[4:7], s13 offen sc1
    buffer_store_dwordx4 v[104:107], v3, s[4:7], s13 offen offset:512 sc1
    v_cvt_pk_bf16_f32 v84, v20, v21
    v_cvt_pk_bf16_f32 v85, v22, v23
    v_cvt_pk_bf16_f32 v86, v24, v25
    v_cvt_pk_bf16_f32 v87, v26, v27
    v_cvt_pk_bf16_f32 v88, v28, v29
    v_cvt_pk_bf16_f32 v89, v30, v31
    v_cvt_pk_bf16_f32 v90, v32, v33
    v_cvt_pk_bf16_f32 v91, v34, v35
    v_permlane32_swap_b32 v84, v86
    v_permlane32_swap_b32 v85, v87
    v_permlane32_swap_b32 v88, v90
    v_permlane32_swap_b32 v89, v91
    v_add_u32 v16, s72, v11
    ds_write_b128 v16, v[84:87] offset:0
    ds_write_b128 v16, v[88:91] offset:1024
    ds_write_b128 v16, v[92:95] offset:2048
    ds_write_b128 v16, v[96:99] offset:3072
    ds_write_b128 v16, v[100:103] offset:4096
    ds_write_b128 v16, v[104:107] offset:5120
    s_add_u32 s72, s72, 24576
    s_cmp_eq_u32 s72, 73728
    s_cselect_b32 s72, 0, s72
    s_cmp_lt_u32 s11, 2
    s_cbranch_scc0 H_T0
    s_waitcnt vmcnt(0) lgkmcnt(0)
    s_add_u32 s20, s11, 1
    v_mov_b32 v16, s20
    buffer_store_dword v16, off, s[4:7], s17 sc1
    s_branch H_NEXT
H_T0:
    s_sub_u32 s29, s11, 2
H_T1:
    v_add_u32 v16, s73, v11
    s_add_u32 s73, s73, 24576
    s_cmp_eq_u32 s73, 73728
    s_cselect_b32 s73, 0, s73
    s_waitcnt lgkmcnt(0)
    ds_read_b128 v[84:87], v16 offset:0
    ds_read_b128 v[88:91], v16 offset:1024
    ds_read_b128 v[92:95], v16 offset:2048
    ds_read_b128 v[96:99], v16 offset:3072
    ds_read_b128 v[100:103], v16 offset:4096
    ds_read_b128 v[104:107], v16 offset:5120
    s_cmp_eq_u32 s30, 1
    s_cbranch_scc1 H_KMPF
    s_waitcnt vmcnt(0)
    s_add_u32 s20, s11, 1
    v_mov_b32 v16, s20
    buffer_store_dword v16, off, s[4:7], s17 sc1
    s_lshl_b32 s21, s29, 1
    s_add_u32 s21, s21, s10
    s_mov_b32 s24, 0
hfr_145:
    buffer_load_dword v15, off, s[4:7], s18 sc1
    s_add_u32 s24, s24, 1
    s_cmp_gt_u32 s24, 200000
    s_cbranch_scc1 K_FAIL
    s_waitcnt vmcnt(0)
    v_cmp_ge_u32 vcc, s21, v15
    s_cbranch_vccz hfrok_146
    s_sleep 1
    s_branch hfr_145
hfrok_146:
    s_and_b32 s20, s21, 7
    s_lshl_b32 s20, s20, 5
    s_add_u32 s20, s20, s8
    s_lshl_b32 s22, s36, 20
    s_lshl_b32 s23, s20, 12
    s_add_u32 s14, s22, s23
    s_add_u32 s14, s14, 25165824
    s_and_b32 s20, s21, 7
    s_lshl_b32 s20, s20, 5
    s_add_u32 s20, s20, s8
    s_lshl_b32 s22, s36, 21
    s_lshl_b32 s23, s20, 13
    s_add_u32 s15, s22, s23
    s_add_u32 s15, s15, 27262976
    s_lshl_b32 s22, s9, 10
    s_add_u32 s22, s22, 159744
    s_mov_b32 m0, s22
    buffer_load_dwordx2 v[126:127], v6, s[4:7], s14 offen sc1
    buffer_load_dwordx4 v4, s[4:7], s14 offen sc1 lds
    s_waitcnt vmcnt(0)
    s_branch H_KMOK
H_KMPF:
    s_waitcnt vmcnt(4)
H_KMOK:
    buffer_load_dword v14, v12, s[4:7], s75 offen sc1
    ds_read_b64_tr_b16 v[68:69], v5 offset:0
    ds_read_b64_tr_b16 v[70:71], v5 offset:64
    ds_read_b64_tr_b16 v[72:73], v5 offset:256
    ds_read_b64_tr_b16 v[74:75], v5 offset:320
    s_waitcnt lgkmcnt(6)
    v_mfma_f32_32x32x16_bf16 v[20:35], v[92:95], v[84:87], 0
    v_mfma_f32_32x32x16_bf16 v[20:35], v[96:99], v[88:91], v[20:35]
    v_mov_b32 v44, v126
    v_mov_b32 v45, v127
    v_mov_b32 v46, 0
    v_mov_b32 v47, 0
    s_waitcnt lgkmcnt(2)
    v_mfma_f32_32x32x16_bf16 v[52:67], v[68:71], v[84:87], 0
    s_waitcnt lgkmcnt(0)
    v_mfma_f32_32x32x16_bf16 v[52:67], v[72:75], v[88:91], v[52:67]
    s_nop 3
    ds_write_b128 v7, v[20:23] offset:0
    ds_write_b128 v7, v[24:27] offset:1024
    ds_write_b128 v7, v[28:31] offset:2048
    ds_write_b128 v7, v[32:35] offset:3072
    s_nop 3
    ds_write_b128 v7, v[52:55] offset:4096
    v_mov_b32 v40, v52
    v_mov_b32 v41, v53
    v_mov_b32 v42, v54
    v_mov_b32 v43, v55
    s_waitcnt lgkmcnt(0)
    s_barrier
    ds_read_b128 v[68:71], v8 offset:0
    ds_read_b128 v[72:75], v8 offset:1024
    ds_read_b128 v[76:79], v8 offset:2048
    ds_read_b128 v[80:83], v8 offset:3072
    ds_read_b128 v[48:51], v8 offset:4096
    ds_read_b128 v[52:55], v9 offset:0
    ds_read_b128 v[56:59], v9 offset:1024
    ds_read_b128 v[60:63], v9 offset:2048
    ds_read_b128 v[64:67], v9 offset:3072
    ds_read_b128 v[120:123], v9 offset:4096
    s_waitcnt lgkmcnt(9)
    v_add_f32 v20, v20, v68
    v_add_f32 v21, v21, v69
    v_add_f32 v22, v22, v70
    v_add_f32 v23, v23, v71
    s_waitcnt lgkmcnt(8)
    v_add_f32 v24, v24, v72
    v_add_f32 v25, v25, v73
    v_add_f32 v26, v26, v74
    v_add_f32 v27, v27, v75
    s_waitcnt lgkmcnt(7)
    v_add_f32 v28, v28, v76
    v_add_f32 v29, v29, v77
    v_add_f32 v30, v30, v78
    v_add_f32 v31, v31, v79
    s_waitcnt lgkmcnt(6)
    v_add_f32 v32, v32, v80
    v_add_f32 v33, v33, v81
    v_add_f32 v34, v34, v82
    v_add_f32 v35, v35, v83
    s_waitcnt lgkmcnt(5)
    v_add_f32 v40, v40, v48
    v_add_f32 v41, v41, v49
    v_add_f32 v42, v42, v50
    v_add_f32 v43, v43, v51
    ds_read_b128 v[68:71], v10 offset:0
    ds_read_b128 v[72:75], v10 offset:1024
    ds_read_b128 v[76:79], v10 offset:2048
    ds_read_b128 v[80:83], v10 offset:3072
    ds_read_b128 v[48:51], v10 offset:4096
    s_waitcnt lgkmcnt(9)
    v_add_f32 v20, v20, v52
    v_add_f32 v21, v21, v53
    v_add_f32 v22, v22, v54
    v_add_f32 v23, v23, v55
    s_waitcnt lgkmcnt(8)
    v_add_f32 v24, v24, v56
    v_add_f32 v25, v25, v57
    v_add_f32 v26, v26, v58
    v_add_f32 v27, v27, v59
    s_waitcnt lgkmcnt(7)
    v_add_f32 v28, v28, v60
    v_add_f32 v29, v29, v61
    v_add_f32 v30, v30, v62
    v_add_f32 v31, v31, v63
    s_waitcnt lgkmcnt(6)
    v_add_f32 v32, v32, v64
    v_add_f32 v33, v33, v65
    v_add_f32 v34, v34, v66
    v_add_f32 v35, v35, v67
    s_waitcnt lgkmcnt(5)
    v_add_f32 v40, v40, v120
    v_add_f32 v41, v41, v121
    v_add_f32 v42, v42, v122
    v_add_f32 v43, v43, v123
    s_waitcnt lgkmcnt(4)
    v_add_f32 v20, v20, v68
    v_add_f32 v21, v21, v69
    v_add_f32 v22, v22, v70
    v_add_f32 v23, v23, v71
    s_waitcnt lgkmcnt(3)
    v_add_f32 v24, v24, v72
    v_add_f32 v25, v25, v73
    v_add_f32 v26, v26, v74
    v_add_f32 v27, v27, v75
    s_waitcnt lgkmcnt(2)
    v_add_f32 v28, v28, v76
    v_add_f32 v29, v29, v77
    v_add_f32 v30, v30, v78
    v_add_f32 v31, v31, v79
    s_waitcnt lgkmcnt(1)
    v_add_f32 v32, v32, v80
    v_add_f32 v33, v33, v81
    v_add_f32 v34, v34, v82
    v_add_f32 v35, v35, v83
    s_waitcnt lgkmcnt(0)
    v_add_f32 v40, v40, v48
    v_add_f32 v41, v41, v49
    v_add_f32 v42, v42, v50
    v_add_f32 v43, v43, v51
    s_waitcnt vmcnt(0)
    s_add_u32 s20, s11, 1
    v_mov_b32 v16, s20
    buffer_store_dword v16, off, s[4:7], s17 sc1
    s_cmp_eq_u32 s31, 1
    s_cbranch_scc1 h2c_147
    s_cmp_gt_i32 s25, s11
    s_cbranch_scc1 h2c_147
    s_cmp_eq_u32 s11, 31
    s_cbranch_scc1 h2c_147
    s_add_u32 s22, s28, 2
    v_cmp_ge_u32 vcc, s22, v14
    s_cbranch_vccnz h2c_147
    s_mov_b32 s23, s22
    s_and_b32 s20, s23, 15
    s_lshl_b32 s20, s20, 15
    s_add_u32 s20, s20, 13631488
    s_lshl_b32 s22, s23, 15
    s_add_u32 s22, s22, 6291456
    s_cmp_eq_u32 s36, 0
    s_cselect_b32 s22, s22, s20
    s_add_u32 s23, s11, 1
    s_and_b32 s20, s23, 1
    s_lshl_b32 s20, s20, 15
    s_lshl_b32 s21, s9, 13
    s_add_u32 s20, s20, s21
    s_mov_b32 m0, s20
    s_nop 0
    buffer_load_dwordx4 v1, s[4:7], s22 offen offset:0 sc1 lds
    buffer_load_dwordx4 v1, s[4:7], s22 offen offset:1024 sc1 lds
    buffer_load_dwordx4 v1, s[4:7], s22 offen offset:2048 sc1 lds
    buffer_load_dwordx4 v1, s[4:7], s22 offen offset:3072 sc1 lds
    s_add_u32 s20, s20, 4096
    s_mov_b32 m0, s20
    s_add_u32 s21, s22, 4096
    buffer_load_dwordx4 v1, s[4:7], s21 offen offset:0 sc1 lds
    buffer_load_dwordx4 v1, s[4:7], s21 offen offset:1024 sc1 lds
    buffer_load_dwordx4 v1, s[4:7], s21 offen offset:2048 sc1 lds
    buffer_load_dwordx4 v1, s[4:7], s21 offen offset:3072 sc1 lds
    s_mov_b32 s25, s23
h2c_147:
    v_mov_b32 v16, 0xf149f2ca
    v_cndmask_b32 v20, v16, v20, s[40:41]
    v_cndmask_b32 v21, v16, v21, s[42:43]
    v_cndmask_b32 v22, v16, v22, s[44:45]
    v_cndmask_b32 v23, v16, v23, s[46:47]
    v_cndmask_b32 v24, v16, v24, s[48:49]
    v_cndmask_b32 v25, v16, v25, s[50:51]
    v_cndmask_b32 v26, v16, v26, s[52:53]
    v_cndmask_b32 v27, v16, v27, s[54:55]
    v_cndmask_b32 v28, v16, v28, s[56:57]
    v_cndmask_b32 v29, v16, v29, s[58:59]
    v_cndmask_b32 v30, v16, v30, s[60:61]
    v_cndmask_b32 v31, v16, v31, s[62:63]
    v_cndmask_b32 v32, v16, v32, s[64:65]
    v_cndmask_b32 v33, v16, v33, s[66:67]
    v_cndmask_b32 v34, v16, v34, s[68:69]
    v_cndmask_b32 v35, v16, v35, s[70:71]
    v_max3_f32 v120, v20, v21, v22
    v_max3_f32 v121, v23, v24, v25
    v_max3_f32 v120, v120, v26, v27
    v_max3_f32 v121, v121, v28, v29
    v_max3_f32 v120, v120, v30, v31
    v_max3_f32 v121, v121, v32, v33
    v_max3_f32 v120, v120, v34, v35
    v_max3_f32 v121, v121, v40, v41
    v_max3_f32 v120, v120, v42, v43
    v_max_f32 v120, v120, v121
    v_mov_b32 v121, v120
    s_nop 1
    v_permlane32_swap_b32 v120, v121
    v_max_f32 v120, v120, v121
    v_mul_f32 v120, s27, v120
    v_fma_f32 v20, v20, s26, v120
    v_fma_f32 v21, v21, s26, v120
    v_fma_f32 v22, v22, s26, v120
    v_fma_f32 v23, v23, s26, v120
    v_fma_f32 v24, v24, s26, v120
    v_fma_f32 v25, v25, s26, v120
    v_fma_f32 v26, v26, s26, v120
    v_fma_f32 v27, v27, s26, v120
    v_fma_f32 v28, v28, s26, v120
    v_fma_f32 v29, v29, s26, v120
    v_fma_f32 v30, v30, s26, v120
    v_fma_f32 v31, v31, s26, v120
    v_fma_f32 v32, v32, s26, v120
    v_fma_f32 v33, v33, s26, v120
    v_fma_f32 v34, v34, s26, v120
    v_fma_f32 v35, v35, s26, v120
    v_fma_f32 v40, v40, s26, v120
    v_fma_f32 v41, v41, s26, v120
    v_fma_f32 v42, v42, s26, v120
    v_fma_f32 v43, v43, s26, v120
    v_exp_f32 v20, v20
    v_exp_f32 v21, v21
    v_exp_f32 v22, v22
    v_exp_f32 v23, v23
    v_exp_f32 v24, v24
    v_exp_f32 v25, v25
    v_exp_f32 v26, v26
    v_exp_f32 v27, v27
    v_exp_f32 v28, v28
    v_exp_f32 v29, v29
    v_exp_f32 v30, v30
    v_exp_f32 v31, v31
    v_exp_f32 v32, v32
    v_exp_f32 v33, v33
    v_exp_f32 v34, v34
    v_exp_f32 v35, v35
    v_exp_f32 v40, v40
    v_exp_f32 v41, v41
    v_exp_f32 v42, v42
    v_exp_f32 v43, v43
    v_cvt_pk_bf16_f32 v108, v20, v21
    v_cvt_pk_bf16_f32 v109, v22, v23
    v_cvt_pk_bf16_f32 v110, v28, v29
    v_cvt_pk_bf16_f32 v111, v30, v31
    v_cvt_pk_bf16_f32 v112, v24, v25
    v_cvt_pk_bf16_f32 v113, v26, v27
    v_cvt_pk_bf16_f32 v114, v32, v33
    v_cvt_pk_bf16_f32 v115, v34, v35
    v_cvt_pk_bf16_f32 v116, v40, v41
    v_cvt_pk_bf16_f32 v117, v42, v43
    v_mov_b32 v118, 0
    v_mov_b32 v119, 0
    v_mfma_f32_32x32x16_bf16 v[52:67], v[100:103], v[108:111], 0
    v_mfma_f32_32x32x16_bf16 v[52:67], v[104:107], v[112:115], v[52:67]
    v_mfma_f32_32x32x16_bf16 v[52:67], v[44:47], v[116:119], v[52:67]
    v_add_f32 v120, v20, v21
    v_add_f32 v121, v22, v23
    v_add_f32 v122, v24, v25
    v_add_f32 v120, v120, v122
    v_add_f32 v122, v26, v27
    v_add_f32 v121, v121, v122
    v_add_f32 v122, v28, v29
    v_add_f32 v120, v120, v122
    v_add_f32 v122, v30, v31
    v_add_f32 v121, v121, v122
    v_add_f32 v122, v32, v33
    v_add_f32 v120, v120, v122
    v_add_f32 v122, v34, v35
    v_add_f32 v121, v121, v122
    v_add_f32 v122, v40, v41
    v_add_f32 v120, v120, v122
    v_add_f32 v122, v42, v43
    v_add_f32 v121, v121, v122
    v_add_f32 v120, v120, v121
    v_mov_b32 v121, v120
    s_nop 1
    v_permlane32_swap_b32 v120, v121
    v_add_f32 v120, v120, v121
    v_rcp_f32 v120, v120
    s_nop 0
    v_mul_f32 v52, v52, v120
    v_mul_f32 v53, v53, v120
    v_mul_f32 v54, v54, v120
    v_mul_f32 v55, v55, v120
    v_mul_f32 v56, v56, v120
    v_mul_f32 v57, v57, v120
    v_mul_f32 v58, v58, v120
    v_mul_f32 v59, v59, v120
    v_mul_f32 v60, v60, v120
    v_mul_f32 v61, v61, v120
    v_mul_f32 v62, v62, v120
    v_mul_f32 v63, v63, v120
    v_mul_f32 v64, v64, v120
    v_mul_f32 v65, v65, v120
    v_mul_f32 v66, v66, v120
    v_mul_f32 v67, v67, v120
    v_cvt_pk_bf16_f32 v84, v52, v53
    v_cvt_pk_bf16_f32 v85, v54, v55
    v_cvt_pk_bf16_f32 v86, v56, v57
    v_cvt_pk_bf16_f32 v87, v58, v59
    v_cvt_pk_bf16_f32 v88, v60, v61
    v_cvt_pk_bf16_f32 v89, v62, v63
    v_cvt_pk_bf16_f32 v90, v64, v65
    v_cvt_pk_bf16_f32 v91, v66, v67
    v_permlane32_swap_b32 v84, v86
    v_permlane32_swap_b32 v85, v87
    v_permlane32_swap_b32 v88, v90
    v_permlane32_swap_b32 v89, v91
    s_lshl_b32 s21, s29, 1
    s_add_u32 s21, s21, s10
    s_sub_u32 s21, s21, 8
    s_cmp_lt_i32 s21, 0
    s_cbranch_scc1 H_OBOK
    v_cmp_ge_u32 vcc, s21, v17
    s_cbranch_vccz H_OBOK
    s_mov_b32 s24, 0
hob_148:
    v_bfe_u32 v19, v0, 4, 1
    v_lshlrev_b32 v19, 7, v19
    buffer_load_dword v17, v19, s[4:7], s74 offen sc1
    s_add_u32 s24, s24, 1
    s_cmp_gt_u32 s24, 200000
    s_cbranch_scc1 K_FAIL
    s_waitcnt vmcnt(0)
    v_cmp_ge_u32 vcc, s21, v17
    s_cbranch_vccz hobok_149
    s_sleep 1
    s_branch hob_148
hobok_149:
H_OBOK:
    s_waitcnt vmcnt(0)
    buffer_store_dwordx4 v[84:87], v2, s[4:7], s15 offen sc1
    buffer_store_dwordx4 v[88:91], v2, s[4:7], s15 offen offset:1024 sc1
    s_cmp_eq_u32 s29, 31
    s_cbranch_scc1 H_END
    s_cmp_eq_u32 s31, 1
    s_cbranch_scc1 H_LASTT
H_NEXT:
    s_cmp_eq_u32 s11, 31
    s_cbranch_scc1 H_LASTT
    s_add_u32 s11, s11, 1
    s_add_u32 s28, s28, 2
    s_branch H_P
H_LASTT:
    s_waitcnt vmcnt(0)
    s_add_u32 s20, s29, 1
    v_mov_b32 v16, s20
    buffer_store_dword v16, off, s[4:7], s19 sc1
    s_add_u32 s29, s29, 1
    s_mov_b32 s30, 0
    s_mov_b32 s31, 1
    s_barrier
    s_branch H_T1
H_END:
    s_waitcnt vmcnt(0)
    s_mov_b32 s23, 31
    s_add_u32 s20, s23, 1
    v_mov_b32 v16, s20
    buffer_store_dword v16, off, s[4:7], s19 sc1
    s_waitcnt vmcnt(0)
    s_branch K_DONE
K_FAIL:
    s_load_dwordx2 s[88:89], s[0:1], 88
    s_waitcnt lgkmcnt(0)
    v_mov_b32 v24, 0xdead
    v_mov_b32 v25, 0
    global_store_dword v25, v24, s[88:89] offset:64
    s_lshl_b32 s93, s90, 2
    s_add_u32 s93, s93, 96
    v_mov_b32 v25, s93
    v_mov_b32 v24, s91
    global_store_dword v25, v24, s[88:89]
    s_waitcnt vmcnt(0)
K_DONE:
    s_endpgm
K_CODE_END:
.section .rodata,"a"
.p2align 6
.amdhsa_kernel interleave_layers__sliding_local_dilated__memory_aug_recurrent_mem_tr__prompt_kernel
  .amdhsa_next_free_vgpr 512
  .amdhsa_next_free_sgpr 102
  .amdhsa_accum_offset 256
  .amdhsa_group_segment_fixed_size 0
  .amdhsa_kernarg_size 104
  .amdhsa_user_sgpr_count 2
  .amdhsa_user_sgpr_kernarg_segment_ptr 1
  .amdhsa_system_sgpr_workgroup_id_x 1
  .amdhsa_float_denorm_mode_32 3
.end_amdhsa_kernel
```
